```python
import torch

def _softmax(x, axis=-1):
    return torch.softmax(x, dim=axis)

def _gelu(x):
    return torch.nn.functional.gelu(x, approximate='tanh')

def _silu(x):
    return torch.nn.functional.silu(x)

def _sigmoid(x):
    return torch.sigmoid(x)

def _layernorm(x, axis=-1, eps=1e-05):
    m = x.mean(dim=axis, keepdim=True)
    v = x.var(dim=axis, keepdim=True, unbiased=False)
    return (x - m) / torch.sqrt(v + eps)

def _scatter_add(tgt, idx, src, axis=0):
    return tgt.clone().index_add_(axis, idx, src)

def _segment_sum(src, seg, n):
    out = torch.zeros((n,) + src.shape[1:], dtype=src.dtype)
    return out.index_add_(0, seg, src)

def _pad(x, pw):
    flat = tuple((v for pair in reversed(pw) for v in pair))
    return torch.nn.functional.pad(x, flat)
kernel_name = 'sequential_preLN__sliding_block__mixer_gmlp__prompt'

def setup_inputs():

    _w = lambda a: (lambda t: t.to(torch.bfloat16) if t.is_floating_point() else t)(torch.as_tensor(a))

    def _A_setup():
        B, S, D = (1, 2048, 1024)
        return {'x': _w((lambda *s: torch.randn(*s, dtype=torch.bfloat16) * 0.05)(B, S, D)), 'wqkv': _w((lambda *s: torch.randn(*s, dtype=torch.bfloat16) * 0.05)(D, 3 * D)), 'wo': _w((lambda *s: torch.randn(*s, dtype=torch.bfloat16) * 0.05)(D, D))}
    _A_in = _A_setup()

    def _B_setup():
        B, S, D, F = (1, 2048, 1024, 3584)
        Fh = F // 2
        return {'x': _w((lambda *s: torch.randn(*s, dtype=torch.bfloat16) * 0.05)(B, S, D)), 'w_in': _w((lambda *s: torch.randn(*s, dtype=torch.bfloat16) * 0.8)(D, 2 * Fh)), 'w_sp': _w(0.01 * (lambda *s: torch.randn(*s, dtype=torch.bfloat16) * 0.8)(S, S)), 'b_sp': _w(1.0 + 0.01 * (lambda *s: torch.randn(*s, dtype=torch.bfloat16) * 0.05)(S)), 'w_out': _w((lambda *s: torch.randn(*s, dtype=torch.bfloat16) * 0.05)(Fh, D))}
    _B_in = _B_setup()
    return {'A_x': _A_in['x'], 'A_wqkv': _A_in['wqkv'], 'A_wo': _A_in['wo'], 'B_x': _B_in['x'], 'B_w_in': _B_in['w_in'], 'B_w_sp': _B_in['w_sp'], 'B_b_sp': _B_in['b_sp'], 'B_w_out': _B_in['w_out']}

def reference(A_x, A_wqkv, A_wo, B_x, B_w_in, B_w_sp, B_b_sp, B_w_out):

    def _A_ref(x, wqkv, wo):
        B, S, D = x.shape
        H = 32
        Dh = D // H
        W = 256
        qkv = (lambda x, *d: x.permute(*d))((x @ wqkv).reshape(B, S, 3, H, Dh), 2, 0, 3, 1, 4)
        q, k, v = (qkv[0], qkv[1], qkv[2])
        scores = torch.einsum('bhqd,bhkd->bhqk', q, k) * Dh ** (-0.5)
        idx = torch.arange(S)
        mask = (idx[:, None] - idx[None, :] >= 0) & (idx[:, None] - idx[None, :] < W)
        scores = torch.where(mask[None, None], scores, -1000000000.0)
        p = _softmax(scores, axis=-1)
        o = torch.einsum('bhqk,bhkd->bhqd', p, v)
        return (lambda x, *d: x.permute(*d))(o, 0, 2, 1, 3).reshape(B, S, D) @ wo

    def _B_ref(x, w_in, w_sp, b_sp, w_out):
        B, S, D = x.shape
        F = w_in.shape[-1]
        Fh = F // 2
        z = _gelu(torch.einsum('bsd,df->bsf', x, w_in))
        z1 = z[..., :Fh].clone()
        z2 = _layernorm(z[..., Fh:], axis=-1)
        g = torch.einsum('ts,bsf->btf', w_sp, z2) + b_sp[None, :, None]
        return torch.einsum('bsf,fd->bsd', z1 * g, w_out)
    x = A_x
    h = x + _A_ref(_layernorm(x, axis=-1), A_wqkv, A_wo)
    h2 = h + _B_ref(_layernorm(h, axis=-1), B_w_in, B_w_sp, B_b_sp, B_w_out)
    return h2
```

```asm
; @launch kernel=sequential_preLN__sliding_block__mixer_gmlp__prompt_kernel grid=(256,1,1) block=(512,1,1) lds=163840
.amdgcn_target "amdgcn-amd-amdhsa--gfx950"
.text
.globl sequential_preLN__sliding_block__mixer_gmlp__prompt_kernel
.p2align 8
.type sequential_preLN__sliding_block__mixer_gmlp__prompt_kernel,@function
sequential_preLN__sliding_block__mixer_gmlp__prompt_kernel:
s_cmp_ge_u32 s2, 256
s_cbranch_scc1 Lsequential_preLN__sliding_block__mixer_gmlp__prompt_kernel_end
s_load_dwordx16 s[40:55], s[0:1], 0
s_load_dwordx4 s[56:59], s[0:1], 64
s_load_dwordx2 s[60:61], s[0:1], 80
v_lshrrev_b32 v2, 6, v0
v_and_b32 v1, 63, v0
s_nop 0
v_readfirstlane_b32 s75, v2
v_and_b32 v2, 15, v1
v_lshrrev_b32 v3, 4, v1
s_waitcnt lgkmcnt(0)
s_and_b32 s30, s75, 3
s_add_u32 s96, s60, 53477376
s_addc_u32 s97, s61, 0
s_mov_b32 s98, 65536
s_mov_b32 s99, 0x00020000
s_cmp_ge_u32 s75, 4
s_cbranch_scc1 Lld1
s_setprio 3
s_and_b32 s3, s2, 7
s_lshr_b32 s4, s2, 3
s_and_b32 s28, s3, 1
s_lshl_b32 s28, s28, 3
s_and_b32 s5, s4, 7
s_add_u32 s28, s28, s5
s_lshr_b32 s29, s3, 1
s_lshl_b32 s29, s29, 2
s_lshr_b32 s5, s4, 3
s_add_u32 s29, s29, s5
s_mov_b32 s20, s40
s_mov_b32 s21, s41
s_mov_b32 s22, 4194304
s_mov_b32 s23, 0x00020000
s_add_u32 s24, s60, 50855936
s_addc_u32 s25, s61, 0
s_mov_b32 s26, 16384
s_mov_b32 s27, 0x00020000
s_lshl_b32 s6, s28, 4
s_add_u32 s6, s6, s29
s_lshl_b32 s3, s6, 14
s_lshl_b32 s4, s30, 12
s_add_u32 s3, s3, s4
v_lshlrev_b32 v60, 4, v1
buffer_load_dwordx4 v[4:7], v60, s[20:23], s3 offen offset:0
buffer_load_dwordx4 v[8:11], v60, s[20:23], s3 offen offset:1024
buffer_load_dwordx4 v[12:15], v60, s[20:23], s3 offen offset:2048
buffer_load_dwordx4 v[16:19], v60, s[20:23], s3 offen offset:3072
s_mov_b32 s8, s42
s_mov_b32 s9, s43
s_mov_b32 s10, 6291456
s_mov_b32 s11, 0x00020000
s_add_u32 s12, s60, 50987008
s_addc_u32 s13, s61, 0
s_mov_b32 s14, 196608
s_mov_b32 s15, 0x00020000
v_and_b32 v96, 7, v1
v_min_u32 v96, 5, v96
s_mul_i32 s4, s30, 6
v_add_u32 v96, s4, v96
v_lshrrev_b32 v97, 3, v1
v_mul_u32_u24 v97, 6144, v97
v_lshrrev_b32 v98, 3, v96
v_lshl_add_u32 v97, v98, 11, v97
v_and_b32 v98, 7, v96
v_lshl_add_u32 v97, v98, 4, v97
v_lshlrev_b32 v96, 5, v96
s_mul_i32 s4, s29, 128
s_mul_i32 s5, s28, 393216
s_add_u32 s5, s5, s4
s_mul_i32 s4, s29, 768
s_mul_i32 s7, s28, 12288
s_add_u32 s7, s7, s4
buffer_load_dwordx4 v[64:67], v97, s[8:11], s5 offen
s_add_u32 s5, s5, 49152
buffer_load_dwordx4 v[68:71], v97, s[8:11], s5 offen
s_add_u32 s5, s5, 49152
buffer_load_dwordx4 v[72:75], v97, s[8:11], s5 offen
s_add_u32 s5, s5, 49152
buffer_load_dwordx4 v[76:79], v97, s[8:11], s5 offen
s_add_u32 s5, s5, 49152
buffer_load_dwordx4 v[80:83], v97, s[8:11], s5 offen
s_add_u32 s5, s5, 49152
buffer_load_dwordx4 v[84:87], v97, s[8:11], s5 offen
s_add_u32 s5, s5, 49152
buffer_load_dwordx4 v[88:91], v97, s[8:11], s5 offen
s_add_u32 s5, s5, 49152
buffer_load_dwordx4 v[92:95], v97, s[8:11], s5 offen
s_add_u32 s5, s5, 49152
s_add_u32 s16, s60, 52428800
s_addc_u32 s17, s61, 0
s_mov_b32 s18, 262144
s_mov_b32 s19, 0x00020000
s_lshl_b32 s4, s6, 10
v_mov_b32 v53, -1
v_mov_b32 v54, 0
v_lshlrev_b32 v52, 2, v0
buffer_store_dword v53, v52, s[16:19], s4 offen sc1
s_waitcnt vmcnt(9)
v_lshlrev_b32 v20, 16, v4
v_and_b32 v21, 0xffff0000, v4
v_lshlrev_b32 v22, 16, v5
v_and_b32 v23, 0xffff0000, v5
v_lshlrev_b32 v24, 16, v6
v_and_b32 v25, 0xffff0000, v6
v_lshlrev_b32 v26, 16, v7
v_and_b32 v27, 0xffff0000, v7
v_lshlrev_b32 v28, 16, v8
v_and_b32 v29, 0xffff0000, v8
v_lshlrev_b32 v30, 16, v9
v_and_b32 v31, 0xffff0000, v9
v_lshlrev_b32 v32, 16, v10
v_and_b32 v33, 0xffff0000, v10
v_lshlrev_b32 v34, 16, v11
v_and_b32 v35, 0xffff0000, v11
v_lshlrev_b32 v36, 16, v12
v_and_b32 v37, 0xffff0000, v12
v_lshlrev_b32 v38, 16, v13
v_and_b32 v39, 0xffff0000, v13
v_lshlrev_b32 v40, 16, v14
v_and_b32 v41, 0xffff0000, v14
v_lshlrev_b32 v42, 16, v15
v_and_b32 v43, 0xffff0000, v15
v_lshlrev_b32 v44, 16, v16
v_and_b32 v45, 0xffff0000, v16
v_lshlrev_b32 v46, 16, v17
v_and_b32 v47, 0xffff0000, v17
v_lshlrev_b32 v48, 16, v18
v_and_b32 v49, 0xffff0000, v18
v_lshlrev_b32 v50, 16, v19
v_and_b32 v51, 0xffff0000, v19
v_pk_add_f32 v[52:53], v[20:21], v[22:23]
v_pk_add_f32 v[52:53], v[52:53], v[24:25]
v_pk_add_f32 v[52:53], v[52:53], v[26:27]
v_pk_add_f32 v[52:53], v[52:53], v[28:29]
v_pk_add_f32 v[52:53], v[52:53], v[30:31]
v_pk_add_f32 v[52:53], v[52:53], v[32:33]
v_pk_add_f32 v[52:53], v[52:53], v[34:35]
v_add_f32 v52, v52, v53
v_pk_add_f32 v[54:55], v[36:37], v[38:39]
v_pk_add_f32 v[54:55], v[54:55], v[40:41]
v_pk_add_f32 v[54:55], v[54:55], v[42:43]
v_pk_add_f32 v[54:55], v[54:55], v[44:45]
v_pk_add_f32 v[54:55], v[54:55], v[46:47]
v_pk_add_f32 v[54:55], v[54:55], v[48:49]
v_pk_add_f32 v[54:55], v[54:55], v[50:51]
v_add_f32 v54, v54, v55
s_nop 1
v_add_f32_dpp v52, v52, v52 quad_perm:[1,0,3,2] row_mask:0xf bank_mask:0xf
v_add_f32_dpp v54, v54, v54 quad_perm:[1,0,3,2] row_mask:0xf bank_mask:0xf
s_nop 1
v_add_f32_dpp v52, v52, v52 quad_perm:[2,3,0,1] row_mask:0xf bank_mask:0xf
v_add_f32_dpp v54, v54, v54 quad_perm:[2,3,0,1] row_mask:0xf bank_mask:0xf
s_nop 1
v_add_f32_dpp v52, v52, v52 row_half_mirror row_mask:0xf bank_mask:0xf
v_add_f32_dpp v54, v54, v54 row_half_mirror row_mask:0xf bank_mask:0xf
s_nop 1
v_add_f32_dpp v52, v52, v52 row_mirror row_mask:0xf bank_mask:0xf
v_add_f32_dpp v54, v54, v54 row_mirror row_mask:0xf bank_mask:0xf
v_mov_b32 v53, v52
v_mov_b32 v55, v54
s_nop 1
v_permlane16_swap_b32 v52, v53
v_permlane16_swap_b32 v54, v55
s_nop 1
v_add_f32 v52, v52, v53
v_add_f32 v54, v54, v55
v_mov_b32 v53, v52
v_mov_b32 v55, v54
s_nop 1
v_permlane32_swap_b32 v52, v53
v_permlane32_swap_b32 v54, v55
s_nop 1
v_add_f32 v52, v52, v53
v_add_f32 v54, v54, v55
v_mul_f32 v52, 0xba800000, v52
v_mul_f32 v54, 0xba800000, v54
v_pk_add_f32 v[20:21], v[20:21], v[52:53] op_sel_hi:[1,0]
v_pk_add_f32 v[22:23], v[22:23], v[52:53] op_sel_hi:[1,0]
v_pk_add_f32 v[24:25], v[24:25], v[52:53] op_sel_hi:[1,0]
v_pk_add_f32 v[26:27], v[26:27], v[52:53] op_sel_hi:[1,0]
v_pk_add_f32 v[28:29], v[28:29], v[52:53] op_sel_hi:[1,0]
v_pk_add_f32 v[30:31], v[30:31], v[52:53] op_sel_hi:[1,0]
v_pk_add_f32 v[32:33], v[32:33], v[52:53] op_sel_hi:[1,0]
v_pk_add_f32 v[34:35], v[34:35], v[52:53] op_sel_hi:[1,0]
v_pk_add_f32 v[36:37], v[36:37], v[54:55] op_sel_hi:[1,0]
v_pk_add_f32 v[38:39], v[38:39], v[54:55] op_sel_hi:[1,0]
v_pk_add_f32 v[40:41], v[40:41], v[54:55] op_sel_hi:[1,0]
v_pk_add_f32 v[42:43], v[42:43], v[54:55] op_sel_hi:[1,0]
v_pk_add_f32 v[44:45], v[44:45], v[54:55] op_sel_hi:[1,0]
v_pk_add_f32 v[46:47], v[46:47], v[54:55] op_sel_hi:[1,0]
v_pk_add_f32 v[48:49], v[48:49], v[54:55] op_sel_hi:[1,0]
v_pk_add_f32 v[50:51], v[50:51], v[54:55] op_sel_hi:[1,0]
v_mov_b32 v56, v52
v_mov_b32 v57, v54
v_pk_mul_f32 v[52:53], v[20:21], v[20:21]
v_pk_fma_f32 v[52:53], v[22:23], v[22:23], v[52:53]
v_pk_fma_f32 v[52:53], v[24:25], v[24:25], v[52:53]
v_pk_fma_f32 v[52:53], v[26:27], v[26:27], v[52:53]
v_pk_fma_f32 v[52:53], v[28:29], v[28:29], v[52:53]
v_pk_fma_f32 v[52:53], v[30:31], v[30:31], v[52:53]
v_pk_fma_f32 v[52:53], v[32:33], v[32:33], v[52:53]
v_pk_fma_f32 v[52:53], v[34:35], v[34:35], v[52:53]
v_add_f32 v52, v52, v53
v_pk_mul_f32 v[54:55], v[36:37], v[36:37]
v_pk_fma_f32 v[54:55], v[38:39], v[38:39], v[54:55]
v_pk_fma_f32 v[54:55], v[40:41], v[40:41], v[54:55]
v_pk_fma_f32 v[54:55], v[42:43], v[42:43], v[54:55]
v_pk_fma_f32 v[54:55], v[44:45], v[44:45], v[54:55]
v_pk_fma_f32 v[54:55], v[46:47], v[46:47], v[54:55]
v_pk_fma_f32 v[54:55], v[48:49], v[48:49], v[54:55]
v_pk_fma_f32 v[54:55], v[50:51], v[50:51], v[54:55]
v_add_f32 v54, v54, v55
s_nop 1
v_add_f32_dpp v52, v52, v52 quad_perm:[1,0,3,2] row_mask:0xf bank_mask:0xf
v_add_f32_dpp v54, v54, v54 quad_perm:[1,0,3,2] row_mask:0xf bank_mask:0xf
s_nop 1
v_add_f32_dpp v52, v52, v52 quad_perm:[2,3,0,1] row_mask:0xf bank_mask:0xf
v_add_f32_dpp v54, v54, v54 quad_perm:[2,3,0,1] row_mask:0xf bank_mask:0xf
s_nop 1
v_add_f32_dpp v52, v52, v52 row_half_mirror row_mask:0xf bank_mask:0xf
v_add_f32_dpp v54, v54, v54 row_half_mirror row_mask:0xf bank_mask:0xf
s_nop 1
v_add_f32_dpp v52, v52, v52 row_mirror row_mask:0xf bank_mask:0xf
v_add_f32_dpp v54, v54, v54 row_mirror row_mask:0xf bank_mask:0xf
v_mov_b32 v53, v52
v_mov_b32 v55, v54
s_nop 1
v_permlane16_swap_b32 v52, v53
v_permlane16_swap_b32 v54, v55
s_nop 1
v_add_f32 v52, v52, v53
v_add_f32 v54, v54, v55
v_mov_b32 v53, v52
v_mov_b32 v55, v54
s_nop 1
v_permlane32_swap_b32 v52, v53
v_permlane32_swap_b32 v54, v55
s_nop 1
v_add_f32 v52, v52, v53
v_add_f32 v54, v54, v55
v_mul_f32 v52, 0x3a800000, v52
v_mul_f32 v54, 0x3a800000, v54
v_add_f32 v52, 0x3727c5ac, v52
v_rsq_f32 v52, v52
v_add_f32 v54, 0x3727c5ac, v54
v_rsq_f32 v54, v54
s_nop 0
v_mul_f32 v53, v56, v52
v_mul_f32 v55, v57, v54
s_lshr_b32 s3, s3, 8
s_mov_b64 exec, 1
buffer_store_dwordx4 v[52:55], off, s[24:27], s3 sc1
s_mov_b64 exec, -1
s_waitcnt vmcnt(9)
v_lshlrev_b32 v20, 16, v64
v_and_b32 v21, 0xffff0000, v64
v_lshlrev_b32 v22, 16, v65
v_and_b32 v23, 0xffff0000, v65
v_lshlrev_b32 v24, 16, v66
v_and_b32 v25, 0xffff0000, v66
v_lshlrev_b32 v26, 16, v67
v_and_b32 v27, 0xffff0000, v67
s_waitcnt vmcnt(8)
v_lshlrev_b32 v28, 16, v68
v_and_b32 v29, 0xffff0000, v68
v_lshlrev_b32 v30, 16, v69
v_and_b32 v31, 0xffff0000, v69
v_lshlrev_b32 v32, 16, v70
v_and_b32 v33, 0xffff0000, v70
v_lshlrev_b32 v34, 16, v71
v_and_b32 v35, 0xffff0000, v71
v_pk_add_f32 v[20:21], v[20:21], v[28:29]
v_pk_add_f32 v[22:23], v[22:23], v[30:31]
v_pk_add_f32 v[24:25], v[24:25], v[32:33]
v_pk_add_f32 v[26:27], v[26:27], v[34:35]
s_waitcnt vmcnt(7)
v_lshlrev_b32 v28, 16, v72
v_and_b32 v29, 0xffff0000, v72
v_lshlrev_b32 v30, 16, v73
v_and_b32 v31, 0xffff0000, v73
v_lshlrev_b32 v32, 16, v74
v_and_b32 v33, 0xffff0000, v74
v_lshlrev_b32 v34, 16, v75
v_and_b32 v35, 0xffff0000, v75
v_pk_add_f32 v[20:21], v[20:21], v[28:29]
v_pk_add_f32 v[22:23], v[22:23], v[30:31]
v_pk_add_f32 v[24:25], v[24:25], v[32:33]
v_pk_add_f32 v[26:27], v[26:27], v[34:35]
s_waitcnt vmcnt(6)
v_lshlrev_b32 v28, 16, v76
v_and_b32 v29, 0xffff0000, v76
v_lshlrev_b32 v30, 16, v77
v_and_b32 v31, 0xffff0000, v77
v_lshlrev_b32 v32, 16, v78
v_and_b32 v33, 0xffff0000, v78
v_lshlrev_b32 v34, 16, v79
v_and_b32 v35, 0xffff0000, v79
v_pk_add_f32 v[20:21], v[20:21], v[28:29]
v_pk_add_f32 v[22:23], v[22:23], v[30:31]
v_pk_add_f32 v[24:25], v[24:25], v[32:33]
v_pk_add_f32 v[26:27], v[26:27], v[34:35]
s_waitcnt vmcnt(5)
v_lshlrev_b32 v28, 16, v80
v_and_b32 v29, 0xffff0000, v80
v_lshlrev_b32 v30, 16, v81
v_and_b32 v31, 0xffff0000, v81
v_lshlrev_b32 v32, 16, v82
v_and_b32 v33, 0xffff0000, v82
v_lshlrev_b32 v34, 16, v83
v_and_b32 v35, 0xffff0000, v83
v_pk_add_f32 v[20:21], v[20:21], v[28:29]
v_pk_add_f32 v[22:23], v[22:23], v[30:31]
v_pk_add_f32 v[24:25], v[24:25], v[32:33]
v_pk_add_f32 v[26:27], v[26:27], v[34:35]
s_waitcnt vmcnt(4)
v_lshlrev_b32 v28, 16, v84
v_and_b32 v29, 0xffff0000, v84
v_lshlrev_b32 v30, 16, v85
v_and_b32 v31, 0xffff0000, v85
v_lshlrev_b32 v32, 16, v86
v_and_b32 v33, 0xffff0000, v86
v_lshlrev_b32 v34, 16, v87
v_and_b32 v35, 0xffff0000, v87
v_pk_add_f32 v[20:21], v[20:21], v[28:29]
v_pk_add_f32 v[22:23], v[22:23], v[30:31]
v_pk_add_f32 v[24:25], v[24:25], v[32:33]
v_pk_add_f32 v[26:27], v[26:27], v[34:35]
s_waitcnt vmcnt(3)
v_lshlrev_b32 v28, 16, v88
v_and_b32 v29, 0xffff0000, v88
v_lshlrev_b32 v30, 16, v89
v_and_b32 v31, 0xffff0000, v89
v_lshlrev_b32 v32, 16, v90
v_and_b32 v33, 0xffff0000, v90
v_lshlrev_b32 v34, 16, v91
v_and_b32 v35, 0xffff0000, v91
v_pk_add_f32 v[20:21], v[20:21], v[28:29]
v_pk_add_f32 v[22:23], v[22:23], v[30:31]
v_pk_add_f32 v[24:25], v[24:25], v[32:33]
v_pk_add_f32 v[26:27], v[26:27], v[34:35]
s_waitcnt vmcnt(2)
v_lshlrev_b32 v28, 16, v92
v_and_b32 v29, 0xffff0000, v92
v_lshlrev_b32 v30, 16, v93
v_and_b32 v31, 0xffff0000, v93
v_lshlrev_b32 v32, 16, v94
v_and_b32 v33, 0xffff0000, v94
v_lshlrev_b32 v34, 16, v95
v_and_b32 v35, 0xffff0000, v95
v_pk_add_f32 v[20:21], v[20:21], v[28:29]
v_pk_add_f32 v[22:23], v[22:23], v[30:31]
v_pk_add_f32 v[24:25], v[24:25], v[32:33]
v_pk_add_f32 v[26:27], v[26:27], v[34:35]
s_nop 1
v_add_f32_dpp v20, v20, v20 row_ror:8 row_mask:0xf bank_mask:0xf
v_add_f32_dpp v21, v21, v21 row_ror:8 row_mask:0xf bank_mask:0xf
v_add_f32_dpp v22, v22, v22 row_ror:8 row_mask:0xf bank_mask:0xf
v_add_f32_dpp v23, v23, v23 row_ror:8 row_mask:0xf bank_mask:0xf
v_add_f32_dpp v24, v24, v24 row_ror:8 row_mask:0xf bank_mask:0xf
v_add_f32_dpp v25, v25, v25 row_ror:8 row_mask:0xf bank_mask:0xf
v_add_f32_dpp v26, v26, v26 row_ror:8 row_mask:0xf bank_mask:0xf
v_add_f32_dpp v27, v27, v27 row_ror:8 row_mask:0xf bank_mask:0xf
v_mov_b32 v28, v20
v_mov_b32 v29, v21
v_mov_b32 v30, v22
v_mov_b32 v31, v23
v_mov_b32 v32, v24
v_mov_b32 v33, v25
v_mov_b32 v34, v26
v_mov_b32 v35, v27
s_nop 1
v_permlane16_swap_b32 v20, v28
v_permlane16_swap_b32 v21, v29
v_permlane16_swap_b32 v22, v30
v_permlane16_swap_b32 v23, v31
v_permlane16_swap_b32 v24, v32
v_permlane16_swap_b32 v25, v33
v_permlane16_swap_b32 v26, v34
v_permlane16_swap_b32 v27, v35
s_nop 1
v_add_f32 v20, v20, v28
v_add_f32 v21, v21, v29
v_add_f32 v22, v22, v30
v_add_f32 v23, v23, v31
v_add_f32 v24, v24, v32
v_add_f32 v25, v25, v33
v_add_f32 v26, v26, v34
v_add_f32 v27, v27, v35
v_mov_b32 v28, v20
v_mov_b32 v29, v21
v_mov_b32 v30, v22
v_mov_b32 v31, v23
v_mov_b32 v32, v24
v_mov_b32 v33, v25
v_mov_b32 v34, v26
v_mov_b32 v35, v27
s_nop 1
v_permlane32_swap_b32 v20, v28
v_permlane32_swap_b32 v21, v29
v_permlane32_swap_b32 v22, v30
v_permlane32_swap_b32 v23, v31
v_permlane32_swap_b32 v24, v32
v_permlane32_swap_b32 v25, v33
v_permlane32_swap_b32 v26, v34
v_permlane32_swap_b32 v27, v35
s_nop 1
v_add_f32 v20, v20, v28
v_add_f32 v21, v21, v29
v_add_f32 v22, v22, v30
v_add_f32 v23, v23, v31
v_add_f32 v24, v24, v32
v_add_f32 v25, v25, v33
v_add_f32 v26, v26, v34
v_add_f32 v27, v27, v35
s_mov_b64 exec, 63
buffer_store_dwordx4 v[20:23], v96, s[12:15], s7 offen offset:0 sc1
buffer_store_dwordx4 v[24:27], v96, s[12:15], s7 offen offset:16 sc1
s_mov_b64 exec, -1
s_and_b32 s3, s2, 7
s_lshr_b32 s4, s2, 3
s_and_b32 s28, s3, 1
s_lshl_b32 s28, s28, 3
s_and_b32 s5, s4, 7
s_add_u32 s28, s28, s5
s_lshr_b32 s29, s3, 1
s_lshl_b32 s29, s29, 2
s_lshr_b32 s5, s4, 3
s_add_u32 s29, s29, s5
s_lshr_b32 s62, s30, 1
s_and_b32 s63, s30, 1
s_mul_i32 s5, s62, 8192
v_bfe_u32 v20, v2, 1, 3
v_xor_b32 v20, v20, v3
v_lshlrev_b32 v20, 4, v20
v_lshl_add_u32 v20, v2, 7, v20
v_add_u32 v4, s5, v20
v_xor_b32 v5, 64, v4
v_bfe_u32 v20, v1, 2, 3
v_bfe_u32 v21, v1, 5, 1
v_lshl_add_u32 v21, v21, 4, v20
v_mul_u32_u24 v21, 384, v21
v_and_b32 v22, 3, v1
v_lshl_add_u32 v21, v22, 3, v21
v_add_u32 v21, 16384, v21
s_mul_i32 s5, s63, 6
v_bfe_u32 v22, v20, 1, 2
s_add_u32 s6, s5, 0
v_xor_b32 v23, s6, v22
v_lshl_add_u32 v8, v23, 5, v21
s_add_u32 s6, s5, 1
v_xor_b32 v23, s6, v22
v_lshl_add_u32 v9, v23, 5, v21
s_add_u32 s6, s5, 2
v_xor_b32 v23, s6, v22
v_lshl_add_u32 v10, v23, 5, v21
s_add_u32 s6, s5, 3
v_xor_b32 v23, s6, v22
v_lshl_add_u32 v11, v23, 5, v21
s_add_u32 s16, s60, 4194304
s_addc_u32 s17, s61, 0
s_mov_b32 s18, 12582912
s_mov_b32 s19, 0x00020000
v_and_b32 v20, 1, v3
v_lshrrev_b32 v21, 1, v3
v_lshl_add_u32 v20, v20, 1, v21
v_mul_u32_u24 v200, 16, v20
v_mul_u32_u24 v201, 8, v3
v_mul_u32_u24 v20, 64, v2
v_add_u32 v200, v200, v20
v_lshrrev_b32 v20, 0, v20
v_add_u32 v201, v201, v20
v_and_b32 v20, 1, v3
v_lshrrev_b32 v21, 1, v3
v_lshl_add_u32 v20, v20, 1, v21
v_mul_u32_u24 v202, 32, v20
v_mul_u32_u24 v203, 16, v3
s_mov_b32 s84, s58
s_mov_b32 s85, s59
s_mov_b32 s86, 256
s_mov_b32 s87, 0x00020000
s_mul_i32 s3, s63, 384
s_add_u32 s3, s3, 115712
v_add_u32 v202, s3, v202
s_lshl_b32 s3, s62, 9
s_add_u32 s3, s3, 114688
v_lshlrev_b32 v203, 3, v2
v_add_u32 v203, s3, v203
v_lshlrev_b32 v20, 7, v1
s_lshl_b32 s88, s2, 2
s_add_u32 s88, s88, s30
v_mov_b64 v[24:25], 0
v_mov_b64 v[26:27], 0
v_mov_b64 v[28:29], 0
v_mov_b64 v[30:31], 0
v_mov_b64 v[32:33], 0
v_mov_b64 v[34:35], 0
v_mov_b64 v[36:37], 0
v_mov_b64 v[38:39], 0
v_mov_b64 v[40:41], 0
v_mov_b64 v[42:43], 0
v_mov_b64 v[44:45], 0
v_mov_b64 v[46:47], 0
v_mov_b64 v[48:49], 0
v_mov_b64 v[50:51], 0
v_mov_b64 v[52:53], 0
v_mov_b64 v[54:55], 0
v_mov_b64 v[56:57], 0
v_mov_b64 v[58:59], 0
v_mov_b64 v[60:61], 0
v_mov_b64 v[62:63], 0
v_mov_b64 v[64:65], 0
v_mov_b64 v[66:67], 0
v_mov_b64 v[68:69], 0
v_mov_b64 v[70:71], 0
v_mov_b64 v[72:73], 0
v_mov_b64 v[74:75], 0
v_mov_b64 v[76:77], 0
v_mov_b64 v[78:79], 0
v_mov_b64 v[80:81], 0
v_mov_b64 v[82:83], 0
v_mov_b64 v[84:85], 0
v_mov_b64 v[86:87], 0
v_mov_b64 v[88:89], 0
v_mov_b64 v[90:91], 0
v_mov_b64 v[92:93], 0
v_mov_b64 v[94:95], 0
v_mov_b64 v[96:97], 0
v_mov_b64 v[98:99], 0
v_mov_b64 v[100:101], 0
v_mov_b64 v[102:103], 0
v_mov_b64 v[104:105], 0
v_mov_b64 v[106:107], 0
v_mov_b64 v[108:109], 0
v_mov_b64 v[110:111], 0
v_mov_b64 v[112:113], 0
v_mov_b64 v[114:115], 0
v_mov_b64 v[116:117], 0
v_mov_b64 v[118:119], 0
s_mov_b32 s33, 16
s_mov_b32 s34, 0
s_mov_b32 s35, 0
v_add_u32 v16, s34, v8
v_add_u32 v17, s34, v9
v_add_u32 v18, s34, v10
v_add_u32 v19, s34, v11
v_add_u32 v12, s34, v4
v_add_u32 v13, s34, v5
s_barrier
ds_read_b64_tr_b16 v[136:137], v16 offset:0
ds_read_b64_tr_b16 v[138:139], v16 offset:3072
ds_read_b128 v[120:123], v12 offset:0
ds_read_b128 v[124:127], v12 offset:2048
ds_read_b128 v[128:131], v12 offset:4096
ds_read_b128 v[132:135], v12 offset:6144
ds_read_b64_tr_b16 v[140:141], v17 offset:0
ds_read_b64_tr_b16 v[142:143], v17 offset:3072
ds_read_b64_tr_b16 v[144:145], v18 offset:0
ds_read_b64_tr_b16 v[146:147], v18 offset:3072
ds_read_b64_tr_b16 v[148:149], v19 offset:0
ds_read_b64_tr_b16 v[150:151], v19 offset:3072
ds_read_b64_tr_b16 v[152:153], v16 offset:128
ds_read_b64_tr_b16 v[154:155], v16 offset:3200
ds_read_b64_tr_b16 v[156:157], v17 offset:128
ds_read_b64_tr_b16 v[158:159], v17 offset:3200
Lp1_loop:
s_waitcnt lgkmcnt(0)
v_mfma_f32_16x16x32_bf16 v[24:27], v[136:139], v[120:123], v[24:27]
ds_read_b64_tr_b16 v[176:177], v16 offset:12288
ds_read_b64_tr_b16 v[178:179], v16 offset:15360
v_mfma_f32_16x16x32_bf16 v[48:51], v[136:139], v[124:127], v[48:51]
ds_read_b128 v[160:163], v13 offset:0
v_mfma_f32_16x16x32_bf16 v[72:75], v[136:139], v[128:131], v[72:75]
ds_read_b128 v[164:167], v13 offset:2048
v_mfma_f32_16x16x32_bf16 v[96:99], v[136:139], v[132:135], v[96:99]
ds_read_b128 v[168:171], v13 offset:4096
v_mfma_f32_16x16x32_bf16 v[28:31], v[140:143], v[120:123], v[28:31]
ds_read_b128 v[172:175], v13 offset:6144
v_mfma_f32_16x16x32_bf16 v[52:55], v[140:143], v[124:127], v[52:55]
ds_read_b64_tr_b16 v[180:181], v17 offset:12288
v_mfma_f32_16x16x32_bf16 v[76:79], v[140:143], v[128:131], v[76:79]
ds_read_b64_tr_b16 v[182:183], v17 offset:15360
v_mfma_f32_16x16x32_bf16 v[100:103], v[140:143], v[132:135], v[100:103]
ds_read_b64_tr_b16 v[184:185], v18 offset:12288
v_mfma_f32_16x16x32_bf16 v[32:35], v[144:147], v[120:123], v[32:35]
ds_read_b64_tr_b16 v[186:187], v18 offset:15360
v_mfma_f32_16x16x32_bf16 v[56:59], v[144:147], v[124:127], v[56:59]
ds_read_b64_tr_b16 v[188:189], v19 offset:12288
v_mfma_f32_16x16x32_bf16 v[80:83], v[144:147], v[128:131], v[80:83]
ds_read_b64_tr_b16 v[190:191], v19 offset:15360
v_mfma_f32_16x16x32_bf16 v[104:107], v[144:147], v[132:135], v[104:107]
ds_read_b64_tr_b16 v[192:193], v16 offset:12416
v_mfma_f32_16x16x32_bf16 v[36:39], v[148:151], v[120:123], v[36:39]
ds_read_b64_tr_b16 v[194:195], v16 offset:15488
v_mfma_f32_16x16x32_bf16 v[60:63], v[148:151], v[124:127], v[60:63]
ds_read_b64_tr_b16 v[196:197], v17 offset:12416
v_mfma_f32_16x16x32_bf16 v[84:87], v[148:151], v[128:131], v[84:87]
ds_read_b64_tr_b16 v[198:199], v17 offset:15488
v_mfma_f32_16x16x32_bf16 v[108:111], v[148:151], v[132:135], v[108:111]
s_add_u32 s34, s34, 40960
s_cmp_eq_u32 s34, 163840
s_cselect_b32 s34, 0, s34
v_mfma_f32_16x16x32_bf16 v[40:43], v[152:155], v[120:123], v[40:43]
v_add_u32 v16, s34, v8
v_mfma_f32_16x16x32_bf16 v[64:67], v[152:155], v[124:127], v[64:67]
v_add_u32 v17, s34, v9
v_mfma_f32_16x16x32_bf16 v[88:91], v[152:155], v[128:131], v[88:91]
v_add_u32 v18, s34, v10
v_mfma_f32_16x16x32_bf16 v[112:115], v[152:155], v[132:135], v[112:115]
v_add_u32 v19, s34, v11
v_mfma_f32_16x16x32_bf16 v[44:47], v[156:159], v[120:123], v[44:47]
v_add_u32 v12, s34, v4
v_mfma_f32_16x16x32_bf16 v[68:71], v[156:159], v[124:127], v[68:71]
v_add_u32 v13, s34, v5
v_mfma_f32_16x16x32_bf16 v[92:95], v[156:159], v[128:131], v[92:95]
s_cmp_lg_u32 s33, 15
s_cbranch_scc1 Lf0
buffer_load_dwordx2 v[204:205], off, s[84:87], 0 sc1
Lf0:
v_mfma_f32_16x16x32_bf16 v[116:119], v[156:159], v[132:135], v[116:119]
s_cmp_lg_u32 s33, 11
s_cbranch_scc1 Lf1
s_waitcnt vmcnt(0)
v_readfirstlane_b32 s100, v204
v_cmp_ne_u32 vcc, 1, v205
s_nop 4
s_cbranch_vccz Lf1n_ok
s_mov_b32 s84, s58
s_mov_b32 s85, s59
s_mov_b32 s86, 256
s_mov_b32 s87, 0x00020000
Lf1n:
buffer_load_dwordx2 v[204:205], off, s[84:87], 0 sc1
s_waitcnt vmcnt(0)
v_readfirstlane_b32 s100, v204
v_cmp_ne_u32 vcc, 1, v205
s_nop 4
s_cbranch_vccz Lf1n_ok
s_sleep 4
s_branch Lf1n
Lf1n_ok:
s_lshl_b32 s3, s28, 4
s_add_u32 s3, s3, s29
s_lshl_b32 s3, s3, 3
s_add_u32 s3, s3, s30
s_lshl_b32 s3, s3, 2
s_add_u32 s3, s3, 49152
v_mov_b32 v204, s100
s_mov_b64 exec, 1
s_waitcnt vmcnt(0)
buffer_store_dword v204, off, s[96:99], s3 sc1
s_mov_b64 exec, -1
Lf1:
s_waitcnt lgkmcnt(0)
v_mfma_f32_16x16x32_bf16 v[24:27], v[176:179], v[160:163], v[24:27]
s_barrier
v_mfma_f32_16x16x32_bf16 v[48:51], v[176:179], v[164:167], v[48:51]
ds_read_b64_tr_b16 v[136:137], v16 offset:0
v_mfma_f32_16x16x32_bf16 v[72:75], v[176:179], v[168:171], v[72:75]
ds_read_b64_tr_b16 v[138:139], v16 offset:3072
v_mfma_f32_16x16x32_bf16 v[96:99], v[176:179], v[172:175], v[96:99]
ds_read_b128 v[120:123], v12 offset:0
v_mfma_f32_16x16x32_bf16 v[28:31], v[180:183], v[160:163], v[28:31]
ds_read_b128 v[124:127], v12 offset:2048
v_mfma_f32_16x16x32_bf16 v[52:55], v[180:183], v[164:167], v[52:55]
ds_read_b128 v[128:131], v12 offset:4096
v_mfma_f32_16x16x32_bf16 v[76:79], v[180:183], v[168:171], v[76:79]
ds_read_b128 v[132:135], v12 offset:6144
v_mfma_f32_16x16x32_bf16 v[100:103], v[180:183], v[172:175], v[100:103]
ds_read_b64_tr_b16 v[140:141], v17 offset:0
v_mfma_f32_16x16x32_bf16 v[32:35], v[184:187], v[160:163], v[32:35]
ds_read_b64_tr_b16 v[142:143], v17 offset:3072
v_mfma_f32_16x16x32_bf16 v[56:59], v[184:187], v[164:167], v[56:59]
ds_read_b64_tr_b16 v[144:145], v18 offset:0
v_mfma_f32_16x16x32_bf16 v[80:83], v[184:187], v[168:171], v[80:83]
ds_read_b64_tr_b16 v[146:147], v18 offset:3072
v_mfma_f32_16x16x32_bf16 v[104:107], v[184:187], v[172:175], v[104:107]
ds_read_b64_tr_b16 v[148:149], v19 offset:0
v_mfma_f32_16x16x32_bf16 v[36:39], v[188:191], v[160:163], v[36:39]
ds_read_b64_tr_b16 v[150:151], v19 offset:3072
v_mfma_f32_16x16x32_bf16 v[60:63], v[188:191], v[164:167], v[60:63]
ds_read_b64_tr_b16 v[152:153], v16 offset:128
v_mfma_f32_16x16x32_bf16 v[84:87], v[188:191], v[168:171], v[84:87]
ds_read_b64_tr_b16 v[154:155], v16 offset:3200
v_mfma_f32_16x16x32_bf16 v[108:111], v[188:191], v[172:175], v[108:111]
ds_read_b64_tr_b16 v[156:157], v17 offset:128
v_mfma_f32_16x16x32_bf16 v[40:43], v[192:195], v[160:163], v[40:43]
ds_read_b64_tr_b16 v[158:159], v17 offset:3200
v_mfma_f32_16x16x32_bf16 v[64:67], v[192:195], v[164:167], v[64:67]
s_sub_u32 s33, s33, 1
s_cmp_lg_u32 s33, 0
v_mfma_f32_16x16x32_bf16 v[88:91], v[192:195], v[168:171], v[88:91]
v_mfma_f32_16x16x32_bf16 v[112:115], v[192:195], v[172:175], v[112:115]
v_mfma_f32_16x16x32_bf16 v[44:47], v[196:199], v[160:163], v[44:47]
v_mfma_f32_16x16x32_bf16 v[68:71], v[196:199], v[164:167], v[68:71]
v_mfma_f32_16x16x32_bf16 v[92:95], v[196:199], v[168:171], v[92:95]
v_mfma_f32_16x16x32_bf16 v[116:119], v[196:199], v[172:175], v[116:119]
s_cbranch_scc1 Lp1_loop
s_waitcnt lgkmcnt(0)
s_nop 7
s_lshl_b32 s3, s29, 18
s_lshl_b32 s4, s28, 13
s_add_u32 s3, s3, s4
s_lshl_b32 s7, s62, 12
s_add_u32 s3, s3, s7
v_bfe_u32 v20, v2, 2, 2
v_lshlrev_b32 v20, 4, v20
s_mul_i32 s4, s63, 3
s_add_u32 s4, s4, 0
s_lshr_b32 s5, s4, 1
s_lshl_b32 s5, s5, 22
s_and_b32 s4, s4, 1
s_lshl_b32 s4, s4, 17
s_add_u32 s4, s4, s5
s_add_u32 s64, s3, s4
s_mov_b32 s4, 65536
s_cmp_eq_u32 s63, 0
s_cselect_b32 s4, 98304, s4
s_cselect_b32 s5, 48, 48
s_add_u32 s4, s4, s7
v_and_b32 v120, s5, v20
v_xor_b32 v120, v120, v200
v_add_u32 v120, s4, v120
s_mul_i32 s4, s63, 3
s_add_u32 s4, s4, 1
s_lshr_b32 s5, s4, 1
s_lshl_b32 s5, s5, 22
s_and_b32 s4, s4, 1
s_lshl_b32 s4, s4, 17
s_add_u32 s4, s4, s5
s_add_u32 s65, s3, s4
s_mov_b32 s4, 40960
s_cmp_eq_u32 s63, 0
s_cselect_b32 s4, 106496, s4
s_cselect_b32 s5, 48, 0
s_add_u32 s4, s4, s7
v_and_b32 v121, s5, v20
v_xor_b32 v121, v121, v200
v_add_u32 v121, s4, v121
s_mul_i32 s4, s63, 3
s_add_u32 s4, s4, 2
s_lshr_b32 s5, s4, 1
s_lshl_b32 s5, s5, 22
s_and_b32 s4, s4, 1
s_lshl_b32 s4, s4, 17
s_add_u32 s4, s4, s5
s_add_u32 s66, s3, s4
s_mov_b32 s4, 90112
s_cmp_eq_u32 s63, 0
s_cselect_b32 s4, 16384, s4
s_cselect_b32 s5, 48, 0
s_add_u32 s4, s4, s7
v_and_b32 v122, s5, v20
v_xor_b32 v122, v122, v200
v_add_u32 v122, s4, v122
ds_read_b128 v[160:163], v202 offset:0
ds_read_b128 v[164:167], v202 offset:16
ds_read_b128 v[168:171], v202 offset:128
ds_read_b128 v[172:175], v202 offset:144
ds_read_b128 v[176:179], v202 offset:256
ds_read_b128 v[180:183], v202 offset:272
ds_read_b64 v[184:185], v203 offset:0
ds_read_b64 v[186:187], v203 offset:128
ds_read_b64 v[188:189], v203 offset:256
ds_read_b64 v[190:191], v203 offset:384
v_permlane16_swap_b32 v24, v28
v_permlane16_swap_b32 v25, v29
v_permlane16_swap_b32 v26, v30
v_permlane16_swap_b32 v27, v31
v_permlane16_swap_b32 v32, v36
v_permlane16_swap_b32 v33, v37
v_permlane16_swap_b32 v34, v38
v_permlane16_swap_b32 v35, v39
v_permlane16_swap_b32 v40, v44
v_permlane16_swap_b32 v41, v45
v_permlane16_swap_b32 v42, v46
v_permlane16_swap_b32 v43, v47
s_nop 1
v_permlane16_swap_b32 v48, v52
v_permlane16_swap_b32 v49, v53
v_permlane16_swap_b32 v50, v54
v_permlane16_swap_b32 v51, v55
v_permlane16_swap_b32 v56, v60
v_permlane16_swap_b32 v57, v61
v_permlane16_swap_b32 v58, v62
v_permlane16_swap_b32 v59, v63
v_permlane16_swap_b32 v64, v68
v_permlane16_swap_b32 v65, v69
v_permlane16_swap_b32 v66, v70
v_permlane16_swap_b32 v67, v71
s_nop 1
v_permlane16_swap_b32 v72, v76
v_permlane16_swap_b32 v73, v77
v_permlane16_swap_b32 v74, v78
v_permlane16_swap_b32 v75, v79
v_permlane16_swap_b32 v80, v84
v_permlane16_swap_b32 v81, v85
v_permlane16_swap_b32 v82, v86
v_permlane16_swap_b32 v83, v87
v_permlane16_swap_b32 v88, v92
v_permlane16_swap_b32 v89, v93
v_permlane16_swap_b32 v90, v94
v_permlane16_swap_b32 v91, v95
s_nop 1
v_permlane16_swap_b32 v96, v100
v_permlane16_swap_b32 v97, v101
v_permlane16_swap_b32 v98, v102
v_permlane16_swap_b32 v99, v103
v_permlane16_swap_b32 v104, v108
v_permlane16_swap_b32 v105, v109
v_permlane16_swap_b32 v106, v110
v_permlane16_swap_b32 v107, v111
v_permlane16_swap_b32 v112, v116
v_permlane16_swap_b32 v113, v117
v_permlane16_swap_b32 v114, v118
v_permlane16_swap_b32 v115, v119
s_nop 1
s_waitcnt lgkmcnt(0)
v_pk_mul_f32 v[40:41], v[40:41], v[184:185] op_sel_hi:[1,0]
v_pk_mul_f32 v[42:43], v[42:43], v[184:185] op_sel_hi:[1,0]
v_pk_mul_f32 v[44:45], v[44:45], v[184:185] op_sel_hi:[1,0]
v_pk_mul_f32 v[46:47], v[46:47], v[184:185] op_sel_hi:[1,0]
v_pk_fma_f32 v[40:41], v[176:177], v[184:185], v[40:41] op_sel:[0,1,0] op_sel_hi:[1,1,1]
v_pk_fma_f32 v[42:43], v[178:179], v[184:185], v[42:43] op_sel:[0,1,0] op_sel_hi:[1,1,1]
v_pk_fma_f32 v[44:45], v[180:181], v[184:185], v[44:45] op_sel:[0,1,0] op_sel_hi:[1,1,1]
v_pk_fma_f32 v[46:47], v[182:183], v[184:185], v[46:47] op_sel:[0,1,0] op_sel_hi:[1,1,1]
v_cvt_pk_bf16_f32 v40, v40, v41
v_cvt_pk_bf16_f32 v41, v42, v43
v_cvt_pk_bf16_f32 v42, v44, v45
v_cvt_pk_bf16_f32 v43, v46, v47
v_pk_mul_f32 v[64:65], v[64:65], v[186:187] op_sel_hi:[1,0]
v_pk_mul_f32 v[66:67], v[66:67], v[186:187] op_sel_hi:[1,0]
v_pk_mul_f32 v[68:69], v[68:69], v[186:187] op_sel_hi:[1,0]
v_pk_mul_f32 v[70:71], v[70:71], v[186:187] op_sel_hi:[1,0]
v_pk_fma_f32 v[64:65], v[176:177], v[186:187], v[64:65] op_sel:[0,1,0] op_sel_hi:[1,1,1]
v_pk_fma_f32 v[66:67], v[178:179], v[186:187], v[66:67] op_sel:[0,1,0] op_sel_hi:[1,1,1]
v_pk_fma_f32 v[68:69], v[180:181], v[186:187], v[68:69] op_sel:[0,1,0] op_sel_hi:[1,1,1]
v_pk_fma_f32 v[70:71], v[182:183], v[186:187], v[70:71] op_sel:[0,1,0] op_sel_hi:[1,1,1]
v_cvt_pk_bf16_f32 v64, v64, v65
v_cvt_pk_bf16_f32 v65, v66, v67
v_cvt_pk_bf16_f32 v66, v68, v69
v_cvt_pk_bf16_f32 v67, v70, v71
v_pk_mul_f32 v[88:89], v[88:89], v[188:189] op_sel_hi:[1,0]
v_pk_mul_f32 v[90:91], v[90:91], v[188:189] op_sel_hi:[1,0]
v_pk_mul_f32 v[92:93], v[92:93], v[188:189] op_sel_hi:[1,0]
v_pk_mul_f32 v[94:95], v[94:95], v[188:189] op_sel_hi:[1,0]
v_pk_fma_f32 v[88:89], v[176:177], v[188:189], v[88:89] op_sel:[0,1,0] op_sel_hi:[1,1,1]
v_pk_fma_f32 v[90:91], v[178:179], v[188:189], v[90:91] op_sel:[0,1,0] op_sel_hi:[1,1,1]
v_pk_fma_f32 v[92:93], v[180:181], v[188:189], v[92:93] op_sel:[0,1,0] op_sel_hi:[1,1,1]
v_pk_fma_f32 v[94:95], v[182:183], v[188:189], v[94:95] op_sel:[0,1,0] op_sel_hi:[1,1,1]
v_cvt_pk_bf16_f32 v88, v88, v89
v_cvt_pk_bf16_f32 v89, v90, v91
v_cvt_pk_bf16_f32 v90, v92, v93
v_cvt_pk_bf16_f32 v91, v94, v95
v_pk_mul_f32 v[112:113], v[112:113], v[190:191] op_sel_hi:[1,0]
v_pk_mul_f32 v[114:115], v[114:115], v[190:191] op_sel_hi:[1,0]
v_pk_mul_f32 v[116:117], v[116:117], v[190:191] op_sel_hi:[1,0]
v_pk_mul_f32 v[118:119], v[118:119], v[190:191] op_sel_hi:[1,0]
v_pk_fma_f32 v[112:113], v[176:177], v[190:191], v[112:113] op_sel:[0,1,0] op_sel_hi:[1,1,1]
v_pk_fma_f32 v[114:115], v[178:179], v[190:191], v[114:115] op_sel:[0,1,0] op_sel_hi:[1,1,1]
v_pk_fma_f32 v[116:117], v[180:181], v[190:191], v[116:117] op_sel:[0,1,0] op_sel_hi:[1,1,1]
v_pk_fma_f32 v[118:119], v[182:183], v[190:191], v[118:119] op_sel:[0,1,0] op_sel_hi:[1,1,1]
v_cvt_pk_bf16_f32 v112, v112, v113
v_cvt_pk_bf16_f32 v113, v114, v115
v_cvt_pk_bf16_f32 v114, v116, v117
v_cvt_pk_bf16_f32 v115, v118, v119
buffer_store_dwordx4 v[40:43], v200, s[16:19], s66 offen offset:0 sc1
buffer_store_dwordx4 v[64:67], v200, s[16:19], s66 offen offset:1024 sc1
buffer_store_dwordx4 v[88:91], v200, s[16:19], s66 offen offset:2048 sc1
buffer_store_dwordx4 v[112:115], v200, s[16:19], s66 offen offset:3072 sc1
Lk1_ns2:
v_pk_mul_f32 v[24:25], v[24:25], v[184:185] op_sel_hi:[1,0]
v_pk_mul_f32 v[26:27], v[26:27], v[184:185] op_sel_hi:[1,0]
v_pk_mul_f32 v[28:29], v[28:29], v[184:185] op_sel_hi:[1,0]
v_pk_mul_f32 v[30:31], v[30:31], v[184:185] op_sel_hi:[1,0]
v_pk_fma_f32 v[24:25], v[160:161], v[184:185], v[24:25] op_sel:[0,1,0] op_sel_hi:[1,1,1]
v_pk_fma_f32 v[26:27], v[162:163], v[184:185], v[26:27] op_sel:[0,1,0] op_sel_hi:[1,1,1]
v_pk_fma_f32 v[28:29], v[164:165], v[184:185], v[28:29] op_sel:[0,1,0] op_sel_hi:[1,1,1]
v_pk_fma_f32 v[30:31], v[166:167], v[184:185], v[30:31] op_sel:[0,1,0] op_sel_hi:[1,1,1]
v_cvt_pk_bf16_f32 v24, v24, v25
v_cvt_pk_bf16_f32 v25, v26, v27
v_cvt_pk_bf16_f32 v26, v28, v29
v_cvt_pk_bf16_f32 v27, v30, v31
v_pk_mul_f32 v[48:49], v[48:49], v[186:187] op_sel_hi:[1,0]
v_pk_mul_f32 v[50:51], v[50:51], v[186:187] op_sel_hi:[1,0]
v_pk_mul_f32 v[52:53], v[52:53], v[186:187] op_sel_hi:[1,0]
v_pk_mul_f32 v[54:55], v[54:55], v[186:187] op_sel_hi:[1,0]
v_pk_fma_f32 v[48:49], v[160:161], v[186:187], v[48:49] op_sel:[0,1,0] op_sel_hi:[1,1,1]
v_pk_fma_f32 v[50:51], v[162:163], v[186:187], v[50:51] op_sel:[0,1,0] op_sel_hi:[1,1,1]
v_pk_fma_f32 v[52:53], v[164:165], v[186:187], v[52:53] op_sel:[0,1,0] op_sel_hi:[1,1,1]
v_pk_fma_f32 v[54:55], v[166:167], v[186:187], v[54:55] op_sel:[0,1,0] op_sel_hi:[1,1,1]
v_cvt_pk_bf16_f32 v48, v48, v49
v_cvt_pk_bf16_f32 v49, v50, v51
v_cvt_pk_bf16_f32 v50, v52, v53
v_cvt_pk_bf16_f32 v51, v54, v55
v_pk_mul_f32 v[72:73], v[72:73], v[188:189] op_sel_hi:[1,0]
v_pk_mul_f32 v[74:75], v[74:75], v[188:189] op_sel_hi:[1,0]
v_pk_mul_f32 v[76:77], v[76:77], v[188:189] op_sel_hi:[1,0]
v_pk_mul_f32 v[78:79], v[78:79], v[188:189] op_sel_hi:[1,0]
v_pk_fma_f32 v[72:73], v[160:161], v[188:189], v[72:73] op_sel:[0,1,0] op_sel_hi:[1,1,1]
v_pk_fma_f32 v[74:75], v[162:163], v[188:189], v[74:75] op_sel:[0,1,0] op_sel_hi:[1,1,1]
v_pk_fma_f32 v[76:77], v[164:165], v[188:189], v[76:77] op_sel:[0,1,0] op_sel_hi:[1,1,1]
v_pk_fma_f32 v[78:79], v[166:167], v[188:189], v[78:79] op_sel:[0,1,0] op_sel_hi:[1,1,1]
v_cvt_pk_bf16_f32 v72, v72, v73
v_cvt_pk_bf16_f32 v73, v74, v75
v_cvt_pk_bf16_f32 v74, v76, v77
v_cvt_pk_bf16_f32 v75, v78, v79
v_pk_mul_f32 v[96:97], v[96:97], v[190:191] op_sel_hi:[1,0]
v_pk_mul_f32 v[98:99], v[98:99], v[190:191] op_sel_hi:[1,0]
v_pk_mul_f32 v[100:101], v[100:101], v[190:191] op_sel_hi:[1,0]
v_pk_mul_f32 v[102:103], v[102:103], v[190:191] op_sel_hi:[1,0]
v_pk_fma_f32 v[96:97], v[160:161], v[190:191], v[96:97] op_sel:[0,1,0] op_sel_hi:[1,1,1]
v_pk_fma_f32 v[98:99], v[162:163], v[190:191], v[98:99] op_sel:[0,1,0] op_sel_hi:[1,1,1]
v_pk_fma_f32 v[100:101], v[164:165], v[190:191], v[100:101] op_sel:[0,1,0] op_sel_hi:[1,1,1]
v_pk_fma_f32 v[102:103], v[166:167], v[190:191], v[102:103] op_sel:[0,1,0] op_sel_hi:[1,1,1]
v_cvt_pk_bf16_f32 v96, v96, v97
v_cvt_pk_bf16_f32 v97, v98, v99
v_cvt_pk_bf16_f32 v98, v100, v101
v_cvt_pk_bf16_f32 v99, v102, v103
s_cmp_eq_u32 s63, 0
s_cbranch_scc1 Lk1_ns0
buffer_store_dwordx4 v[24:27], v200, s[16:19], s64 offen offset:0 sc1
buffer_store_dwordx4 v[48:51], v200, s[16:19], s64 offen offset:1024 sc1
buffer_store_dwordx4 v[72:75], v200, s[16:19], s64 offen offset:2048 sc1
buffer_store_dwordx4 v[96:99], v200, s[16:19], s64 offen offset:3072 sc1
Lk1_ns0:
v_pk_mul_f32 v[32:33], v[32:33], v[184:185] op_sel_hi:[1,0]
v_pk_mul_f32 v[34:35], v[34:35], v[184:185] op_sel_hi:[1,0]
v_pk_mul_f32 v[36:37], v[36:37], v[184:185] op_sel_hi:[1,0]
v_pk_mul_f32 v[38:39], v[38:39], v[184:185] op_sel_hi:[1,0]
v_pk_fma_f32 v[32:33], v[168:169], v[184:185], v[32:33] op_sel:[0,1,0] op_sel_hi:[1,1,1]
v_pk_fma_f32 v[34:35], v[170:171], v[184:185], v[34:35] op_sel:[0,1,0] op_sel_hi:[1,1,1]
v_pk_fma_f32 v[36:37], v[172:173], v[184:185], v[36:37] op_sel:[0,1,0] op_sel_hi:[1,1,1]
v_pk_fma_f32 v[38:39], v[174:175], v[184:185], v[38:39] op_sel:[0,1,0] op_sel_hi:[1,1,1]
v_cvt_pk_bf16_f32 v32, v32, v33
v_cvt_pk_bf16_f32 v33, v34, v35
v_cvt_pk_bf16_f32 v34, v36, v37
v_cvt_pk_bf16_f32 v35, v38, v39
v_pk_mul_f32 v[56:57], v[56:57], v[186:187] op_sel_hi:[1,0]
v_pk_mul_f32 v[58:59], v[58:59], v[186:187] op_sel_hi:[1,0]
v_pk_mul_f32 v[60:61], v[60:61], v[186:187] op_sel_hi:[1,0]
v_pk_mul_f32 v[62:63], v[62:63], v[186:187] op_sel_hi:[1,0]
v_pk_fma_f32 v[56:57], v[168:169], v[186:187], v[56:57] op_sel:[0,1,0] op_sel_hi:[1,1,1]
v_pk_fma_f32 v[58:59], v[170:171], v[186:187], v[58:59] op_sel:[0,1,0] op_sel_hi:[1,1,1]
v_pk_fma_f32 v[60:61], v[172:173], v[186:187], v[60:61] op_sel:[0,1,0] op_sel_hi:[1,1,1]
v_pk_fma_f32 v[62:63], v[174:175], v[186:187], v[62:63] op_sel:[0,1,0] op_sel_hi:[1,1,1]
v_cvt_pk_bf16_f32 v56, v56, v57
v_cvt_pk_bf16_f32 v57, v58, v59
v_cvt_pk_bf16_f32 v58, v60, v61
v_cvt_pk_bf16_f32 v59, v62, v63
v_pk_mul_f32 v[80:81], v[80:81], v[188:189] op_sel_hi:[1,0]
v_pk_mul_f32 v[82:83], v[82:83], v[188:189] op_sel_hi:[1,0]
v_pk_mul_f32 v[84:85], v[84:85], v[188:189] op_sel_hi:[1,0]
v_pk_mul_f32 v[86:87], v[86:87], v[188:189] op_sel_hi:[1,0]
v_pk_fma_f32 v[80:81], v[168:169], v[188:189], v[80:81] op_sel:[0,1,0] op_sel_hi:[1,1,1]
v_pk_fma_f32 v[82:83], v[170:171], v[188:189], v[82:83] op_sel:[0,1,0] op_sel_hi:[1,1,1]
v_pk_fma_f32 v[84:85], v[172:173], v[188:189], v[84:85] op_sel:[0,1,0] op_sel_hi:[1,1,1]
v_pk_fma_f32 v[86:87], v[174:175], v[188:189], v[86:87] op_sel:[0,1,0] op_sel_hi:[1,1,1]
v_cvt_pk_bf16_f32 v80, v80, v81
v_cvt_pk_bf16_f32 v81, v82, v83
v_cvt_pk_bf16_f32 v82, v84, v85
v_cvt_pk_bf16_f32 v83, v86, v87
v_pk_mul_f32 v[104:105], v[104:105], v[190:191] op_sel_hi:[1,0]
v_pk_mul_f32 v[106:107], v[106:107], v[190:191] op_sel_hi:[1,0]
v_pk_mul_f32 v[108:109], v[108:109], v[190:191] op_sel_hi:[1,0]
v_pk_mul_f32 v[110:111], v[110:111], v[190:191] op_sel_hi:[1,0]
v_pk_fma_f32 v[104:105], v[168:169], v[190:191], v[104:105] op_sel:[0,1,0] op_sel_hi:[1,1,1]
v_pk_fma_f32 v[106:107], v[170:171], v[190:191], v[106:107] op_sel:[0,1,0] op_sel_hi:[1,1,1]
v_pk_fma_f32 v[108:109], v[172:173], v[190:191], v[108:109] op_sel:[0,1,0] op_sel_hi:[1,1,1]
v_pk_fma_f32 v[110:111], v[174:175], v[190:191], v[110:111] op_sel:[0,1,0] op_sel_hi:[1,1,1]
v_cvt_pk_bf16_f32 v104, v104, v105
v_cvt_pk_bf16_f32 v105, v106, v107
v_cvt_pk_bf16_f32 v106, v108, v109
v_cvt_pk_bf16_f32 v107, v110, v111
s_cmp_eq_u32 s63, 0
s_cbranch_scc1 Lk1_ns1
buffer_store_dwordx4 v[32:35], v200, s[16:19], s65 offen offset:0 sc1
buffer_store_dwordx4 v[56:59], v200, s[16:19], s65 offen offset:1024 sc1
buffer_store_dwordx4 v[80:83], v200, s[16:19], s65 offen offset:2048 sc1
buffer_store_dwordx4 v[104:107], v200, s[16:19], s65 offen offset:3072 sc1
Lk1_ns1:
ds_write_b128 v120, v[24:27] offset:0
ds_write_b128 v120, v[48:51] offset:1024
ds_write_b128 v120, v[72:75] offset:2048
ds_write_b128 v120, v[96:99] offset:3072
ds_write_b128 v121, v[32:35] offset:0
ds_write_b128 v121, v[56:59] offset:1024
ds_write_b128 v121, v[80:83] offset:2048
ds_write_b128 v121, v[104:107] offset:3072
ds_write_b128 v122, v[40:43] offset:0
ds_write_b128 v122, v[64:67] offset:1024
ds_write_b128 v122, v[88:91] offset:2048
ds_write_b128 v122, v[112:115] offset:3072
s_lshl_b32 s3, s28, 4
s_add_u32 s3, s3, s29
s_lshl_b32 s3, s3, 3
s_add_u32 s3, s3, s30
s_lshl_b32 s3, s3, 2
s_add_u32 s3, s3, 8192
v_mov_b32 v20, s100
s_mov_b64 exec, 1
s_waitcnt vmcnt(0)
buffer_store_dword v20, off, s[96:99], s3 sc1
s_mov_b64 exec, -1
s_branch Latt
Lld1:
s_setprio 1
v_lshlrev_b32 v32, 7, v1
s_lshl_b32 s3, s2, 8
s_cmp_lg_u32 s30, 1
s_cbranch_scc1 Lft
s_mov_b64 exec, 3
buffer_load_dword v0, v32, s[96:99], s3 offen sc1
s_mov_b64 exec, -1
Lft:
s_mov_b32 s84, s58
s_mov_b32 s85, s59
s_mov_b32 s86, 256
s_mov_b32 s87, 0x00020000
s_add_u32 s3, s2, s30
s_cmp_lg_u32 s3, 0
s_cbranch_scc1 Lnonce
s_mov_b32 s3, 65532
s_mov_b64 exec, 1
buffer_load_dword v32, off, s[96:99], s3 sc1
s_mov_b64 exec, -1
Lnonce:
s_and_b32 s3, s2, 7
s_lshr_b32 s4, s2, 3
s_and_b32 s28, s3, 1
s_lshl_b32 s28, s28, 3
s_and_b32 s5, s4, 7
s_add_u32 s28, s28, s5
s_lshr_b32 s29, s3, 1
s_lshl_b32 s29, s29, 2
s_lshr_b32 s5, s4, 3
s_add_u32 s29, s29, s5
s_lshl_b32 s5, s30, 5
v_lshrrev_b32 v24, 3, v1
v_add_u32 v24, s5, v24
s_mov_b32 s6, 2048
v_mul_lo_u32 v24, v24, s6
v_and_b32 v25, 7, v1
v_xor_b32 v25, v25, v3
v_lshlrev_b32 v25, 4, v25
v_xor_b32 v26, 0, v25
v_add_u32 v26, v24, v26
v_add_u32 v4, 0, v26
v_xor_b32 v26, 64, v25
v_add_u32 v26, v24, v26
v_add_u32 v5, 16384, v26
v_xor_b32 v26, 0, v25
v_add_u32 v26, v24, v26
v_add_u32 v6, 32768, v26
v_xor_b32 v26, 64, v25
v_add_u32 v26, v24, v26
v_add_u32 v7, 49152, v26
s_and_b32 s7, s29, 1
s_mul_i32 s35, s7, 14
s_lshl_b32 s7, s7, 1
s_lshl_b32 s5, s30, 6
s_mov_b32 s6, 6144
v_add_u32 v24, s5, v1
v_add_u32 v24, 0, v24
v_mul_u32_u24 v25, 43691, v24
v_lshrrev_b32 v25, 20, v25
v_mul_u32_u24 v26, 24, v25
v_sub_u32 v26, v24, v26
v_bfe_u32 v27, v25, 1, 2
v_lshlrev_b32 v27, 1, v27
v_xor_b32 v26, v26, v27
v_and_b32 v27, 0x33, v25
v_bfe_u32 v28, v25, 2, 1
v_lshl_or_b32 v27, v28, 3, v27
v_bfe_u32 v28, v25, 3, 1
v_lshl_or_b32 v27, v28, 2, v27
v_mul_lo_u32 v27, v27, s6
v_lshrrev_b32 v28, 3, v26
v_lshl_add_u32 v27, v28, 11, v27
v_and_b32 v26, 7, v26
v_lshl_add_u32 v16, v26, 4, v27
v_add_u32 v24, s5, v1
v_add_u32 v24, 256, v24
v_mul_u32_u24 v25, 43691, v24
v_lshrrev_b32 v25, 20, v25
v_mul_u32_u24 v26, 24, v25
v_sub_u32 v26, v24, v26
v_bfe_u32 v27, v25, 1, 2
v_lshlrev_b32 v27, 1, v27
v_xor_b32 v26, v26, v27
v_and_b32 v27, 0x33, v25
v_bfe_u32 v28, v25, 2, 1
v_lshl_or_b32 v27, v28, 3, v27
v_bfe_u32 v28, v25, 3, 1
v_lshl_or_b32 v27, v28, 2, v27
v_mul_lo_u32 v27, v27, s6
v_lshrrev_b32 v28, 3, v26
v_lshl_add_u32 v27, v28, 11, v27
v_and_b32 v26, 7, v26
v_lshl_add_u32 v17, v26, 4, v27
v_add_u32 v24, s5, v1
v_add_u32 v24, 512, v24
v_mul_u32_u24 v25, 43691, v24
v_lshrrev_b32 v25, 20, v25
v_mul_u32_u24 v26, 24, v25
v_sub_u32 v26, v24, v26
v_bfe_u32 v27, v25, 1, 2
v_lshlrev_b32 v27, 1, v27
v_xor_b32 v26, v26, v27
v_and_b32 v27, 0x33, v25
v_bfe_u32 v28, v25, 2, 1
v_lshl_or_b32 v27, v28, 3, v27
v_bfe_u32 v28, v25, 3, 1
v_lshl_or_b32 v27, v28, 2, v27
v_mul_lo_u32 v27, v27, s6
v_lshrrev_b32 v28, 3, v26
v_lshl_add_u32 v27, v28, 11, v27
v_and_b32 v26, 7, v26
v_lshl_add_u32 v18, v26, 4, v27
v_add_u32 v24, s5, v1
v_add_u32 v24, 768, v24
v_mul_u32_u24 v25, 43691, v24
v_lshrrev_b32 v25, 20, v25
v_mul_u32_u24 v26, 24, v25
v_sub_u32 v26, v24, v26
v_bfe_u32 v27, v25, 1, 2
v_lshlrev_b32 v27, 1, v27
v_xor_b32 v26, v26, v27
v_and_b32 v27, 0x33, v25
v_bfe_u32 v28, v25, 2, 1
v_lshl_or_b32 v27, v28, 3, v27
v_bfe_u32 v28, v25, 3, 1
v_lshl_or_b32 v27, v28, 2, v27
v_mul_lo_u32 v27, v27, s6
v_lshrrev_b32 v28, 3, v26
v_lshl_add_u32 v27, v28, 11, v27
v_and_b32 v26, 7, v26
v_lshl_add_u32 v19, v26, 4, v27
v_add_u32 v24, s5, v1
v_add_u32 v24, 1024, v24
v_mul_u32_u24 v25, 43691, v24
v_lshrrev_b32 v25, 20, v25
v_mul_u32_u24 v26, 24, v25
v_sub_u32 v26, v24, v26
v_bfe_u32 v27, v25, 1, 2
v_lshlrev_b32 v27, 1, v27
v_xor_b32 v26, v26, v27
v_and_b32 v27, 0x33, v25
v_bfe_u32 v28, v25, 2, 1
v_lshl_or_b32 v27, v28, 3, v27
v_bfe_u32 v28, v25, 3, 1
v_lshl_or_b32 v27, v28, 2, v27
v_mul_lo_u32 v27, v27, s6
v_lshrrev_b32 v28, 3, v26
v_lshl_add_u32 v27, v28, 11, v27
v_and_b32 v26, 7, v26
v_lshl_add_u32 v20, v26, 4, v27
v_add_u32 v24, s5, v1
v_add_u32 v24, 1280, v24
v_mul_u32_u24 v25, 43691, v24
v_lshrrev_b32 v25, 20, v25
v_mul_u32_u24 v26, 24, v25
v_sub_u32 v26, v24, v26
v_bfe_u32 v27, v25, 1, 2
v_lshlrev_b32 v27, 1, v27
v_xor_b32 v26, v26, v27
v_and_b32 v27, 0x33, v25
v_bfe_u32 v28, v25, 2, 1
v_lshl_or_b32 v27, v28, 3, v27
v_bfe_u32 v28, v25, 3, 1
v_lshl_or_b32 v27, v28, 2, v27
v_mul_lo_u32 v27, v27, s6
v_lshrrev_b32 v28, 3, v26
v_lshl_add_u32 v27, v28, 11, v27
v_and_b32 v26, 7, v26
v_lshl_add_u32 v21, v26, 4, v27
s_mov_b32 s8, s40
s_mov_b32 s9, s41
s_mov_b32 s10, 4194304
s_mov_b32 s11, 0x00020000
s_mov_b32 s12, s42
s_mov_b32 s13, s43
s_mov_b32 s14, 6291456
s_mov_b32 s15, 0x00020000
s_mul_i32 s31, s28, 262144
s_lshr_b32 s32, s29, 0
s_mul_i32 s32, s32, 128
s_lshl_b32 s36, s30, 12
s_lshl_b32 s37, s30, 10
s_add_u32 s37, s37, 16384
s_mov_b32 s35, s32
s_add_u32 s38, s36, 0
s_add_u32 m0, s38, 0
s_nop 0
buffer_load_dwordx4 v4, s[8:11], s31 offen lds
s_add_u32 m0, s38, 1024
s_nop 0
buffer_load_dwordx4 v5, s[8:11], s31 offen lds
s_add_u32 m0, s38, 2048
s_nop 0
buffer_load_dwordx4 v6, s[8:11], s31 offen lds
s_add_u32 m0, s38, 3072
s_nop 0
buffer_load_dwordx4 v7, s[8:11], s31 offen lds
s_add_u32 s31, s31, 128
s_add_u32 s39, s37, 0
s_add_u32 m0, s39, 0
s_nop 0
buffer_load_dwordx4 v16, s[12:15], s32 offen lds
s_add_u32 m0, s39, 4096
s_nop 0
buffer_load_dwordx4 v17, s[12:15], s32 offen lds
s_add_u32 m0, s39, 8192
s_nop 0
buffer_load_dwordx4 v18, s[12:15], s32 offen lds
s_add_u32 m0, s39, 12288
s_nop 0
buffer_load_dwordx4 v19, s[12:15], s32 offen lds
s_add_u32 m0, s39, 16384
s_nop 0
buffer_load_dwordx4 v20, s[12:15], s32 offen lds
s_add_u32 m0, s39, 20480
s_nop 0
buffer_load_dwordx4 v21, s[12:15], s32 offen lds
s_add_u32 s32, s32, 393216
s_add_u32 s38, s36, 40960
s_add_u32 m0, s38, 0
s_nop 0
buffer_load_dwordx4 v4, s[8:11], s31 offen lds
s_add_u32 m0, s38, 1024
s_nop 0
buffer_load_dwordx4 v5, s[8:11], s31 offen lds
s_add_u32 m0, s38, 2048
s_nop 0
buffer_load_dwordx4 v6, s[8:11], s31 offen lds
s_add_u32 m0, s38, 3072
s_nop 0
buffer_load_dwordx4 v7, s[8:11], s31 offen lds
s_add_u32 s31, s31, 128
s_add_u32 s39, s37, 40960
s_add_u32 m0, s39, 0
s_nop 0
buffer_load_dwordx4 v16, s[12:15], s32 offen lds
s_add_u32 m0, s39, 4096
s_nop 0
buffer_load_dwordx4 v17, s[12:15], s32 offen lds
s_add_u32 m0, s39, 8192
s_nop 0
buffer_load_dwordx4 v18, s[12:15], s32 offen lds
s_add_u32 m0, s39, 12288
s_nop 0
buffer_load_dwordx4 v19, s[12:15], s32 offen lds
s_add_u32 m0, s39, 16384
s_nop 0
buffer_load_dwordx4 v20, s[12:15], s32 offen lds
s_add_u32 m0, s39, 20480
s_nop 0
buffer_load_dwordx4 v21, s[12:15], s32 offen lds
s_add_u32 s32, s32, 393216
s_add_u32 s38, s36, 81920
s_add_u32 m0, s38, 0
s_nop 0
buffer_load_dwordx4 v4, s[8:11], s31 offen lds
s_add_u32 m0, s38, 1024
s_nop 0
buffer_load_dwordx4 v5, s[8:11], s31 offen lds
s_add_u32 m0, s38, 2048
s_nop 0
buffer_load_dwordx4 v6, s[8:11], s31 offen lds
s_add_u32 m0, s38, 3072
s_nop 0
buffer_load_dwordx4 v7, s[8:11], s31 offen lds
s_add_u32 s31, s31, 128
s_add_u32 s39, s37, 81920
s_add_u32 m0, s39, 0
s_nop 0
buffer_load_dwordx4 v16, s[12:15], s32 offen lds
s_add_u32 m0, s39, 4096
s_nop 0
buffer_load_dwordx4 v17, s[12:15], s32 offen lds
s_add_u32 m0, s39, 8192
s_nop 0
buffer_load_dwordx4 v18, s[12:15], s32 offen lds
s_add_u32 m0, s39, 12288
s_nop 0
buffer_load_dwordx4 v19, s[12:15], s32 offen lds
s_add_u32 m0, s39, 16384
s_nop 0
buffer_load_dwordx4 v20, s[12:15], s32 offen lds
s_add_u32 m0, s39, 20480
s_nop 0
buffer_load_dwordx4 v21, s[12:15], s32 offen lds
s_add_u32 s32, s32, 393216
s_add_u32 s3, s2, s30
s_cmp_lg_u32 s3, 0
s_cbranch_scc1 Lnonce2
s_mov_b32 s3, 65532
s_mov_b64 exec, 1
v_mov_b32 v33, 1
s_waitcnt vmcnt(30)
v_add_u32 v32, 1, v32
buffer_store_dword v32, off, s[96:99], s3 sc1
buffer_store_dwordx2 v[32:33], off, s[84:87], 0 sc1
s_mov_b64 exec, -1
Lnonce2:
s_waitcnt vmcnt(20)
s_barrier
s_add_u32 s38, s36, 122880
s_add_u32 m0, s38, 0
s_nop 0
buffer_load_dwordx4 v4, s[8:11], s31 offen lds
s_add_u32 m0, s38, 1024
s_nop 0
buffer_load_dwordx4 v5, s[8:11], s31 offen lds
s_add_u32 m0, s38, 2048
s_nop 0
buffer_load_dwordx4 v6, s[8:11], s31 offen lds
s_add_u32 m0, s38, 3072
s_nop 0
buffer_load_dwordx4 v7, s[8:11], s31 offen lds
s_add_u32 s31, s31, 128
s_add_u32 s39, s37, 122880
s_add_u32 m0, s39, 0
s_nop 0
buffer_load_dwordx4 v16, s[12:15], s32 offen lds
s_add_u32 m0, s39, 4096
s_nop 0
buffer_load_dwordx4 v17, s[12:15], s32 offen lds
s_add_u32 m0, s39, 8192
s_nop 0
buffer_load_dwordx4 v18, s[12:15], s32 offen lds
s_add_u32 m0, s39, 12288
s_nop 0
buffer_load_dwordx4 v19, s[12:15], s32 offen lds
s_add_u32 m0, s39, 16384
s_nop 0
buffer_load_dwordx4 v20, s[12:15], s32 offen lds
s_add_u32 m0, s39, 20480
s_nop 0
buffer_load_dwordx4 v21, s[12:15], s32 offen lds
s_add_u32 s32, s32, 393216
s_waitcnt vmcnt(20)
s_barrier
s_add_u32 s38, s36, 0
s_add_u32 m0, s38, 0
s_nop 0
buffer_load_dwordx4 v4, s[8:11], s31 offen lds
s_add_u32 m0, s38, 1024
s_nop 0
buffer_load_dwordx4 v5, s[8:11], s31 offen lds
s_add_u32 m0, s38, 2048
s_nop 0
buffer_load_dwordx4 v6, s[8:11], s31 offen lds
s_add_u32 m0, s38, 3072
s_nop 0
buffer_load_dwordx4 v7, s[8:11], s31 offen lds
s_add_u32 s31, s31, 128
s_add_u32 s39, s37, 0
s_add_u32 m0, s39, 0
s_nop 0
buffer_load_dwordx4 v16, s[12:15], s32 offen lds
s_add_u32 m0, s39, 4096
s_nop 0
buffer_load_dwordx4 v17, s[12:15], s32 offen lds
s_add_u32 m0, s39, 8192
s_nop 0
buffer_load_dwordx4 v18, s[12:15], s32 offen lds
s_add_u32 m0, s39, 12288
s_nop 0
buffer_load_dwordx4 v19, s[12:15], s32 offen lds
s_add_u32 m0, s39, 16384
s_nop 0
buffer_load_dwordx4 v20, s[12:15], s32 offen lds
s_add_u32 m0, s39, 20480
s_nop 0
buffer_load_dwordx4 v21, s[12:15], s32 offen lds
s_add_u32 s32, s32, 393216
s_mov_b32 s33, 11
s_mov_b32 s34, 40960
Lp1_ll0:
s_waitcnt vmcnt(20)
s_barrier
s_add_u32 s38, s36, s34
s_add_u32 m0, s38, 0
s_nop 0
buffer_load_dwordx4 v4, s[8:11], s31 offen lds
s_add_u32 m0, s38, 1024
s_nop 0
buffer_load_dwordx4 v5, s[8:11], s31 offen lds
s_add_u32 m0, s38, 2048
s_nop 0
buffer_load_dwordx4 v6, s[8:11], s31 offen lds
s_add_u32 m0, s38, 3072
s_nop 0
buffer_load_dwordx4 v7, s[8:11], s31 offen lds
s_add_u32 s31, s31, 128
s_add_u32 s39, s37, s34
s_add_u32 m0, s39, 0
s_nop 0
buffer_load_dwordx4 v16, s[12:15], s32 offen lds
s_add_u32 m0, s39, 4096
s_nop 0
buffer_load_dwordx4 v17, s[12:15], s32 offen lds
s_add_u32 m0, s39, 8192
s_nop 0
buffer_load_dwordx4 v18, s[12:15], s32 offen lds
s_add_u32 m0, s39, 12288
s_nop 0
buffer_load_dwordx4 v19, s[12:15], s32 offen lds
s_add_u32 m0, s39, 16384
s_nop 0
buffer_load_dwordx4 v20, s[12:15], s32 offen lds
s_add_u32 m0, s39, 20480
s_nop 0
buffer_load_dwordx4 v21, s[12:15], s32 offen lds
s_add_u32 s32, s32, 393216
s_add_u32 s34, s34, 40960
s_cmp_eq_u32 s34, 163840
s_cselect_b32 s34, 0, s34
s_sub_u32 s33, s33, 1
s_cmp_lg_u32 s33, 0
s_cbranch_scc1 Lp1_ll0
s_mov_b32 s16, s58
s_mov_b32 s17, s59
s_mov_b32 s18, 256
s_mov_b32 s19, 0x00020000
s_add_u32 s20, s60, 50855936
s_addc_u32 s21, s61, 0
s_mov_b32 s22, 16384
s_mov_b32 s23, 0x00020000
s_add_u32 s24, s60, 50987008
s_addc_u32 s25, s61, 0
s_mov_b32 s26, 196608
s_mov_b32 s27, 0x00020000
v_lshrrev_b32 v24, 2, v1
v_and_b32 v26, 3, v1
v_lshlrev_b32 v26, 2, v26
v_lshl_add_u32 v25, v24, 9, v26
v_lshl_add_u32 v24, v24, 5, v26
v_and_b32 v26, 31, v1
v_lshlrev_b32 v26, 3, v26
v_min_u32 v28, 11, v2
s_mul_i32 s5, s30, 12
v_add_u32 v28, s5, v28
v_lshlrev_b32 v28, 4, v28
v_mul_u32_u24 v27, 49152, v3
v_add_u32 v27, v27, v28
s_lshl_b32 s3, s28, 9
s_add_u32 s3, s3, 49152
s_lshl_b32 s4, s29, 5
s_add_u32 s4, s4, 49152
buffer_load_dwordx2 v[32:33], off, s[16:19], 0 sc1
buffer_load_dword v34, v24, s[96:99], s3 offen sc1
buffer_load_dword v35, v25, s[96:99], s4 offen sc1
s_lshl_b32 s5, s28, 10
s_lshl_b32 s6, s30, 8
s_add_u32 s5, s5, s6
buffer_load_dwordx2 v[36:37], v26, s[20:23], s5 offen sc1
s_mul_i32 s5, s29, 768
buffer_load_dwordx4 v[40:43], v27, s[24:27], s5 offen sc1
s_add_u32 s5, s5, 12288
buffer_load_dwordx4 v[44:47], v27, s[24:27], s5 offen sc1
s_add_u32 s5, s5, 12288
buffer_load_dwordx4 v[48:51], v27, s[24:27], s5 offen sc1
s_add_u32 s5, s5, 12288
buffer_load_dwordx4 v[52:55], v27, s[24:27], s5 offen sc1
s_add_u32 s5, s5, 12288
v_lshlrev_b32 v29, 7, v1
s_lshl_b32 s88, s2, 2
s_add_u32 s88, s88, s30
s_mov_b32 s84, s44
s_mov_b32 s85, s45
s_mov_b32 s86, 2097152
s_mov_b32 s87, 0x00020000
s_mul_i32 s89, s88, 2048
v_cmp_gt_u32 vcc, 2048, v29
s_nop 3
s_mov_b64 exec, vcc
buffer_load_dword v0, v29, s[84:87], s89 offen
s_add_u32 s89, s89, 2048
s_mov_b64 exec, -1
s_mov_b32 s84, s48
s_mov_b32 s85, s49
s_mov_b32 s86, 7340032
s_mov_b32 s87, 0x00020000
s_mul_i32 s89, s88, 7168
v_cmp_gt_u32 vcc, 7168, v29
s_nop 3
s_mov_b64 exec, vcc
buffer_load_dword v0, v29, s[84:87], s89 offen
s_add_u32 s89, s89, 7168
s_mov_b64 exec, -1
s_waitcnt vmcnt(30)
s_barrier
s_waitcnt vmcnt(20)
s_barrier
s_waitcnt vmcnt(10)
s_barrier
s_waitcnt vmcnt(2)
v_readfirstlane_b32 s100, v32
v_xor_b32 v33, 1, v33
v_xor_b32 v34, v32, v34
v_xor_b32 v35, v32, v35
v_or3_b32 v33, v33, v34, v35
v_cmp_ne_u32 vcc, 0, v33
s_nop 4
s_cbranch_vccz Llt_ok
s_mov_b32 s84, s58
s_mov_b32 s85, s59
s_mov_b32 s86, 256
s_mov_b32 s87, 0x00020000
Llt_n:
buffer_load_dwordx2 v[32:33], off, s[84:87], 0 sc1
s_waitcnt vmcnt(0)
v_readfirstlane_b32 s100, v32
v_cmp_ne_u32 vcc, 1, v33
s_nop 4
s_cbranch_vccz Llt_n_ok
s_sleep 4
s_branch Llt_n
Llt_n_ok:
s_lshl_b32 s3, s28, 9
s_add_u32 s3, s3, 49152
s_lshl_b32 s4, s29, 5
s_add_u32 s4, s4, 49152
Llt_p:
buffer_load_dword v34, v24, s[96:99], s3 offen sc1
buffer_load_dword v35, v25, s[96:99], s4 offen sc1
s_waitcnt vmcnt(0)
v_xor_b32 v34, s100, v34
v_xor_b32 v35, s100, v35
v_or_b32 v34, v34, v35
v_cmp_ne_u32 vcc, 0, v34
s_nop 4
s_cbranch_vccz Llt_p_ok
s_sleep 4
s_branch Llt_p
Llt_p_ok:
s_lshl_b32 s5, s28, 10
s_lshl_b32 s6, s30, 8
s_add_u32 s5, s5, s6
buffer_load_dwordx2 v[36:37], v26, s[20:23], s5 offen sc1
s_mul_i32 s5, s29, 768
buffer_load_dwordx4 v[40:43], v27, s[24:27], s5 offen sc1
s_add_u32 s5, s5, 12288
buffer_load_dwordx4 v[44:47], v27, s[24:27], s5 offen sc1
s_add_u32 s5, s5, 12288
buffer_load_dwordx4 v[48:51], v27, s[24:27], s5 offen sc1
s_add_u32 s5, s5, 12288
buffer_load_dwordx4 v[52:55], v27, s[24:27], s5 offen sc1
s_add_u32 s5, s5, 12288
s_waitcnt vmcnt(0)
Llt_ok:
v_pk_add_f32 v[40:41], v[40:41], v[44:45]
v_pk_add_f32 v[42:43], v[42:43], v[46:47]
v_pk_add_f32 v[40:41], v[40:41], v[48:49]
v_pk_add_f32 v[42:43], v[42:43], v[50:51]
v_pk_add_f32 v[40:41], v[40:41], v[52:53]
v_pk_add_f32 v[42:43], v[42:43], v[54:55]
v_mov_b32 v44, v40
v_mov_b32 v45, v41
v_mov_b32 v46, v42
v_mov_b32 v47, v43
s_nop 1
v_permlane16_swap_b32 v40, v44
v_permlane16_swap_b32 v41, v45
v_permlane16_swap_b32 v42, v46
v_permlane16_swap_b32 v43, v47
s_nop 1
v_add_f32 v40, v40, v44
v_add_f32 v41, v41, v45
v_add_f32 v42, v42, v46
v_add_f32 v43, v43, v47
v_mov_b32 v44, v40
v_mov_b32 v45, v41
v_mov_b32 v46, v42
v_mov_b32 v47, v43
s_nop 1
v_permlane32_swap_b32 v40, v44
v_permlane32_swap_b32 v41, v45
v_permlane32_swap_b32 v42, v46
v_permlane32_swap_b32 v43, v47
s_nop 1
v_add_f32 v40, v40, v44
v_add_f32 v41, v41, v45
v_add_f32 v42, v42, v46
v_add_f32 v43, v43, v47
s_lshl_b32 s5, s30, 8
s_add_u32 s5, s5, 114688
v_add_u32 v26, s5, v26
v_add_u32 v28, 115712, v28
ds_write_b128 v28, v[40:43]
ds_write_b64 v26, v[36:37]
s_waitcnt lgkmcnt(0)
s_barrier
Latt:
s_setprio 0
s_and_b32 s3, s2, 7
s_lshr_b32 s4, s2, 3
s_and_b32 s28, s3, 1
s_lshl_b32 s28, s28, 3
s_and_b32 s5, s4, 7
s_add_u32 s28, s28, s5
s_lshr_b32 s29, s3, 1
s_lshl_b32 s29, s29, 2
s_lshr_b32 s5, s4, 3
s_add_u32 s29, s29, s5
s_add_u32 s64, s60, 4194304
s_addc_u32 s65, s61, 0
s_mov_b32 s66, 12582912
s_mov_b32 s67, 0x00020000
s_add_u32 s68, s60, 16777216
s_addc_u32 s69, s61, 0
s_mov_b32 s70, 4194304
s_mov_b32 s71, 0x00020000
s_cmp_lt_u32 s75, 4
s_cbranch_scc1 Lp2_nl
s_lshr_b32 s6, s30, 1
s_lshl_b32 s5, s29, 1
s_add_u32 s5, s5, s6
s_lshl_b32 s5, s5, 17
s_and_b32 s6, s30, 1
s_lshl_b32 s7, s6, 22
s_add_u32 s5, s5, s7
s_lshl_b32 s7, s28, 13
s_add_u32 s5, s5, s7
s_add_u32 s72, s5, 4177920
s_mul_i32 s74, s30, 24576
s_cmp_eq_u32 s6, 0
s_cselect_b32 s6, 48, 0
v_lshlrev_b32 v220, 4, v1
v_and_b32 v221, s6, v1
v_xor_b32 v220, v220, v221
v_and_b32 v221, 3, v1
v_bfe_u32 v222, v1, 2, 1
s_sub_u32 s3, s28, 2
v_add_u32 v222, s3, v222
v_max_i32 v222, 0, v222
v_lshlrev_b32 v222, 9, v222
v_lshl_add_u32 v221, v221, 2, v222
s_lshl_b32 s3, s29, 5
s_add_u32 s3, s3, 8192
s_cmp_eq_u32 s28, 0
s_cbranch_scc1 Lp2_p_ok
s_cmp_lg_u32 s30, 0
s_cbranch_scc1 Lp2_p_ok
Lp2_p:
buffer_load_dword v222, v221, s[96:99], s3 offen sc1
s_waitcnt vmcnt(0)
v_xor_b32 v222, s100, v222
v_cmp_ne_u32 vcc, 0, v222
s_nop 4
s_cbranch_vccz Lp2_p_ok
s_sleep 4
s_branch Lp2_p
Lp2_p_ok:
s_barrier
s_cmp_lt_u32 s28, 2
s_cselect_b32 s73, 0x80000000, s72
s_add_u32 s3, s73, 0
s_add_u32 m0, s74, 0
s_nop 0
buffer_load_dwordx4 v220, s[64:67], s3 offen offset:0 sc1 lds
buffer_load_dwordx4 v220, s[64:67], s3 offen offset:1024 sc1 lds
buffer_load_dwordx4 v220, s[64:67], s3 offen offset:2048 sc1 lds
buffer_load_dwordx4 v220, s[64:67], s3 offen offset:3072 sc1 lds
s_add_u32 s3, s73, 4096
s_add_u32 m0, s74, 4096
s_nop 0
buffer_load_dwordx4 v220, s[64:67], s3 offen offset:0 sc1 lds
buffer_load_dwordx4 v220, s[64:67], s3 offen offset:1024 sc1 lds
buffer_load_dwordx4 v220, s[64:67], s3 offen offset:2048 sc1 lds
buffer_load_dwordx4 v220, s[64:67], s3 offen offset:3072 sc1 lds
s_cmp_lt_u32 s28, 1
s_cselect_b32 s73, 0x80000000, s72
s_add_u32 s3, s73, 8192
s_add_u32 m0, s74, 8192
s_nop 0
buffer_load_dwordx4 v220, s[64:67], s3 offen offset:0 sc1 lds
buffer_load_dwordx4 v220, s[64:67], s3 offen offset:1024 sc1 lds
buffer_load_dwordx4 v220, s[64:67], s3 offen offset:2048 sc1 lds
buffer_load_dwordx4 v220, s[64:67], s3 offen offset:3072 sc1 lds
s_add_u32 s3, s73, 12288
s_add_u32 m0, s74, 12288
s_nop 0
buffer_load_dwordx4 v220, s[64:67], s3 offen offset:0 sc1 lds
buffer_load_dwordx4 v220, s[64:67], s3 offen offset:1024 sc1 lds
buffer_load_dwordx4 v220, s[64:67], s3 offen offset:2048 sc1 lds
buffer_load_dwordx4 v220, s[64:67], s3 offen offset:3072 sc1 lds
s_waitcnt vmcnt(0)
v_lshlrev_b32 v220, 7, v1
s_lshl_b32 s88, s2, 2
s_add_u32 s88, s88, s30
s_branch Lp2_nl2
Lp2_nl:
s_barrier
v_lshlrev_b32 v220, 7, v1
s_lshl_b32 s88, s2, 2
s_add_u32 s88, s88, s30
Lp2_nl2:
s_lshr_b32 s62, s75, 2
s_lshl_b32 s5, s30, 11
v_and_b32 v222, 31, v1
v_lshrrev_b32 v223, 5, v1
s_lshl_b32 s4, s62, 13
s_add_u32 s4, s4, s5
s_add_u32 s4, s4, 98304
s_mul_i32 s3, s62, 49152
s_add_u32 s5, s5, s3
v_bfe_u32 v225, v1, 2, 2
v_xor_b32 v225, v225, v223
v_lshlrev_b32 v225, 4, v225
v_lshl_add_u32 v225, v222, 6, v225
v_add_u32 v228, s5, v225
v_add_u32 v232, s4, v225
v_xor_b32 v233, 32, v232
v_xor_b32 v229, 32, v228
v_bfe_u32 v225, v1, 2, 2
v_lshl_add_u32 v225, v223, 2, v225
v_lshlrev_b32 v225, 6, v225
v_bfe_u32 v226, v1, 4, 1
v_lshl_add_u32 v225, v226, 5, v225
v_and_b32 v226, 3, v1
v_lshl_add_u32 v225, v226, 3, v225
s_add_u32 s5, s5, 24576
v_add_u32 v230, s5, v225
v_lshlrev_b32 v231, 6, v2
v_lshl_add_u32 v231, v223, 4, v231
v_and_b32 v226, 16, v1
v_lshl_add_u32 v231, v226, 1, v231
v_lshlrev_b32 v223, 2, v223
v_sub_u32 v222, v222, v223
s_lshl_b32 s72, s28, 13
s_lshl_b32 s3, s30, 11
s_add_u32 s72, s72, s3
s_lshl_b32 s3, s29, 18
s_add_u32 s72, s72, s3
s_lshl_b32 s3, s62, 17
s_add_u32 s72, s72, s3
s_add_u32 s74, s72, 1024
s_lshl_b32 s3, s28, 2
s_add_u32 s3, s3, s30
s_sub_i32 s73, 8, s3
s_max_i32 s73, s73, 0
v_cmp_gt_i32 s[8:9], 0, v222
v_cmp_gt_i32 s[10:11], 1, v222
v_cmp_gt_i32 s[12:13], 2, v222
v_cmp_gt_i32 s[14:15], 3, v222
v_cmp_gt_i32 s[16:17], 8, v222
v_cmp_gt_i32 s[18:19], 9, v222
v_cmp_gt_i32 s[20:21], 10, v222
v_cmp_gt_i32 s[22:23], 11, v222
v_cmp_gt_i32 s[24:25], 16, v222
v_cmp_gt_i32 s[26:27], 17, v222
v_cmp_gt_i32 s[28:29], 18, v222
v_cmp_gt_i32 s[30:31], 19, v222
v_cmp_gt_i32 s[32:33], 24, v222
v_cmp_gt_i32 s[34:35], 25, v222
v_cmp_gt_i32 s[36:37], 26, v222
v_cmp_gt_i32 s[38:39], 27, v222
s_waitcnt lgkmcnt(0)
s_barrier
ds_read_b128 v[180:183], v232
ds_read_b128 v[184:187], v233
ds_read_b128 v[164:167], v228 offset:0
ds_read_b128 v[168:171], v229 offset:0
ds_read_b128 v[172:175], v228 offset:2048
ds_read_b128 v[176:179], v229 offset:2048
s_waitcnt lgkmcnt(2)
v_mfma_f32_32x32x16_bf16 v[4:19], v[164:167], v[180:183], 0
v_mfma_f32_32x32x16_bf16 v[4:19], v[168:171], v[184:187], v[4:19]
ds_read_b128 v[164:167], v228 offset:4096
ds_read_b128 v[168:171], v229 offset:4096
s_waitcnt lgkmcnt(2)
v_mfma_f32_32x32x16_bf16 v[20:35], v[172:175], v[180:183], 0
v_mfma_f32_32x32x16_bf16 v[20:35], v[176:179], v[184:187], v[20:35]
ds_read_b128 v[172:175], v228 offset:6144
ds_read_b128 v[176:179], v229 offset:6144
s_waitcnt lgkmcnt(2)
v_mfma_f32_32x32x16_bf16 v[36:51], v[164:167], v[180:183], 0
v_mfma_f32_32x32x16_bf16 v[36:51], v[168:171], v[184:187], v[36:51]
ds_read_b128 v[164:167], v228 offset:8192
ds_read_b128 v[168:171], v229 offset:8192
s_waitcnt lgkmcnt(2)
v_mfma_f32_32x32x16_bf16 v[52:67], v[172:175], v[180:183], 0
v_mfma_f32_32x32x16_bf16 v[52:67], v[176:179], v[184:187], v[52:67]
ds_read_b128 v[172:175], v228 offset:10240
ds_read_b128 v[176:179], v229 offset:10240
s_waitcnt lgkmcnt(2)
v_mfma_f32_32x32x16_bf16 v[68:83], v[164:167], v[180:183], 0
v_mfma_f32_32x32x16_bf16 v[68:83], v[168:171], v[184:187], v[68:83]
ds_read_b128 v[164:167], v228 offset:12288
ds_read_b128 v[168:171], v229 offset:12288
s_waitcnt lgkmcnt(2)
v_mfma_f32_32x32x16_bf16 v[84:99], v[172:175], v[180:183], 0
v_mfma_f32_32x32x16_bf16 v[84:99], v[176:179], v[184:187], v[84:99]
ds_read_b128 v[172:175], v228 offset:14336
ds_read_b128 v[176:179], v229 offset:14336
s_waitcnt lgkmcnt(2)
v_mfma_f32_32x32x16_bf16 v[100:115], v[164:167], v[180:183], 0
v_mfma_f32_32x32x16_bf16 v[100:115], v[168:171], v[184:187], v[100:115]
ds_read_b128 v[164:167], v228 offset:16384
ds_read_b128 v[168:171], v229 offset:16384
s_waitcnt lgkmcnt(2)
v_mfma_f32_32x32x16_bf16 v[116:131], v[172:175], v[180:183], 0
v_mfma_f32_32x32x16_bf16 v[116:131], v[176:179], v[184:187], v[116:131]
s_waitcnt lgkmcnt(0)
v_mfma_f32_32x32x16_bf16 v[132:147], v[164:167], v[180:183], 0
v_mfma_f32_32x32x16_bf16 v[132:147], v[168:171], v[184:187], v[132:147]
s_cmp_eq_u32 s73, 0
s_cbranch_scc1 Lp2_nm
s_nop 7
v_mov_b32 v4, 0xf149f2ca
v_mov_b32 v5, 0xf149f2ca
v_mov_b32 v6, 0xf149f2ca
v_mov_b32 v7, 0xf149f2ca
v_mov_b32 v8, 0xf149f2ca
v_mov_b32 v9, 0xf149f2ca
v_mov_b32 v10, 0xf149f2ca
v_mov_b32 v11, 0xf149f2ca
v_mov_b32 v12, 0xf149f2ca
v_mov_b32 v13, 0xf149f2ca
v_mov_b32 v14, 0xf149f2ca
v_mov_b32 v15, 0xf149f2ca
v_mov_b32 v16, 0xf149f2ca
v_mov_b32 v17, 0xf149f2ca
v_mov_b32 v18, 0xf149f2ca
v_mov_b32 v19, 0xf149f2ca
s_cmp_eq_u32 s73, 1
s_cbranch_scc1 Lp2_nm
v_mov_b32 v20, 0xf149f2ca
v_mov_b32 v21, 0xf149f2ca
v_mov_b32 v22, 0xf149f2ca
v_mov_b32 v23, 0xf149f2ca
v_mov_b32 v24, 0xf149f2ca
v_mov_b32 v25, 0xf149f2ca
v_mov_b32 v26, 0xf149f2ca
v_mov_b32 v27, 0xf149f2ca
v_mov_b32 v28, 0xf149f2ca
v_mov_b32 v29, 0xf149f2ca
v_mov_b32 v30, 0xf149f2ca
v_mov_b32 v31, 0xf149f2ca
v_mov_b32 v32, 0xf149f2ca
v_mov_b32 v33, 0xf149f2ca
v_mov_b32 v34, 0xf149f2ca
v_mov_b32 v35, 0xf149f2ca
s_cmp_eq_u32 s73, 2
s_cbranch_scc1 Lp2_nm
v_mov_b32 v36, 0xf149f2ca
v_mov_b32 v37, 0xf149f2ca
v_mov_b32 v38, 0xf149f2ca
v_mov_b32 v39, 0xf149f2ca
v_mov_b32 v40, 0xf149f2ca
v_mov_b32 v41, 0xf149f2ca
v_mov_b32 v42, 0xf149f2ca
v_mov_b32 v43, 0xf149f2ca
v_mov_b32 v44, 0xf149f2ca
v_mov_b32 v45, 0xf149f2ca
v_mov_b32 v46, 0xf149f2ca
v_mov_b32 v47, 0xf149f2ca
v_mov_b32 v48, 0xf149f2ca
v_mov_b32 v49, 0xf149f2ca
v_mov_b32 v50, 0xf149f2ca
v_mov_b32 v51, 0xf149f2ca
s_cmp_eq_u32 s73, 3
s_cbranch_scc1 Lp2_nm
v_mov_b32 v52, 0xf149f2ca
v_mov_b32 v53, 0xf149f2ca
v_mov_b32 v54, 0xf149f2ca
v_mov_b32 v55, 0xf149f2ca
v_mov_b32 v56, 0xf149f2ca
v_mov_b32 v57, 0xf149f2ca
v_mov_b32 v58, 0xf149f2ca
v_mov_b32 v59, 0xf149f2ca
v_mov_b32 v60, 0xf149f2ca
v_mov_b32 v61, 0xf149f2ca
v_mov_b32 v62, 0xf149f2ca
v_mov_b32 v63, 0xf149f2ca
v_mov_b32 v64, 0xf149f2ca
v_mov_b32 v65, 0xf149f2ca
v_mov_b32 v66, 0xf149f2ca
v_mov_b32 v67, 0xf149f2ca
s_cmp_eq_u32 s73, 4
s_cbranch_scc1 Lp2_nm
v_mov_b32 v68, 0xf149f2ca
v_mov_b32 v69, 0xf149f2ca
v_mov_b32 v70, 0xf149f2ca
v_mov_b32 v71, 0xf149f2ca
v_mov_b32 v72, 0xf149f2ca
v_mov_b32 v73, 0xf149f2ca
v_mov_b32 v74, 0xf149f2ca
v_mov_b32 v75, 0xf149f2ca
v_mov_b32 v76, 0xf149f2ca
v_mov_b32 v77, 0xf149f2ca
v_mov_b32 v78, 0xf149f2ca
v_mov_b32 v79, 0xf149f2ca
v_mov_b32 v80, 0xf149f2ca
v_mov_b32 v81, 0xf149f2ca
v_mov_b32 v82, 0xf149f2ca
v_mov_b32 v83, 0xf149f2ca
s_cmp_eq_u32 s73, 5
s_cbranch_scc1 Lp2_nm
v_mov_b32 v84, 0xf149f2ca
v_mov_b32 v85, 0xf149f2ca
v_mov_b32 v86, 0xf149f2ca
v_mov_b32 v87, 0xf149f2ca
v_mov_b32 v88, 0xf149f2ca
v_mov_b32 v89, 0xf149f2ca
v_mov_b32 v90, 0xf149f2ca
v_mov_b32 v91, 0xf149f2ca
v_mov_b32 v92, 0xf149f2ca
v_mov_b32 v93, 0xf149f2ca
v_mov_b32 v94, 0xf149f2ca
v_mov_b32 v95, 0xf149f2ca
v_mov_b32 v96, 0xf149f2ca
v_mov_b32 v97, 0xf149f2ca
v_mov_b32 v98, 0xf149f2ca
v_mov_b32 v99, 0xf149f2ca
s_cmp_eq_u32 s73, 6
s_cbranch_scc1 Lp2_nm
v_mov_b32 v100, 0xf149f2ca
v_mov_b32 v101, 0xf149f2ca
v_mov_b32 v102, 0xf149f2ca
v_mov_b32 v103, 0xf149f2ca
v_mov_b32 v104, 0xf149f2ca
v_mov_b32 v105, 0xf149f2ca
v_mov_b32 v106, 0xf149f2ca
v_mov_b32 v107, 0xf149f2ca
v_mov_b32 v108, 0xf149f2ca
v_mov_b32 v109, 0xf149f2ca
v_mov_b32 v110, 0xf149f2ca
v_mov_b32 v111, 0xf149f2ca
v_mov_b32 v112, 0xf149f2ca
v_mov_b32 v113, 0xf149f2ca
v_mov_b32 v114, 0xf149f2ca
v_mov_b32 v115, 0xf149f2ca
s_cmp_eq_u32 s73, 7
s_cbranch_scc1 Lp2_nm
v_mov_b32 v116, 0xf149f2ca
v_mov_b32 v117, 0xf149f2ca
v_mov_b32 v118, 0xf149f2ca
v_mov_b32 v119, 0xf149f2ca
v_mov_b32 v120, 0xf149f2ca
v_mov_b32 v121, 0xf149f2ca
v_mov_b32 v122, 0xf149f2ca
v_mov_b32 v123, 0xf149f2ca
v_mov_b32 v124, 0xf149f2ca
v_mov_b32 v125, 0xf149f2ca
v_mov_b32 v126, 0xf149f2ca
v_mov_b32 v127, 0xf149f2ca
v_mov_b32 v128, 0xf149f2ca
v_mov_b32 v129, 0xf149f2ca
v_mov_b32 v130, 0xf149f2ca
v_mov_b32 v131, 0xf149f2ca
s_cmp_eq_u32 s73, 8
s_cbranch_scc1 Lp2_nm
Lp2_nm:
ds_read_b64_tr_b16 v[196:197], v230 offset:2048
ds_read_b64_tr_b16 v[198:199], v230 offset:2560
ds_read_b64_tr_b16 v[200:201], v230 offset:3072
ds_read_b64_tr_b16 v[202:203], v230 offset:3584
v_max_f32 v232, v20, v21
v_max_f32 v233, v22, v23
v_max3_f32 v232, v24, v25, v232
v_max3_f32 v233, v26, v27, v233
v_max3_f32 v232, v28, v29, v232
v_max3_f32 v233, v30, v31, v233
v_max3_f32 v232, v32, v33, v232
v_max3_f32 v233, v34, v35, v233
v_max3_f32 v232, v36, v37, v232
v_max3_f32 v233, v38, v39, v233
v_max3_f32 v232, v40, v41, v232
v_max3_f32 v233, v42, v43, v233
v_max3_f32 v232, v44, v45, v232
v_max3_f32 v233, v46, v47, v233
v_max3_f32 v232, v48, v49, v232
v_max3_f32 v233, v50, v51, v233
v_max3_f32 v232, v52, v53, v232
v_max3_f32 v233, v54, v55, v233
v_max3_f32 v232, v56, v57, v232
v_max3_f32 v233, v58, v59, v233
v_max3_f32 v232, v60, v61, v232
v_max3_f32 v233, v62, v63, v233
v_max3_f32 v232, v64, v65, v232
v_max3_f32 v233, v66, v67, v233
v_max3_f32 v232, v68, v69, v232
v_max3_f32 v233, v70, v71, v233
v_max3_f32 v232, v72, v73, v232
v_max3_f32 v233, v74, v75, v233
v_max3_f32 v232, v76, v77, v232
v_max3_f32 v233, v78, v79, v233
v_max3_f32 v232, v80, v81, v232
v_max3_f32 v233, v82, v83, v233
v_max3_f32 v232, v84, v85, v232
v_max3_f32 v233, v86, v87, v233
v_max3_f32 v232, v88, v89, v232
v_max3_f32 v233, v90, v91, v233
v_max3_f32 v232, v92, v93, v232
v_max3_f32 v233, v94, v95, v233
v_max3_f32 v232, v96, v97, v232
v_max3_f32 v233, v98, v99, v233
v_max3_f32 v232, v100, v101, v232
v_max3_f32 v233, v102, v103, v233
v_max3_f32 v232, v104, v105, v232
v_max3_f32 v233, v106, v107, v233
v_max3_f32 v232, v108, v109, v232
v_max3_f32 v233, v110, v111, v233
v_max3_f32 v232, v112, v113, v232
v_max3_f32 v233, v114, v115, v233
v_max3_f32 v232, v116, v117, v232
v_max3_f32 v233, v118, v119, v233
v_max3_f32 v232, v120, v121, v232
v_max3_f32 v233, v122, v123, v233
v_max3_f32 v232, v124, v125, v232
v_max3_f32 v233, v126, v127, v233
v_max3_f32 v232, v128, v129, v232
v_max3_f32 v233, v130, v131, v233
v_cndmask_b32 v132, v132, v4, s[8:9]
v_cndmask_b32 v133, v133, v5, s[10:11]
v_cndmask_b32 v134, v134, v6, s[12:13]
v_cndmask_b32 v135, v135, v7, s[14:15]
v_cndmask_b32 v136, v136, v8, s[16:17]
v_cndmask_b32 v137, v137, v9, s[18:19]
v_cndmask_b32 v138, v138, v10, s[20:21]
v_cndmask_b32 v139, v139, v11, s[22:23]
v_cndmask_b32 v140, v140, v12, s[24:25]
v_cndmask_b32 v141, v141, v13, s[26:27]
v_cndmask_b32 v142, v142, v14, s[28:29]
v_cndmask_b32 v143, v143, v15, s[30:31]
v_cndmask_b32 v144, v144, v16, s[32:33]
v_cndmask_b32 v145, v145, v17, s[34:35]
v_cndmask_b32 v146, v146, v18, s[36:37]
v_cndmask_b32 v147, v147, v19, s[38:39]
v_max3_f32 v232, v132, v133, v232
v_max3_f32 v233, v134, v135, v233
v_max3_f32 v232, v136, v137, v232
v_max3_f32 v233, v138, v139, v233
v_max3_f32 v232, v140, v141, v232
v_max3_f32 v233, v142, v143, v233
v_max3_f32 v232, v144, v145, v232
v_max3_f32 v233, v146, v147, v233
v_max_f32 v232, v232, v233
s_mov_b32 s6, 0x3e8293ee
v_mov_b32 v233, v232
s_mov_b32 s7, s6
s_nop 0
v_permlane32_swap_b32 v232, v233
s_nop 1
v_max_f32 v232, v232, v233
v_mul_f32 v232, 0xbe8293ee, v232
v_pk_fma_f32 v[20:21], v[20:21], s[6:7], v[232:233] op_sel_hi:[1,1,0]
v_pk_fma_f32 v[22:23], v[22:23], s[6:7], v[232:233] op_sel_hi:[1,1,0]
v_pk_fma_f32 v[24:25], v[24:25], s[6:7], v[232:233] op_sel_hi:[1,1,0]
v_pk_fma_f32 v[26:27], v[26:27], s[6:7], v[232:233] op_sel_hi:[1,1,0]
v_pk_fma_f32 v[28:29], v[28:29], s[6:7], v[232:233] op_sel_hi:[1,1,0]
v_pk_fma_f32 v[30:31], v[30:31], s[6:7], v[232:233] op_sel_hi:[1,1,0]
v_pk_fma_f32 v[32:33], v[32:33], s[6:7], v[232:233] op_sel_hi:[1,1,0]
v_pk_fma_f32 v[34:35], v[34:35], s[6:7], v[232:233] op_sel_hi:[1,1,0]
v_exp_f32 v20, v20
v_exp_f32 v21, v21
v_exp_f32 v22, v22
v_exp_f32 v23, v23
v_exp_f32 v24, v24
v_exp_f32 v25, v25
v_exp_f32 v26, v26
v_exp_f32 v27, v27
v_exp_f32 v28, v28
v_exp_f32 v29, v29
v_exp_f32 v30, v30
v_exp_f32 v31, v31
v_exp_f32 v32, v32
v_exp_f32 v33, v33
v_exp_f32 v34, v34
v_exp_f32 v35, v35
ds_read_b64_tr_b16 v[188:189], v230 offset:4096
ds_read_b64_tr_b16 v[190:191], v230 offset:4608
ds_read_b64_tr_b16 v[192:193], v230 offset:5120
ds_read_b64_tr_b16 v[194:195], v230 offset:5632
v_pk_add_f32 v[234:235], v[20:21], v[22:23]
v_pk_add_f32 v[234:235], v[234:235], v[24:25]
v_pk_add_f32 v[234:235], v[234:235], v[26:27]
v_pk_add_f32 v[234:235], v[234:235], v[28:29]
v_pk_add_f32 v[234:235], v[234:235], v[30:31]
v_pk_add_f32 v[234:235], v[234:235], v[32:33]
v_pk_add_f32 v[234:235], v[234:235], v[34:35]
v_cvt_pk_bf16_f32 v212, v20, v21
v_cvt_pk_bf16_f32 v213, v22, v23
v_cvt_pk_bf16_f32 v214, v24, v25
v_cvt_pk_bf16_f32 v215, v26, v27
v_cvt_pk_bf16_f32 v216, v28, v29
v_cvt_pk_bf16_f32 v217, v30, v31
v_cvt_pk_bf16_f32 v218, v32, v33
v_cvt_pk_bf16_f32 v219, v34, v35
s_waitcnt lgkmcnt(4)
s_nop 0
v_mfma_f32_32x32x16_bf16 v[148:163], v[196:199], v[212:215], 0
v_mfma_f32_32x32x16_bf16 v[148:163], v[200:203], v[216:219], v[148:163]
v_pk_fma_f32 v[36:37], v[36:37], s[6:7], v[232:233] op_sel_hi:[1,1,0]
v_pk_fma_f32 v[38:39], v[38:39], s[6:7], v[232:233] op_sel_hi:[1,1,0]
v_pk_fma_f32 v[40:41], v[40:41], s[6:7], v[232:233] op_sel_hi:[1,1,0]
v_pk_fma_f32 v[42:43], v[42:43], s[6:7], v[232:233] op_sel_hi:[1,1,0]
v_pk_fma_f32 v[44:45], v[44:45], s[6:7], v[232:233] op_sel_hi:[1,1,0]
v_pk_fma_f32 v[46:47], v[46:47], s[6:7], v[232:233] op_sel_hi:[1,1,0]
v_pk_fma_f32 v[48:49], v[48:49], s[6:7], v[232:233] op_sel_hi:[1,1,0]
v_pk_fma_f32 v[50:51], v[50:51], s[6:7], v[232:233] op_sel_hi:[1,1,0]
v_exp_f32 v36, v36
v_exp_f32 v37, v37
v_exp_f32 v38, v38
v_exp_f32 v39, v39
v_exp_f32 v40, v40
v_exp_f32 v41, v41
v_exp_f32 v42, v42
v_exp_f32 v43, v43
v_exp_f32 v44, v44
v_exp_f32 v45, v45
v_exp_f32 v46, v46
v_exp_f32 v47, v47
v_exp_f32 v48, v48
v_exp_f32 v49, v49
v_exp_f32 v50, v50
v_exp_f32 v51, v51
ds_read_b64_tr_b16 v[196:197], v230 offset:6144
ds_read_b64_tr_b16 v[198:199], v230 offset:6656
ds_read_b64_tr_b16 v[200:201], v230 offset:7168
ds_read_b64_tr_b16 v[202:203], v230 offset:7680
v_pk_add_f32 v[234:235], v[234:235], v[36:37]
v_pk_add_f32 v[234:235], v[234:235], v[38:39]
v_pk_add_f32 v[234:235], v[234:235], v[40:41]
v_pk_add_f32 v[234:235], v[234:235], v[42:43]
v_pk_add_f32 v[234:235], v[234:235], v[44:45]
v_pk_add_f32 v[234:235], v[234:235], v[46:47]
v_pk_add_f32 v[234:235], v[234:235], v[48:49]
v_pk_add_f32 v[234:235], v[234:235], v[50:51]
v_cvt_pk_bf16_f32 v204, v36, v37
v_cvt_pk_bf16_f32 v205, v38, v39
v_cvt_pk_bf16_f32 v206, v40, v41
v_cvt_pk_bf16_f32 v207, v42, v43
v_cvt_pk_bf16_f32 v208, v44, v45
v_cvt_pk_bf16_f32 v209, v46, v47
v_cvt_pk_bf16_f32 v210, v48, v49
v_cvt_pk_bf16_f32 v211, v50, v51
s_waitcnt lgkmcnt(4)
s_nop 0
v_mfma_f32_32x32x16_bf16 v[148:163], v[188:191], v[204:207], v[148:163]
v_mfma_f32_32x32x16_bf16 v[148:163], v[192:195], v[208:211], v[148:163]
v_pk_fma_f32 v[52:53], v[52:53], s[6:7], v[232:233] op_sel_hi:[1,1,0]
v_pk_fma_f32 v[54:55], v[54:55], s[6:7], v[232:233] op_sel_hi:[1,1,0]
v_pk_fma_f32 v[56:57], v[56:57], s[6:7], v[232:233] op_sel_hi:[1,1,0]
v_pk_fma_f32 v[58:59], v[58:59], s[6:7], v[232:233] op_sel_hi:[1,1,0]
v_pk_fma_f32 v[60:61], v[60:61], s[6:7], v[232:233] op_sel_hi:[1,1,0]
v_pk_fma_f32 v[62:63], v[62:63], s[6:7], v[232:233] op_sel_hi:[1,1,0]
v_pk_fma_f32 v[64:65], v[64:65], s[6:7], v[232:233] op_sel_hi:[1,1,0]
v_pk_fma_f32 v[66:67], v[66:67], s[6:7], v[232:233] op_sel_hi:[1,1,0]
v_exp_f32 v52, v52
v_exp_f32 v53, v53
v_exp_f32 v54, v54
v_exp_f32 v55, v55
v_exp_f32 v56, v56
v_exp_f32 v57, v57
v_exp_f32 v58, v58
v_exp_f32 v59, v59
v_exp_f32 v60, v60
v_exp_f32 v61, v61
v_exp_f32 v62, v62
v_exp_f32 v63, v63
v_exp_f32 v64, v64
v_exp_f32 v65, v65
v_exp_f32 v66, v66
v_exp_f32 v67, v67
ds_read_b64_tr_b16 v[188:189], v230 offset:8192
ds_read_b64_tr_b16 v[190:191], v230 offset:8704
ds_read_b64_tr_b16 v[192:193], v230 offset:9216
ds_read_b64_tr_b16 v[194:195], v230 offset:9728
v_pk_add_f32 v[234:235], v[234:235], v[52:53]
v_pk_add_f32 v[234:235], v[234:235], v[54:55]
v_pk_add_f32 v[234:235], v[234:235], v[56:57]
v_pk_add_f32 v[234:235], v[234:235], v[58:59]
v_pk_add_f32 v[234:235], v[234:235], v[60:61]
v_pk_add_f32 v[234:235], v[234:235], v[62:63]
v_pk_add_f32 v[234:235], v[234:235], v[64:65]
v_pk_add_f32 v[234:235], v[234:235], v[66:67]
v_cvt_pk_bf16_f32 v212, v52, v53
v_cvt_pk_bf16_f32 v213, v54, v55
v_cvt_pk_bf16_f32 v214, v56, v57
v_cvt_pk_bf16_f32 v215, v58, v59
v_cvt_pk_bf16_f32 v216, v60, v61
v_cvt_pk_bf16_f32 v217, v62, v63
v_cvt_pk_bf16_f32 v218, v64, v65
v_cvt_pk_bf16_f32 v219, v66, v67
s_waitcnt lgkmcnt(4)
s_nop 0
v_mfma_f32_32x32x16_bf16 v[148:163], v[196:199], v[212:215], v[148:163]
v_mfma_f32_32x32x16_bf16 v[148:163], v[200:203], v[216:219], v[148:163]
v_pk_fma_f32 v[68:69], v[68:69], s[6:7], v[232:233] op_sel_hi:[1,1,0]
v_pk_fma_f32 v[70:71], v[70:71], s[6:7], v[232:233] op_sel_hi:[1,1,0]
v_pk_fma_f32 v[72:73], v[72:73], s[6:7], v[232:233] op_sel_hi:[1,1,0]
v_pk_fma_f32 v[74:75], v[74:75], s[6:7], v[232:233] op_sel_hi:[1,1,0]
v_pk_fma_f32 v[76:77], v[76:77], s[6:7], v[232:233] op_sel_hi:[1,1,0]
v_pk_fma_f32 v[78:79], v[78:79], s[6:7], v[232:233] op_sel_hi:[1,1,0]
v_pk_fma_f32 v[80:81], v[80:81], s[6:7], v[232:233] op_sel_hi:[1,1,0]
v_pk_fma_f32 v[82:83], v[82:83], s[6:7], v[232:233] op_sel_hi:[1,1,0]
v_exp_f32 v68, v68
v_exp_f32 v69, v69
v_exp_f32 v70, v70
v_exp_f32 v71, v71
v_exp_f32 v72, v72
v_exp_f32 v73, v73
v_exp_f32 v74, v74
v_exp_f32 v75, v75
v_exp_f32 v76, v76
v_exp_f32 v77, v77
v_exp_f32 v78, v78
v_exp_f32 v79, v79
v_exp_f32 v80, v80
v_exp_f32 v81, v81
v_exp_f32 v82, v82
v_exp_f32 v83, v83
ds_read_b64_tr_b16 v[196:197], v230 offset:10240
ds_read_b64_tr_b16 v[198:199], v230 offset:10752
ds_read_b64_tr_b16 v[200:201], v230 offset:11264
ds_read_b64_tr_b16 v[202:203], v230 offset:11776
v_pk_add_f32 v[234:235], v[234:235], v[68:69]
v_pk_add_f32 v[234:235], v[234:235], v[70:71]
v_pk_add_f32 v[234:235], v[234:235], v[72:73]
v_pk_add_f32 v[234:235], v[234:235], v[74:75]
v_pk_add_f32 v[234:235], v[234:235], v[76:77]
v_pk_add_f32 v[234:235], v[234:235], v[78:79]
v_pk_add_f32 v[234:235], v[234:235], v[80:81]
v_pk_add_f32 v[234:235], v[234:235], v[82:83]
v_cvt_pk_bf16_f32 v204, v68, v69
v_cvt_pk_bf16_f32 v205, v70, v71
v_cvt_pk_bf16_f32 v206, v72, v73
v_cvt_pk_bf16_f32 v207, v74, v75
v_cvt_pk_bf16_f32 v208, v76, v77
v_cvt_pk_bf16_f32 v209, v78, v79
v_cvt_pk_bf16_f32 v210, v80, v81
v_cvt_pk_bf16_f32 v211, v82, v83
s_waitcnt lgkmcnt(4)
s_nop 0
v_mfma_f32_32x32x16_bf16 v[148:163], v[188:191], v[204:207], v[148:163]
v_mfma_f32_32x32x16_bf16 v[148:163], v[192:195], v[208:211], v[148:163]
v_pk_fma_f32 v[84:85], v[84:85], s[6:7], v[232:233] op_sel_hi:[1,1,0]
v_pk_fma_f32 v[86:87], v[86:87], s[6:7], v[232:233] op_sel_hi:[1,1,0]
v_pk_fma_f32 v[88:89], v[88:89], s[6:7], v[232:233] op_sel_hi:[1,1,0]
v_pk_fma_f32 v[90:91], v[90:91], s[6:7], v[232:233] op_sel_hi:[1,1,0]
v_pk_fma_f32 v[92:93], v[92:93], s[6:7], v[232:233] op_sel_hi:[1,1,0]
v_pk_fma_f32 v[94:95], v[94:95], s[6:7], v[232:233] op_sel_hi:[1,1,0]
v_pk_fma_f32 v[96:97], v[96:97], s[6:7], v[232:233] op_sel_hi:[1,1,0]
v_pk_fma_f32 v[98:99], v[98:99], s[6:7], v[232:233] op_sel_hi:[1,1,0]
v_exp_f32 v84, v84
v_exp_f32 v85, v85
v_exp_f32 v86, v86
v_exp_f32 v87, v87
v_exp_f32 v88, v88
v_exp_f32 v89, v89
v_exp_f32 v90, v90
v_exp_f32 v91, v91
v_exp_f32 v92, v92
v_exp_f32 v93, v93
v_exp_f32 v94, v94
v_exp_f32 v95, v95
v_exp_f32 v96, v96
v_exp_f32 v97, v97
v_exp_f32 v98, v98
v_exp_f32 v99, v99
ds_read_b64_tr_b16 v[188:189], v230 offset:12288
ds_read_b64_tr_b16 v[190:191], v230 offset:12800
ds_read_b64_tr_b16 v[192:193], v230 offset:13312
ds_read_b64_tr_b16 v[194:195], v230 offset:13824
v_pk_add_f32 v[234:235], v[234:235], v[84:85]
v_pk_add_f32 v[234:235], v[234:235], v[86:87]
v_pk_add_f32 v[234:235], v[234:235], v[88:89]
v_pk_add_f32 v[234:235], v[234:235], v[90:91]
v_pk_add_f32 v[234:235], v[234:235], v[92:93]
v_pk_add_f32 v[234:235], v[234:235], v[94:95]
v_pk_add_f32 v[234:235], v[234:235], v[96:97]
v_pk_add_f32 v[234:235], v[234:235], v[98:99]
v_cvt_pk_bf16_f32 v212, v84, v85
v_cvt_pk_bf16_f32 v213, v86, v87
v_cvt_pk_bf16_f32 v214, v88, v89
v_cvt_pk_bf16_f32 v215, v90, v91
v_cvt_pk_bf16_f32 v216, v92, v93
v_cvt_pk_bf16_f32 v217, v94, v95
v_cvt_pk_bf16_f32 v218, v96, v97
v_cvt_pk_bf16_f32 v219, v98, v99
s_waitcnt lgkmcnt(4)
s_nop 0
v_mfma_f32_32x32x16_bf16 v[148:163], v[196:199], v[212:215], v[148:163]
v_mfma_f32_32x32x16_bf16 v[148:163], v[200:203], v[216:219], v[148:163]
v_pk_fma_f32 v[100:101], v[100:101], s[6:7], v[232:233] op_sel_hi:[1,1,0]
v_pk_fma_f32 v[102:103], v[102:103], s[6:7], v[232:233] op_sel_hi:[1,1,0]
v_pk_fma_f32 v[104:105], v[104:105], s[6:7], v[232:233] op_sel_hi:[1,1,0]
v_pk_fma_f32 v[106:107], v[106:107], s[6:7], v[232:233] op_sel_hi:[1,1,0]
v_pk_fma_f32 v[108:109], v[108:109], s[6:7], v[232:233] op_sel_hi:[1,1,0]
v_pk_fma_f32 v[110:111], v[110:111], s[6:7], v[232:233] op_sel_hi:[1,1,0]
v_pk_fma_f32 v[112:113], v[112:113], s[6:7], v[232:233] op_sel_hi:[1,1,0]
v_pk_fma_f32 v[114:115], v[114:115], s[6:7], v[232:233] op_sel_hi:[1,1,0]
v_exp_f32 v100, v100
v_exp_f32 v101, v101
v_exp_f32 v102, v102
v_exp_f32 v103, v103
v_exp_f32 v104, v104
v_exp_f32 v105, v105
v_exp_f32 v106, v106
v_exp_f32 v107, v107
v_exp_f32 v108, v108
v_exp_f32 v109, v109
v_exp_f32 v110, v110
v_exp_f32 v111, v111
v_exp_f32 v112, v112
v_exp_f32 v113, v113
v_exp_f32 v114, v114
v_exp_f32 v115, v115
ds_read_b64_tr_b16 v[196:197], v230 offset:14336
ds_read_b64_tr_b16 v[198:199], v230 offset:14848
ds_read_b64_tr_b16 v[200:201], v230 offset:15360
ds_read_b64_tr_b16 v[202:203], v230 offset:15872
v_pk_add_f32 v[234:235], v[234:235], v[100:101]
v_pk_add_f32 v[234:235], v[234:235], v[102:103]
v_pk_add_f32 v[234:235], v[234:235], v[104:105]
v_pk_add_f32 v[234:235], v[234:235], v[106:107]
v_pk_add_f32 v[234:235], v[234:235], v[108:109]
v_pk_add_f32 v[234:235], v[234:235], v[110:111]
v_pk_add_f32 v[234:235], v[234:235], v[112:113]
v_pk_add_f32 v[234:235], v[234:235], v[114:115]
v_cvt_pk_bf16_f32 v204, v100, v101
v_cvt_pk_bf16_f32 v205, v102, v103
v_cvt_pk_bf16_f32 v206, v104, v105
v_cvt_pk_bf16_f32 v207, v106, v107
v_cvt_pk_bf16_f32 v208, v108, v109
v_cvt_pk_bf16_f32 v209, v110, v111
v_cvt_pk_bf16_f32 v210, v112, v113
v_cvt_pk_bf16_f32 v211, v114, v115
s_waitcnt lgkmcnt(4)
s_nop 0
v_mfma_f32_32x32x16_bf16 v[148:163], v[188:191], v[204:207], v[148:163]
v_mfma_f32_32x32x16_bf16 v[148:163], v[192:195], v[208:211], v[148:163]
v_pk_fma_f32 v[116:117], v[116:117], s[6:7], v[232:233] op_sel_hi:[1,1,0]
v_pk_fma_f32 v[118:119], v[118:119], s[6:7], v[232:233] op_sel_hi:[1,1,0]
v_pk_fma_f32 v[120:121], v[120:121], s[6:7], v[232:233] op_sel_hi:[1,1,0]
v_pk_fma_f32 v[122:123], v[122:123], s[6:7], v[232:233] op_sel_hi:[1,1,0]
v_pk_fma_f32 v[124:125], v[124:125], s[6:7], v[232:233] op_sel_hi:[1,1,0]
v_pk_fma_f32 v[126:127], v[126:127], s[6:7], v[232:233] op_sel_hi:[1,1,0]
v_pk_fma_f32 v[128:129], v[128:129], s[6:7], v[232:233] op_sel_hi:[1,1,0]
v_pk_fma_f32 v[130:131], v[130:131], s[6:7], v[232:233] op_sel_hi:[1,1,0]
v_exp_f32 v116, v116
v_exp_f32 v117, v117
v_exp_f32 v118, v118
v_exp_f32 v119, v119
v_exp_f32 v120, v120
v_exp_f32 v121, v121
v_exp_f32 v122, v122
v_exp_f32 v123, v123
v_exp_f32 v124, v124
v_exp_f32 v125, v125
v_exp_f32 v126, v126
v_exp_f32 v127, v127
v_exp_f32 v128, v128
v_exp_f32 v129, v129
v_exp_f32 v130, v130
v_exp_f32 v131, v131
ds_read_b64_tr_b16 v[188:189], v230 offset:16384
ds_read_b64_tr_b16 v[190:191], v230 offset:16896
ds_read_b64_tr_b16 v[192:193], v230 offset:17408
ds_read_b64_tr_b16 v[194:195], v230 offset:17920
v_pk_add_f32 v[234:235], v[234:235], v[116:117]
v_pk_add_f32 v[234:235], v[234:235], v[118:119]
v_pk_add_f32 v[234:235], v[234:235], v[120:121]
v_pk_add_f32 v[234:235], v[234:235], v[122:123]
v_pk_add_f32 v[234:235], v[234:235], v[124:125]
v_pk_add_f32 v[234:235], v[234:235], v[126:127]
v_pk_add_f32 v[234:235], v[234:235], v[128:129]
v_pk_add_f32 v[234:235], v[234:235], v[130:131]
v_cvt_pk_bf16_f32 v212, v116, v117
v_cvt_pk_bf16_f32 v213, v118, v119
v_cvt_pk_bf16_f32 v214, v120, v121
v_cvt_pk_bf16_f32 v215, v122, v123
v_cvt_pk_bf16_f32 v216, v124, v125
v_cvt_pk_bf16_f32 v217, v126, v127
v_cvt_pk_bf16_f32 v218, v128, v129
v_cvt_pk_bf16_f32 v219, v130, v131
s_waitcnt lgkmcnt(4)
s_nop 0
v_mfma_f32_32x32x16_bf16 v[148:163], v[196:199], v[212:215], v[148:163]
v_mfma_f32_32x32x16_bf16 v[148:163], v[200:203], v[216:219], v[148:163]
v_pk_fma_f32 v[132:133], v[132:133], s[6:7], v[232:233] op_sel_hi:[1,1,0]
v_pk_fma_f32 v[134:135], v[134:135], s[6:7], v[232:233] op_sel_hi:[1,1,0]
v_pk_fma_f32 v[136:137], v[136:137], s[6:7], v[232:233] op_sel_hi:[1,1,0]
v_pk_fma_f32 v[138:139], v[138:139], s[6:7], v[232:233] op_sel_hi:[1,1,0]
v_pk_fma_f32 v[140:141], v[140:141], s[6:7], v[232:233] op_sel_hi:[1,1,0]
v_pk_fma_f32 v[142:143], v[142:143], s[6:7], v[232:233] op_sel_hi:[1,1,0]
v_pk_fma_f32 v[144:145], v[144:145], s[6:7], v[232:233] op_sel_hi:[1,1,0]
v_pk_fma_f32 v[146:147], v[146:147], s[6:7], v[232:233] op_sel_hi:[1,1,0]
v_exp_f32 v132, v132
v_exp_f32 v133, v133
v_exp_f32 v134, v134
v_exp_f32 v135, v135
v_exp_f32 v136, v136
v_exp_f32 v137, v137
v_exp_f32 v138, v138
v_exp_f32 v139, v139
v_exp_f32 v140, v140
v_exp_f32 v141, v141
v_exp_f32 v142, v142
v_exp_f32 v143, v143
v_exp_f32 v144, v144
v_exp_f32 v145, v145
v_exp_f32 v146, v146
v_exp_f32 v147, v147
ds_read_b64_tr_b16 v[196:197], v230 offset:0
ds_read_b64_tr_b16 v[198:199], v230 offset:512
ds_read_b64_tr_b16 v[200:201], v230 offset:1024
ds_read_b64_tr_b16 v[202:203], v230 offset:1536
v_pk_add_f32 v[234:235], v[234:235], v[132:133]
v_pk_add_f32 v[234:235], v[234:235], v[134:135]
v_pk_add_f32 v[234:235], v[234:235], v[136:137]
v_pk_add_f32 v[234:235], v[234:235], v[138:139]
v_pk_add_f32 v[234:235], v[234:235], v[140:141]
v_pk_add_f32 v[234:235], v[234:235], v[142:143]
v_pk_add_f32 v[234:235], v[234:235], v[144:145]
v_pk_add_f32 v[234:235], v[234:235], v[146:147]
v_cndmask_b32 v4, 0, v132, s[8:9]
v_cndmask_b32 v132, v132, 0, s[8:9]
v_cndmask_b32 v5, 0, v133, s[10:11]
v_cndmask_b32 v133, v133, 0, s[10:11]
v_cndmask_b32 v6, 0, v134, s[12:13]
v_cndmask_b32 v134, v134, 0, s[12:13]
v_cndmask_b32 v7, 0, v135, s[14:15]
v_cndmask_b32 v135, v135, 0, s[14:15]
v_cndmask_b32 v8, 0, v136, s[16:17]
v_cndmask_b32 v136, v136, 0, s[16:17]
v_cndmask_b32 v9, 0, v137, s[18:19]
v_cndmask_b32 v137, v137, 0, s[18:19]
v_cndmask_b32 v10, 0, v138, s[20:21]
v_cndmask_b32 v138, v138, 0, s[20:21]
v_cndmask_b32 v11, 0, v139, s[22:23]
v_cndmask_b32 v139, v139, 0, s[22:23]
v_cndmask_b32 v12, 0, v140, s[24:25]
v_cndmask_b32 v140, v140, 0, s[24:25]
v_cndmask_b32 v13, 0, v141, s[26:27]
v_cndmask_b32 v141, v141, 0, s[26:27]
v_cndmask_b32 v14, 0, v142, s[28:29]
v_cndmask_b32 v142, v142, 0, s[28:29]
v_cndmask_b32 v15, 0, v143, s[30:31]
v_cndmask_b32 v143, v143, 0, s[30:31]
v_cndmask_b32 v16, 0, v144, s[32:33]
v_cndmask_b32 v144, v144, 0, s[32:33]
v_cndmask_b32 v17, 0, v145, s[34:35]
v_cndmask_b32 v145, v145, 0, s[34:35]
v_cndmask_b32 v18, 0, v146, s[36:37]
v_cndmask_b32 v146, v146, 0, s[36:37]
v_cndmask_b32 v19, 0, v147, s[38:39]
v_cndmask_b32 v147, v147, 0, s[38:39]
v_cvt_pk_bf16_f32 v204, v132, v133
v_cvt_pk_bf16_f32 v205, v134, v135
v_cvt_pk_bf16_f32 v206, v136, v137
v_cvt_pk_bf16_f32 v207, v138, v139
v_cvt_pk_bf16_f32 v208, v140, v141
v_cvt_pk_bf16_f32 v209, v142, v143
v_cvt_pk_bf16_f32 v210, v144, v145
v_cvt_pk_bf16_f32 v211, v146, v147
s_waitcnt lgkmcnt(4)
s_nop 0
v_mfma_f32_32x32x16_bf16 v[148:163], v[188:191], v[204:207], v[148:163]
v_mfma_f32_32x32x16_bf16 v[148:163], v[192:195], v[208:211], v[148:163]
v_cvt_pk_bf16_f32 v212, v4, v5
v_cvt_pk_bf16_f32 v213, v6, v7
v_cvt_pk_bf16_f32 v214, v8, v9
v_cvt_pk_bf16_f32 v215, v10, v11
v_cvt_pk_bf16_f32 v216, v12, v13
v_cvt_pk_bf16_f32 v217, v14, v15
v_cvt_pk_bf16_f32 v218, v16, v17
v_cvt_pk_bf16_f32 v219, v18, v19
s_waitcnt lgkmcnt(0)
s_nop 0
v_mfma_f32_32x32x16_bf16 v[148:163], v[196:199], v[212:215], v[148:163]
v_mfma_f32_32x32x16_bf16 v[148:163], v[200:203], v[216:219], v[148:163]
v_add_f32 v234, v234, v235
v_mov_b32 v235, v234
s_nop 1
v_permlane32_swap_b32 v234, v235
s_nop 1
v_add_f32 v234, v234, v235
v_rcp_f32 v234, v234
s_nop 7
v_pk_mul_f32 v[148:149], v[148:149], v[234:235] op_sel_hi:[1,0]
v_pk_mul_f32 v[150:151], v[150:151], v[234:235] op_sel_hi:[1,0]
v_pk_mul_f32 v[152:153], v[152:153], v[234:235] op_sel_hi:[1,0]
v_pk_mul_f32 v[154:155], v[154:155], v[234:235] op_sel_hi:[1,0]
v_pk_mul_f32 v[156:157], v[156:157], v[234:235] op_sel_hi:[1,0]
v_pk_mul_f32 v[158:159], v[158:159], v[234:235] op_sel_hi:[1,0]
v_pk_mul_f32 v[160:161], v[160:161], v[234:235] op_sel_hi:[1,0]
v_pk_mul_f32 v[162:163], v[162:163], v[234:235] op_sel_hi:[1,0]
v_cvt_pk_bf16_f32 v4, v148, v149
v_cvt_pk_bf16_f32 v5, v150, v151
v_cvt_pk_bf16_f32 v6, v152, v153
v_cvt_pk_bf16_f32 v7, v154, v155
v_cvt_pk_bf16_f32 v8, v156, v157
v_cvt_pk_bf16_f32 v9, v158, v159
v_cvt_pk_bf16_f32 v10, v160, v161
v_cvt_pk_bf16_f32 v11, v162, v163
s_nop 1
v_permlane32_swap_b32 v4, v6
v_permlane32_swap_b32 v5, v7
v_permlane32_swap_b32 v8, v10
v_permlane32_swap_b32 v9, v11
s_nop 1
v_permlane16_swap_b32 v4, v8
v_permlane16_swap_b32 v5, v9
v_permlane16_swap_b32 v6, v10
v_permlane16_swap_b32 v7, v11
s_nop 0
buffer_store_dwordx4 v[4:7], v231, s[68:71], s72 offen sc1
buffer_store_dwordx4 v[8:11], v231, s[68:71], s74 offen sc1
s_and_b32 s30, s75, 3
s_and_b32 s3, s2, 7
s_lshr_b32 s4, s2, 3
s_and_b32 s28, s3, 1
s_lshl_b32 s28, s28, 3
s_and_b32 s5, s4, 7
s_add_u32 s28, s28, s5
s_lshr_b32 s29, s3, 1
s_lshl_b32 s29, s29, 2
s_lshr_b32 s5, s4, 3
s_add_u32 s29, s29, s5
s_lshl_b32 s3, s28, 4
s_add_u32 s3, s3, s29
s_lshl_b32 s3, s3, 3
s_add_u32 s3, s3, s75
s_lshl_b32 s3, s3, 2
s_add_u32 s3, s3, 16384
v_mov_b32 v220, s100
s_mov_b64 exec, 1
s_waitcnt vmcnt(0)
buffer_store_dword v220, off, s[96:99], s3 sc1
s_mov_b64 exec, -1
s_cmp_ge_u32 s75, 4
s_cbranch_scc1 Lld3
s_setprio 3
s_and_b32 s3, s2, 7
s_lshr_b32 s4, s2, 3
s_and_b32 s28, s3, 3
s_lshl_b32 s28, s28, 2
s_and_b32 s5, s4, 3
s_add_u32 s28, s28, s5
s_lshr_b32 s29, s3, 2
s_lshl_b32 s29, s29, 3
s_lshr_b32 s5, s4, 2
s_add_u32 s29, s29, s5
s_mov_b32 s62, s30
s_mov_b32 s63, 0
s_mul_i32 s5, s62, 4096
v_bfe_u32 v20, v2, 1, 3
v_xor_b32 v20, v20, v3
v_lshlrev_b32 v20, 4, v20
v_lshl_add_u32 v20, v2, 7, v20
v_add_u32 v4, s5, v20
v_xor_b32 v5, 64, v4
v_bfe_u32 v20, v1, 2, 3
v_bfe_u32 v21, v1, 5, 1
v_lshl_add_u32 v21, v21, 4, v20
v_mul_u32_u24 v21, 128, v21
v_and_b32 v22, 3, v1
v_lshl_add_u32 v21, v22, 3, v21
v_add_u32 v21, 65536, v21
s_mul_i32 s5, s63, 4
v_bfe_u32 v22, v20, 1, 2
s_add_u32 s6, s5, 0
v_xor_b32 v23, s6, v22
v_lshl_add_u32 v8, v23, 5, v21
s_add_u32 s6, s5, 1
v_xor_b32 v23, s6, v22
v_lshl_add_u32 v9, v23, 5, v21
s_add_u32 s6, s5, 2
v_xor_b32 v23, s6, v22
v_lshl_add_u32 v10, v23, 5, v21
s_add_u32 s6, s5, 3
v_xor_b32 v23, s6, v22
v_lshl_add_u32 v11, v23, 5, v21
s_barrier
s_mov_b32 s8, s48
s_mov_b32 s9, s49
s_mov_b32 s10, 7340032
s_mov_b32 s11, 0x00020000
s_add_u32 s12, s60, 50331648
s_addc_u32 s13, s61, 0
s_mov_b32 s14, 229376
s_mov_b32 s15, 0x00020000
v_and_b32 v20, 7, v1
v_min_u32 v20, 6, v20
s_mul_i32 s4, s30, 7
v_add_u32 v20, s4, v20
v_lshrrev_b32 v21, 3, v1
v_mul_u32_u24 v21, 7168, v21
v_lshl_add_u32 v21, v20, 4, v21
v_lshlrev_b32 v20, 5, v20
s_mul_i32 s4, s29, 448
s_mul_i32 s5, s28, 458752
s_add_u32 s5, s5, s4
s_mul_i32 s4, s29, 896
s_mul_i32 s7, s28, 14336
s_add_u32 s7, s7, s4
buffer_load_dwordx4 v[24:27], v21, s[8:11], s5 offen
s_add_u32 s5, s5, 57344
buffer_load_dwordx4 v[28:31], v21, s[8:11], s5 offen
s_add_u32 s5, s5, 57344
buffer_load_dwordx4 v[32:35], v21, s[8:11], s5 offen
s_add_u32 s5, s5, 57344
buffer_load_dwordx4 v[36:39], v21, s[8:11], s5 offen
s_add_u32 s5, s5, 57344
buffer_load_dwordx4 v[40:43], v21, s[8:11], s5 offen
s_add_u32 s5, s5, 57344
buffer_load_dwordx4 v[44:47], v21, s[8:11], s5 offen
s_add_u32 s5, s5, 57344
buffer_load_dwordx4 v[48:51], v21, s[8:11], s5 offen
s_add_u32 s5, s5, 57344
buffer_load_dwordx4 v[52:55], v21, s[8:11], s5 offen
s_add_u32 s5, s5, 57344
s_waitcnt vmcnt(7)
v_lshlrev_b32 v56, 16, v24
v_and_b32 v57, 0xffff0000, v24
v_lshlrev_b32 v58, 16, v25
v_and_b32 v59, 0xffff0000, v25
v_lshlrev_b32 v60, 16, v26
v_and_b32 v61, 0xffff0000, v26
v_lshlrev_b32 v62, 16, v27
v_and_b32 v63, 0xffff0000, v27
s_waitcnt vmcnt(6)
v_lshlrev_b32 v64, 16, v28
v_and_b32 v65, 0xffff0000, v28
v_lshlrev_b32 v66, 16, v29
v_and_b32 v67, 0xffff0000, v29
v_lshlrev_b32 v68, 16, v30
v_and_b32 v69, 0xffff0000, v30
v_lshlrev_b32 v70, 16, v31
v_and_b32 v71, 0xffff0000, v31
v_pk_add_f32 v[56:57], v[56:57], v[64:65]
v_pk_add_f32 v[58:59], v[58:59], v[66:67]
v_pk_add_f32 v[60:61], v[60:61], v[68:69]
v_pk_add_f32 v[62:63], v[62:63], v[70:71]
s_waitcnt vmcnt(5)
v_lshlrev_b32 v64, 16, v32
v_and_b32 v65, 0xffff0000, v32
v_lshlrev_b32 v66, 16, v33
v_and_b32 v67, 0xffff0000, v33
v_lshlrev_b32 v68, 16, v34
v_and_b32 v69, 0xffff0000, v34
v_lshlrev_b32 v70, 16, v35
v_and_b32 v71, 0xffff0000, v35
v_pk_add_f32 v[56:57], v[56:57], v[64:65]
v_pk_add_f32 v[58:59], v[58:59], v[66:67]
v_pk_add_f32 v[60:61], v[60:61], v[68:69]
v_pk_add_f32 v[62:63], v[62:63], v[70:71]
s_waitcnt vmcnt(4)
v_lshlrev_b32 v64, 16, v36
v_and_b32 v65, 0xffff0000, v36
v_lshlrev_b32 v66, 16, v37
v_and_b32 v67, 0xffff0000, v37
v_lshlrev_b32 v68, 16, v38
v_and_b32 v69, 0xffff0000, v38
v_lshlrev_b32 v70, 16, v39
v_and_b32 v71, 0xffff0000, v39
v_pk_add_f32 v[56:57], v[56:57], v[64:65]
v_pk_add_f32 v[58:59], v[58:59], v[66:67]
v_pk_add_f32 v[60:61], v[60:61], v[68:69]
v_pk_add_f32 v[62:63], v[62:63], v[70:71]
s_waitcnt vmcnt(3)
v_lshlrev_b32 v64, 16, v40
v_and_b32 v65, 0xffff0000, v40
v_lshlrev_b32 v66, 16, v41
v_and_b32 v67, 0xffff0000, v41
v_lshlrev_b32 v68, 16, v42
v_and_b32 v69, 0xffff0000, v42
v_lshlrev_b32 v70, 16, v43
v_and_b32 v71, 0xffff0000, v43
v_pk_add_f32 v[56:57], v[56:57], v[64:65]
v_pk_add_f32 v[58:59], v[58:59], v[66:67]
v_pk_add_f32 v[60:61], v[60:61], v[68:69]
v_pk_add_f32 v[62:63], v[62:63], v[70:71]
s_waitcnt vmcnt(2)
v_lshlrev_b32 v64, 16, v44
v_and_b32 v65, 0xffff0000, v44
v_lshlrev_b32 v66, 16, v45
v_and_b32 v67, 0xffff0000, v45
v_lshlrev_b32 v68, 16, v46
v_and_b32 v69, 0xffff0000, v46
v_lshlrev_b32 v70, 16, v47
v_and_b32 v71, 0xffff0000, v47
v_pk_add_f32 v[56:57], v[56:57], v[64:65]
v_pk_add_f32 v[58:59], v[58:59], v[66:67]
v_pk_add_f32 v[60:61], v[60:61], v[68:69]
v_pk_add_f32 v[62:63], v[62:63], v[70:71]
s_waitcnt vmcnt(1)
v_lshlrev_b32 v64, 16, v48
v_and_b32 v65, 0xffff0000, v48
v_lshlrev_b32 v66, 16, v49
v_and_b32 v67, 0xffff0000, v49
v_lshlrev_b32 v68, 16, v50
v_and_b32 v69, 0xffff0000, v50
v_lshlrev_b32 v70, 16, v51
v_and_b32 v71, 0xffff0000, v51
v_pk_add_f32 v[56:57], v[56:57], v[64:65]
v_pk_add_f32 v[58:59], v[58:59], v[66:67]
v_pk_add_f32 v[60:61], v[60:61], v[68:69]
v_pk_add_f32 v[62:63], v[62:63], v[70:71]
s_waitcnt vmcnt(0)
v_lshlrev_b32 v64, 16, v52
v_and_b32 v65, 0xffff0000, v52
v_lshlrev_b32 v66, 16, v53
v_and_b32 v67, 0xffff0000, v53
v_lshlrev_b32 v68, 16, v54
v_and_b32 v69, 0xffff0000, v54
v_lshlrev_b32 v70, 16, v55
v_and_b32 v71, 0xffff0000, v55
v_pk_add_f32 v[56:57], v[56:57], v[64:65]
v_pk_add_f32 v[58:59], v[58:59], v[66:67]
v_pk_add_f32 v[60:61], v[60:61], v[68:69]
v_pk_add_f32 v[62:63], v[62:63], v[70:71]
s_nop 1
v_add_f32_dpp v56, v56, v56 row_ror:8 row_mask:0xf bank_mask:0xf
v_add_f32_dpp v57, v57, v57 row_ror:8 row_mask:0xf bank_mask:0xf
v_add_f32_dpp v58, v58, v58 row_ror:8 row_mask:0xf bank_mask:0xf
v_add_f32_dpp v59, v59, v59 row_ror:8 row_mask:0xf bank_mask:0xf
v_add_f32_dpp v60, v60, v60 row_ror:8 row_mask:0xf bank_mask:0xf
v_add_f32_dpp v61, v61, v61 row_ror:8 row_mask:0xf bank_mask:0xf
v_add_f32_dpp v62, v62, v62 row_ror:8 row_mask:0xf bank_mask:0xf
v_add_f32_dpp v63, v63, v63 row_ror:8 row_mask:0xf bank_mask:0xf
v_mov_b32 v64, v56
v_mov_b32 v65, v57
v_mov_b32 v66, v58
v_mov_b32 v67, v59
v_mov_b32 v68, v60
v_mov_b32 v69, v61
v_mov_b32 v70, v62
v_mov_b32 v71, v63
s_nop 1
v_permlane16_swap_b32 v56, v64
v_permlane16_swap_b32 v57, v65
v_permlane16_swap_b32 v58, v66
v_permlane16_swap_b32 v59, v67
v_permlane16_swap_b32 v60, v68
v_permlane16_swap_b32 v61, v69
v_permlane16_swap_b32 v62, v70
v_permlane16_swap_b32 v63, v71
s_nop 1
v_add_f32 v56, v56, v64
v_add_f32 v57, v57, v65
v_add_f32 v58, v58, v66
v_add_f32 v59, v59, v67
v_add_f32 v60, v60, v68
v_add_f32 v61, v61, v69
v_add_f32 v62, v62, v70
v_add_f32 v63, v63, v71
v_mov_b32 v64, v56
v_mov_b32 v65, v57
v_mov_b32 v66, v58
v_mov_b32 v67, v59
v_mov_b32 v68, v60
v_mov_b32 v69, v61
v_mov_b32 v70, v62
v_mov_b32 v71, v63
s_nop 1
v_permlane32_swap_b32 v56, v64
v_permlane32_swap_b32 v57, v65
v_permlane32_swap_b32 v58, v66
v_permlane32_swap_b32 v59, v67
v_permlane32_swap_b32 v60, v68
v_permlane32_swap_b32 v61, v69
v_permlane32_swap_b32 v62, v70
v_permlane32_swap_b32 v63, v71
s_nop 1
v_add_f32 v56, v56, v64
v_add_f32 v57, v57, v65
v_add_f32 v58, v58, v66
v_add_f32 v59, v59, v67
v_add_f32 v60, v60, v68
v_add_f32 v61, v61, v69
v_add_f32 v62, v62, v70
v_add_f32 v63, v63, v71
s_mov_b64 exec, 127
buffer_store_dwordx4 v[56:59], v20, s[12:15], s7 offen offset:0 sc1
buffer_store_dwordx4 v[60:63], v20, s[12:15], s7 offen offset:16 sc1
s_mov_b64 exec, -1
s_add_u32 s16, s60, 20971520
s_addc_u32 s17, s61, 0
s_mov_b32 s18, 4194304
s_mov_b32 s19, 0x00020000
s_mov_b32 s20, s40
s_mov_b32 s21, s41
s_mov_b32 s22, 4194304
s_mov_b32 s23, 0x00020000
s_lshl_b32 s3, s29, 18
s_lshl_b32 s4, s28, 13
s_add_u32 s3, s3, s4
s_lshl_b32 s4, s30, 11
s_add_u32 s64, s3, s4
s_add_u32 s65, s64, 0x20000
v_and_b32 v20, 1, v3
v_lshrrev_b32 v21, 1, v3
v_lshl_add_u32 v20, v20, 1, v21
v_mul_u32_u24 v120, 16, v20
v_mul_u32_u24 v121, 8, v3
v_mul_u32_u24 v20, 64, v2
v_add_u32 v120, v120, v20
v_lshrrev_b32 v20, 0, v20
v_add_u32 v121, v121, v20
s_lshl_b32 s3, s28, 18
s_lshl_b32 s4, s30, 16
s_add_u32 s3, s3, s4
s_lshl_b32 s4, s29, 7
s_add_u32 s68, s3, s4
s_add_u32 s69, s68, 0x8000
v_and_b32 v20, 1, v3
v_lshrrev_b32 v21, 1, v3
v_lshl_add_u32 v20, v20, 1, v21
v_mul_u32_u24 v122, 16, v20
v_mul_u32_u24 v123, 8, v3
v_mul_u32_u24 v20, 2048, v2
v_add_u32 v122, v122, v20
v_lshrrev_b32 v20, 0, v20
v_add_u32 v123, v123, v20
buffer_load_dwordx4 v[104:107], v122, s[20:23], s68 offen offset:0 sc1
buffer_load_dwordx4 v[108:111], v122, s[20:23], s68 offen offset:64 sc1
buffer_load_dwordx4 v[112:115], v122, s[20:23], s69 offen offset:0 sc1
buffer_load_dwordx4 v[116:119], v122, s[20:23], s69 offen offset:64 sc1
v_lshlrev_b32 v20, 7, v1
s_lshl_b32 s88, s2, 2
s_add_u32 s88, s88, s30
v_mov_b64 v[24:25], 0
v_mov_b64 v[26:27], 0
v_mov_b64 v[28:29], 0
v_mov_b64 v[30:31], 0
v_mov_b64 v[32:33], 0
v_mov_b64 v[34:35], 0
v_mov_b64 v[36:37], 0
v_mov_b64 v[38:39], 0
v_mov_b64 v[40:41], 0
v_mov_b64 v[42:43], 0
v_mov_b64 v[44:45], 0
v_mov_b64 v[46:47], 0
v_mov_b64 v[48:49], 0
v_mov_b64 v[50:51], 0
v_mov_b64 v[52:53], 0
v_mov_b64 v[54:55], 0
s_mov_b32 s33, 16
s_mov_b32 s34, 0
s_mov_b32 s35, 0
v_add_u32 v16, s35, v8
v_add_u32 v17, s35, v9
v_add_u32 v18, s35, v10
v_add_u32 v19, s35, v11
v_add_u32 v12, s34, v4
v_add_u32 v13, s34, v5
s_barrier
s_barrier
ds_read_b64_tr_b16 v[64:65], v16 offset:0
ds_read_b64_tr_b16 v[66:67], v16 offset:1024
ds_read_b128 v[56:59], v12 offset:0
ds_read_b128 v[60:63], v12 offset:2048
ds_read_b64_tr_b16 v[68:69], v17 offset:0
ds_read_b64_tr_b16 v[70:71], v17 offset:1024
ds_read_b64_tr_b16 v[72:73], v18 offset:0
ds_read_b64_tr_b16 v[74:75], v18 offset:1024
ds_read_b64_tr_b16 v[76:77], v19 offset:0
ds_read_b64_tr_b16 v[78:79], v19 offset:1024
s_setprio 0
Lp3_loop:
s_waitcnt lgkmcnt(0)
v_mfma_f32_16x16x32_bf16 v[24:27], v[64:67], v[56:59], v[24:27]
ds_read_b64_tr_b16 v[88:89], v16 offset:4096
ds_read_b64_tr_b16 v[90:91], v16 offset:5120
ds_read_b128 v[80:83], v13 offset:0
v_mfma_f32_16x16x32_bf16 v[40:43], v[64:67], v[60:63], v[40:43]
ds_read_b128 v[84:87], v13 offset:2048
ds_read_b64_tr_b16 v[92:93], v17 offset:4096
ds_read_b64_tr_b16 v[94:95], v17 offset:5120
v_mfma_f32_16x16x32_bf16 v[28:31], v[68:71], v[56:59], v[28:31]
ds_read_b64_tr_b16 v[96:97], v18 offset:4096
ds_read_b64_tr_b16 v[98:99], v18 offset:5120
v_mfma_f32_16x16x32_bf16 v[44:47], v[68:71], v[60:63], v[44:47]
ds_read_b64_tr_b16 v[100:101], v19 offset:4096
ds_read_b64_tr_b16 v[102:103], v19 offset:5120
v_mfma_f32_16x16x32_bf16 v[32:35], v[72:75], v[56:59], v[32:35]
s_add_u32 s34, s34, 16384
s_cmp_eq_u32 s34, 65536
s_cselect_b32 s34, 0, s34
s_add_u32 s35, s35, 8192
s_cmp_eq_u32 s35, 98304
s_cselect_b32 s35, 0, s35
v_mfma_f32_16x16x32_bf16 v[48:51], v[72:75], v[60:63], v[48:51]
v_add_u32 v16, s35, v8
v_add_u32 v17, s35, v9
v_mfma_f32_16x16x32_bf16 v[36:39], v[76:79], v[56:59], v[36:39]
v_add_u32 v18, s35, v10
v_add_u32 v19, s35, v11
v_mfma_f32_16x16x32_bf16 v[52:55], v[76:79], v[60:63], v[52:55]
v_add_u32 v12, s34, v4
v_add_u32 v13, s34, v5
s_waitcnt lgkmcnt(0)
v_mfma_f32_16x16x32_bf16 v[24:27], v[88:91], v[80:83], v[24:27]
s_barrier
v_mfma_f32_16x16x32_bf16 v[40:43], v[88:91], v[84:87], v[40:43]
ds_read_b64_tr_b16 v[64:65], v16 offset:0
ds_read_b64_tr_b16 v[66:67], v16 offset:1024
v_mfma_f32_16x16x32_bf16 v[28:31], v[92:95], v[80:83], v[28:31]
ds_read_b128 v[56:59], v12 offset:0
ds_read_b128 v[60:63], v12 offset:2048
v_mfma_f32_16x16x32_bf16 v[44:47], v[92:95], v[84:87], v[44:47]
ds_read_b64_tr_b16 v[68:69], v17 offset:0
ds_read_b64_tr_b16 v[70:71], v17 offset:1024
v_mfma_f32_16x16x32_bf16 v[32:35], v[96:99], v[80:83], v[32:35]
ds_read_b64_tr_b16 v[72:73], v18 offset:0
ds_read_b64_tr_b16 v[74:75], v18 offset:1024
v_mfma_f32_16x16x32_bf16 v[48:51], v[96:99], v[84:87], v[48:51]
ds_read_b64_tr_b16 v[76:77], v19 offset:0
ds_read_b64_tr_b16 v[78:79], v19 offset:1024
v_mfma_f32_16x16x32_bf16 v[36:39], v[100:103], v[80:83], v[36:39]
s_sub_u32 s33, s33, 1
s_cmp_lg_u32 s33, 0
v_mfma_f32_16x16x32_bf16 v[52:55], v[100:103], v[84:87], v[52:55]
s_cbranch_scc1 Lp3_loop
s_waitcnt lgkmcnt(0)
s_nop 7
s_setprio 3
s_waitcnt vmcnt(0)
s_lshl_b32 s3, s28, 4
s_add_u32 s3, s3, s29
s_lshl_b32 s3, s3, 3
s_add_u32 s3, s3, s30
s_lshl_b32 s3, s3, 2
s_add_u32 s3, s3, 0
v_mov_b32 v20, s100
s_mov_b64 exec, 1
s_waitcnt vmcnt(0)
buffer_store_dword v20, off, s[96:99], s3 sc1
s_mov_b64 exec, -1
s_add_u32 s24, s60, 51380224
s_addc_u32 s25, s61, 0
s_mov_b32 s26, 262144
s_mov_b32 s27, 0x00020000
s_lshl_b32 s3, s28, 14
s_lshl_b32 s4, s30, 12
s_add_u32 s3, s3, s4
s_lshl_b32 s4, s29, 8
s_add_u32 s66, s3, s4
v_lshlrev_b32 v92, 3, v1
v_permlane16_swap_b32 v24, v28
v_permlane16_swap_b32 v25, v29
v_permlane16_swap_b32 v26, v30
v_permlane16_swap_b32 v27, v31
v_permlane16_swap_b32 v32, v36
v_permlane16_swap_b32 v33, v37
v_permlane16_swap_b32 v34, v38
v_permlane16_swap_b32 v35, v39
s_nop 1
v_lshlrev_b32 v56, 16, v104
v_and_b32 v57, 0xffff0000, v104
v_lshlrev_b32 v58, 16, v105
v_and_b32 v59, 0xffff0000, v105
v_lshlrev_b32 v60, 16, v106
v_and_b32 v61, 0xffff0000, v106
v_lshlrev_b32 v62, 16, v107
v_and_b32 v63, 0xffff0000, v107
v_pk_add_f32 v[24:25], v[24:25], v[56:57]
v_pk_mul_f32 v[82:83], v[24:25], v[24:25]
v_mov_b32 v80, v24
v_mov_b32 v81, v25
v_pk_add_f32 v[26:27], v[26:27], v[58:59]
v_pk_fma_f32 v[82:83], v[26:27], v[26:27], v[82:83]
v_pk_add_f32 v[80:81], v[80:81], v[26:27]
v_pk_add_f32 v[28:29], v[28:29], v[60:61]
v_pk_fma_f32 v[82:83], v[28:29], v[28:29], v[82:83]
v_pk_add_f32 v[80:81], v[80:81], v[28:29]
v_pk_add_f32 v[30:31], v[30:31], v[62:63]
v_pk_fma_f32 v[82:83], v[30:31], v[30:31], v[82:83]
v_pk_add_f32 v[80:81], v[80:81], v[30:31]
v_cvt_pk_bf16_f32 v24, v24, v25
v_cvt_pk_bf16_f32 v25, v26, v27
v_cvt_pk_bf16_f32 v26, v28, v29
v_cvt_pk_bf16_f32 v27, v30, v31
buffer_store_dwordx4 v[24:27], v120, s[16:19], s64 offen offset:0  sc1
v_lshlrev_b32 v56, 16, v108
v_and_b32 v57, 0xffff0000, v108
v_lshlrev_b32 v58, 16, v109
v_and_b32 v59, 0xffff0000, v109
v_lshlrev_b32 v60, 16, v110
v_and_b32 v61, 0xffff0000, v110
v_lshlrev_b32 v62, 16, v111
v_and_b32 v63, 0xffff0000, v111
v_pk_add_f32 v[32:33], v[32:33], v[56:57]
v_pk_fma_f32 v[82:83], v[32:33], v[32:33], v[82:83]
v_pk_add_f32 v[80:81], v[80:81], v[32:33]
v_pk_add_f32 v[34:35], v[34:35], v[58:59]
v_pk_fma_f32 v[82:83], v[34:35], v[34:35], v[82:83]
v_pk_add_f32 v[80:81], v[80:81], v[34:35]
v_pk_add_f32 v[36:37], v[36:37], v[60:61]
v_pk_fma_f32 v[82:83], v[36:37], v[36:37], v[82:83]
v_pk_add_f32 v[80:81], v[80:81], v[36:37]
v_pk_add_f32 v[38:39], v[38:39], v[62:63]
v_pk_fma_f32 v[82:83], v[38:39], v[38:39], v[82:83]
v_pk_add_f32 v[80:81], v[80:81], v[38:39]
v_cvt_pk_bf16_f32 v32, v32, v33
v_cvt_pk_bf16_f32 v33, v34, v35
v_cvt_pk_bf16_f32 v34, v36, v37
v_cvt_pk_bf16_f32 v35, v38, v39
buffer_store_dwordx4 v[32:35], v120, s[16:19], s65 offen offset:0  sc1
v_permlane16_swap_b32 v40, v44
v_permlane16_swap_b32 v41, v45
v_permlane16_swap_b32 v42, v46
v_permlane16_swap_b32 v43, v47
v_permlane16_swap_b32 v48, v52
v_permlane16_swap_b32 v49, v53
v_permlane16_swap_b32 v50, v54
v_permlane16_swap_b32 v51, v55
s_nop 1
v_lshlrev_b32 v56, 16, v112
v_and_b32 v57, 0xffff0000, v112
v_lshlrev_b32 v58, 16, v113
v_and_b32 v59, 0xffff0000, v113
v_lshlrev_b32 v60, 16, v114
v_and_b32 v61, 0xffff0000, v114
v_lshlrev_b32 v62, 16, v115
v_and_b32 v63, 0xffff0000, v115
v_pk_add_f32 v[40:41], v[40:41], v[56:57]
v_pk_mul_f32 v[86:87], v[40:41], v[40:41]
v_mov_b32 v84, v40
v_mov_b32 v85, v41
v_pk_add_f32 v[42:43], v[42:43], v[58:59]
v_pk_fma_f32 v[86:87], v[42:43], v[42:43], v[86:87]
v_pk_add_f32 v[84:85], v[84:85], v[42:43]
v_pk_add_f32 v[44:45], v[44:45], v[60:61]
v_pk_fma_f32 v[86:87], v[44:45], v[44:45], v[86:87]
v_pk_add_f32 v[84:85], v[84:85], v[44:45]
v_pk_add_f32 v[46:47], v[46:47], v[62:63]
v_pk_fma_f32 v[86:87], v[46:47], v[46:47], v[86:87]
v_pk_add_f32 v[84:85], v[84:85], v[46:47]
v_cvt_pk_bf16_f32 v40, v40, v41
v_cvt_pk_bf16_f32 v41, v42, v43
v_cvt_pk_bf16_f32 v42, v44, v45
v_cvt_pk_bf16_f32 v43, v46, v47
buffer_store_dwordx4 v[40:43], v120, s[16:19], s64 offen offset:1024  sc1
v_lshlrev_b32 v56, 16, v116
v_and_b32 v57, 0xffff0000, v116
v_lshlrev_b32 v58, 16, v117
v_and_b32 v59, 0xffff0000, v117
v_lshlrev_b32 v60, 16, v118
v_and_b32 v61, 0xffff0000, v118
v_lshlrev_b32 v62, 16, v119
v_and_b32 v63, 0xffff0000, v119
v_pk_add_f32 v[48:49], v[48:49], v[56:57]
v_pk_fma_f32 v[86:87], v[48:49], v[48:49], v[86:87]
v_pk_add_f32 v[84:85], v[84:85], v[48:49]
v_pk_add_f32 v[50:51], v[50:51], v[58:59]
v_pk_fma_f32 v[86:87], v[50:51], v[50:51], v[86:87]
v_pk_add_f32 v[84:85], v[84:85], v[50:51]
v_pk_add_f32 v[52:53], v[52:53], v[60:61]
v_pk_fma_f32 v[86:87], v[52:53], v[52:53], v[86:87]
v_pk_add_f32 v[84:85], v[84:85], v[52:53]
v_pk_add_f32 v[54:55], v[54:55], v[62:63]
v_pk_fma_f32 v[86:87], v[54:55], v[54:55], v[86:87]
v_pk_add_f32 v[84:85], v[84:85], v[54:55]
v_cvt_pk_bf16_f32 v48, v48, v49
v_cvt_pk_bf16_f32 v49, v50, v51
v_cvt_pk_bf16_f32 v50, v52, v53
v_cvt_pk_bf16_f32 v51, v54, v55
buffer_store_dwordx4 v[48:51], v120, s[16:19], s65 offen offset:1024  sc1
v_add_f32 v80, v80, v81
v_add_f32 v81, v82, v83
v_add_f32 v84, v84, v85
v_add_f32 v85, v86, v87
v_mov_b32 v56, v80
v_mov_b32 v57, v81
v_mov_b32 v58, v84
v_mov_b32 v59, v85
s_nop 1
v_permlane16_swap_b32 v80, v56
v_permlane16_swap_b32 v81, v57
v_permlane16_swap_b32 v84, v58
v_permlane16_swap_b32 v85, v59
s_nop 1
v_add_f32 v80, v80, v56
v_add_f32 v81, v81, v57
v_add_f32 v84, v84, v58
v_add_f32 v85, v85, v59
v_mov_b32 v56, v80
v_mov_b32 v57, v81
v_mov_b32 v58, v84
v_mov_b32 v59, v85
s_nop 1
v_permlane32_swap_b32 v80, v56
v_permlane32_swap_b32 v81, v57
v_permlane32_swap_b32 v84, v58
v_permlane32_swap_b32 v85, v59
s_nop 1
v_add_f32 v80, v80, v56
v_add_f32 v81, v81, v57
v_add_f32 v84, v84, v58
v_add_f32 v85, v85, v59
v_cmp_eq_u32 vcc, 1, v3
s_nop 1
v_cndmask_b32 v80, v80, v84, vcc
v_cndmask_b32 v81, v81, v85, vcc
s_mov_b32 exec_hi, 0
buffer_store_dwordx2 v[80:81], v92, s[24:27], s66 offen sc1
s_mov_b64 exec, -1
s_barrier
s_lshl_b32 s3, s28, 4
s_add_u32 s3, s3, s29
s_lshl_b32 s3, s3, 3
s_add_u32 s3, s3, s30
s_lshl_b32 s3, s3, 2
s_add_u32 s3, s3, 24576
v_mov_b32 v20, s100
s_mov_b64 exec, 1
s_waitcnt vmcnt(0)
buffer_store_dword v20, off, s[96:99], s3 sc1
s_mov_b64 exec, -1
s_and_b32 s3, s2, 7
s_lshr_b32 s4, s2, 3
s_and_b32 s28, s3, 1
s_lshl_b32 s28, s28, 3
s_and_b32 s5, s4, 7
s_add_u32 s28, s28, s5
s_lshr_b32 s29, s3, 1
s_lshl_b32 s29, s29, 2
s_lshr_b32 s5, s4, 3
s_add_u32 s29, s29, s5
s_lshr_b32 s62, s30, 1
s_and_b32 s63, s30, 1
s_mul_i32 s5, s62, 8192
v_bfe_u32 v12, v2, 1, 3
v_xor_b32 v12, v12, v3
v_lshlrev_b32 v12, 4, v12
v_lshl_add_u32 v12, v2, 7, v12
v_add_u32 v4, s5, v12
v_xor_b32 v5, 64, v4
v_bfe_u32 v12, v1, 2, 3
v_bfe_u32 v13, v1, 5, 1
v_lshl_add_u32 v13, v13, 4, v12
v_mul_u32_u24 v13, 448, v13
v_and_b32 v14, 3, v1
v_lshl_add_u32 v13, v14, 3, v13
v_add_u32 v13, 49152, v13
s_mul_i32 s5, s63, 7
v_bfe_u32 v14, v12, 2, 1
s_add_u32 s6, s5, 0
v_xor_b32 v15, s6, v14
v_lshl_add_u32 v6, v15, 5, v13
s_add_u32 s6, s5, 1
v_xor_b32 v15, s6, v14
v_lshl_add_u32 v7, v15, 5, v13
s_add_u32 s16, s60, 33554432
s_addc_u32 s17, s61, 0
s_mov_b32 s18, 7340032
s_mov_b32 s19, 0x00020000
s_add_u32 s24, s60, 52428800
s_addc_u32 s25, s61, 0
s_mov_b32 s26, 262144
s_mov_b32 s27, 0x00020000
s_lshr_b32 s3, s29, 1
s_mul_i32 s3, s3, 917504
s_lshl_b32 s4, s28, 12
s_lshl_b32 s5, s30, 10
s_add_u32 s5, s5, s4
s_add_u32 s67, s3, s5
s_add_u32 s3, s67, s5
s_and_b32 s4, s29, 1
s_lshl_b32 s5, s4, 16
s_add_u32 s67, s67, s5
s_add_u32 s67, s67, 0x60000
s_lshl_b32 s4, s4, 19
s_add_u32 s64, s3, s4
s_add_u32 s65, s64, 0x20000
s_add_u32 s66, s64, 0x40000
v_and_b32 v12, 1, v3
v_lshrrev_b32 v13, 1, v3
v_lshl_add_u32 v12, v12, 1, v13
v_mul_u32_u24 v220, 16, v12
v_mul_u32_u24 v221, 8, v3
v_mul_u32_u24 v12, 64, v2
v_add_u32 v220, v220, v12
v_lshrrev_b32 v12, 1, v12
v_add_u32 v221, v221, v12
s_lshl_b32 s3, s28, 14
s_lshl_b32 s4, s30, 12
s_add_u32 s68, s3, s4
s_lshl_b32 s3, s29, 8
s_add_u32 s69, s68, s3
v_lshlrev_b32 v12, 7, v1
s_lshl_b32 s88, s2, 2
s_add_u32 s88, s88, s30
v_mov_b64 v[16:17], 0
v_mov_b64 v[18:19], 0
v_mov_b64 v[20:21], 0
v_mov_b64 v[22:23], 0
v_mov_b64 v[24:25], 0
v_mov_b64 v[26:27], 0
v_mov_b64 v[28:29], 0
v_mov_b64 v[30:31], 0
v_mov_b64 v[32:33], 0
v_mov_b64 v[34:35], 0
v_mov_b64 v[36:37], 0
v_mov_b64 v[38:39], 0
v_mov_b64 v[40:41], 0
v_mov_b64 v[42:43], 0
v_mov_b64 v[44:45], 0
v_mov_b64 v[46:47], 0
v_mov_b64 v[48:49], 0
v_mov_b64 v[50:51], 0
v_mov_b64 v[52:53], 0
v_mov_b64 v[54:55], 0
v_mov_b64 v[56:57], 0
v_mov_b64 v[58:59], 0
v_mov_b64 v[60:61], 0
v_mov_b64 v[62:63], 0
v_mov_b64 v[64:65], 0
v_mov_b64 v[66:67], 0
v_mov_b64 v[68:69], 0
v_mov_b64 v[70:71], 0
v_mov_b64 v[72:73], 0
v_mov_b64 v[74:75], 0
v_mov_b64 v[76:77], 0
v_mov_b64 v[78:79], 0
v_mov_b64 v[80:81], 0
v_mov_b64 v[82:83], 0
v_mov_b64 v[84:85], 0
v_mov_b64 v[86:87], 0
v_mov_b64 v[88:89], 0
v_mov_b64 v[90:91], 0
v_mov_b64 v[92:93], 0
v_mov_b64 v[94:95], 0
v_mov_b64 v[96:97], 0
v_mov_b64 v[98:99], 0
v_mov_b64 v[100:101], 0
v_mov_b64 v[102:103], 0
v_mov_b64 v[104:105], 0
v_mov_b64 v[106:107], 0
v_mov_b64 v[108:109], 0
v_mov_b64 v[110:111], 0
v_mov_b64 v[112:113], 0
v_mov_b64 v[114:115], 0
v_mov_b64 v[116:117], 0
v_mov_b64 v[118:119], 0
v_mov_b64 v[120:121], 0
v_mov_b64 v[122:123], 0
v_mov_b64 v[124:125], 0
v_mov_b64 v[126:127], 0
s_mov_b32 s33, 16
s_mov_b32 s34, 0
s_mov_b32 s35, 0
v_add_u32 v10, s35, v6
v_add_u32 v11, s35, v7
v_add_u32 v8, s34, v4
v_add_u32 v9, s34, v5
s_barrier
s_barrier
ds_read_b64_tr_b16 v[144:145], v10 offset:0
ds_read_b64_tr_b16 v[146:147], v10 offset:3584
ds_read_b128 v[128:131], v8 offset:0
ds_read_b128 v[132:135], v8 offset:2048
ds_read_b128 v[136:139], v8 offset:4096
ds_read_b128 v[140:143], v8 offset:6144
ds_read_b64_tr_b16 v[148:149], v11 offset:0
ds_read_b64_tr_b16 v[150:151], v11 offset:3584
ds_read_b64_tr_b16 v[152:153], v10 offset:64
ds_read_b64_tr_b16 v[154:155], v10 offset:3648
ds_read_b64_tr_b16 v[156:157], v11 offset:64
ds_read_b64_tr_b16 v[158:159], v11 offset:3648
ds_read_b64_tr_b16 v[160:161], v10 offset:128
ds_read_b64_tr_b16 v[162:163], v10 offset:3712
ds_read_b64_tr_b16 v[164:165], v11 offset:128
ds_read_b64_tr_b16 v[166:167], v11 offset:3712
ds_read_b64_tr_b16 v[168:169], v10 offset:192
ds_read_b64_tr_b16 v[170:171], v10 offset:3776
Lp4_loop:
s_waitcnt lgkmcnt(0)
v_mfma_f32_16x16x32_bf16 v[16:19], v[144:147], v[128:131], v[16:19]
ds_read_b64_tr_b16 v[188:189], v10 offset:14336
v_mfma_f32_16x16x32_bf16 v[44:47], v[144:147], v[132:135], v[44:47]
ds_read_b64_tr_b16 v[190:191], v10 offset:17920
v_mfma_f32_16x16x32_bf16 v[72:75], v[144:147], v[136:139], v[72:75]
ds_read_b128 v[172:175], v9 offset:0
v_mfma_f32_16x16x32_bf16 v[100:103], v[144:147], v[140:143], v[100:103]
ds_read_b128 v[176:179], v9 offset:2048
v_mfma_f32_16x16x32_bf16 v[20:23], v[148:151], v[128:131], v[20:23]
ds_read_b128 v[180:183], v9 offset:4096
v_mfma_f32_16x16x32_bf16 v[48:51], v[148:151], v[132:135], v[48:51]
ds_read_b128 v[184:187], v9 offset:6144
v_mfma_f32_16x16x32_bf16 v[76:79], v[148:151], v[136:139], v[76:79]
ds_read_b64_tr_b16 v[192:193], v11 offset:14336
v_mfma_f32_16x16x32_bf16 v[104:107], v[148:151], v[140:143], v[104:107]
ds_read_b64_tr_b16 v[194:195], v11 offset:17920
v_mfma_f32_16x16x32_bf16 v[24:27], v[152:155], v[128:131], v[24:27]
ds_read_b64_tr_b16 v[196:197], v10 offset:14400
v_mfma_f32_16x16x32_bf16 v[52:55], v[152:155], v[132:135], v[52:55]
ds_read_b64_tr_b16 v[198:199], v10 offset:17984
v_mfma_f32_16x16x32_bf16 v[80:83], v[152:155], v[136:139], v[80:83]
ds_read_b64_tr_b16 v[200:201], v11 offset:14400
v_mfma_f32_16x16x32_bf16 v[108:111], v[152:155], v[140:143], v[108:111]
ds_read_b64_tr_b16 v[202:203], v11 offset:17984
v_mfma_f32_16x16x32_bf16 v[28:31], v[156:159], v[128:131], v[28:31]
ds_read_b64_tr_b16 v[204:205], v10 offset:14464
v_mfma_f32_16x16x32_bf16 v[56:59], v[156:159], v[132:135], v[56:59]
ds_read_b64_tr_b16 v[206:207], v10 offset:18048
v_mfma_f32_16x16x32_bf16 v[84:87], v[156:159], v[136:139], v[84:87]
ds_read_b64_tr_b16 v[208:209], v11 offset:14464
v_mfma_f32_16x16x32_bf16 v[112:115], v[156:159], v[140:143], v[112:115]
ds_read_b64_tr_b16 v[210:211], v11 offset:18048
v_mfma_f32_16x16x32_bf16 v[32:35], v[160:163], v[128:131], v[32:35]
ds_read_b64_tr_b16 v[212:213], v10 offset:14528
v_mfma_f32_16x16x32_bf16 v[60:63], v[160:163], v[132:135], v[60:63]
ds_read_b64_tr_b16 v[214:215], v10 offset:18112
v_mfma_f32_16x16x32_bf16 v[88:91], v[160:163], v[136:139], v[88:91]
s_add_u32 s34, s34, 16384
s_cmp_eq_u32 s34, 49152
s_cselect_b32 s34, 0, s34
v_mfma_f32_16x16x32_bf16 v[116:119], v[160:163], v[140:143], v[116:119]
s_add_u32 s35, s35, 28672
s_cmp_eq_u32 s35, 114688
s_cselect_b32 s35, 0, s35
v_mfma_f32_16x16x32_bf16 v[36:39], v[164:167], v[128:131], v[36:39]
v_add_u32 v10, s35, v6
v_mfma_f32_16x16x32_bf16 v[64:67], v[164:167], v[132:135], v[64:67]
v_add_u32 v11, s35, v7
v_mfma_f32_16x16x32_bf16 v[92:95], v[164:167], v[136:139], v[92:95]
v_add_u32 v8, s34, v4
v_mfma_f32_16x16x32_bf16 v[120:123], v[164:167], v[140:143], v[120:123]
v_add_u32 v9, s34, v5
v_mfma_f32_16x16x32_bf16 v[40:43], v[168:171], v[128:131], v[40:43]
v_mfma_f32_16x16x32_bf16 v[68:71], v[168:171], v[132:135], v[68:71]
v_mfma_f32_16x16x32_bf16 v[96:99], v[168:171], v[136:139], v[96:99]
v_mfma_f32_16x16x32_bf16 v[124:127], v[168:171], v[140:143], v[124:127]
s_waitcnt lgkmcnt(0)
v_mfma_f32_16x16x32_bf16 v[16:19], v[188:191], v[172:175], v[16:19]
s_barrier
v_mfma_f32_16x16x32_bf16 v[44:47], v[188:191], v[176:179], v[44:47]
ds_read_b64_tr_b16 v[144:145], v10 offset:0
v_mfma_f32_16x16x32_bf16 v[72:75], v[188:191], v[180:183], v[72:75]
ds_read_b64_tr_b16 v[146:147], v10 offset:3584
v_mfma_f32_16x16x32_bf16 v[100:103], v[188:191], v[184:187], v[100:103]
ds_read_b128 v[128:131], v8 offset:0
v_mfma_f32_16x16x32_bf16 v[20:23], v[192:195], v[172:175], v[20:23]
ds_read_b128 v[132:135], v8 offset:2048
v_mfma_f32_16x16x32_bf16 v[48:51], v[192:195], v[176:179], v[48:51]
ds_read_b128 v[136:139], v8 offset:4096
v_mfma_f32_16x16x32_bf16 v[76:79], v[192:195], v[180:183], v[76:79]
ds_read_b128 v[140:143], v8 offset:6144
v_mfma_f32_16x16x32_bf16 v[104:107], v[192:195], v[184:187], v[104:107]
ds_read_b64_tr_b16 v[148:149], v11 offset:0
v_mfma_f32_16x16x32_bf16 v[24:27], v[196:199], v[172:175], v[24:27]
ds_read_b64_tr_b16 v[150:151], v11 offset:3584
v_mfma_f32_16x16x32_bf16 v[52:55], v[196:199], v[176:179], v[52:55]
ds_read_b64_tr_b16 v[152:153], v10 offset:64
v_mfma_f32_16x16x32_bf16 v[80:83], v[196:199], v[180:183], v[80:83]
ds_read_b64_tr_b16 v[154:155], v10 offset:3648
v_mfma_f32_16x16x32_bf16 v[108:111], v[196:199], v[184:187], v[108:111]
ds_read_b64_tr_b16 v[156:157], v11 offset:64
v_mfma_f32_16x16x32_bf16 v[28:31], v[200:203], v[172:175], v[28:31]
ds_read_b64_tr_b16 v[158:159], v11 offset:3648
v_mfma_f32_16x16x32_bf16 v[56:59], v[200:203], v[176:179], v[56:59]
ds_read_b64_tr_b16 v[160:161], v10 offset:128
v_mfma_f32_16x16x32_bf16 v[84:87], v[200:203], v[180:183], v[84:87]
ds_read_b64_tr_b16 v[162:163], v10 offset:3712
v_mfma_f32_16x16x32_bf16 v[112:115], v[200:203], v[184:187], v[112:115]
ds_read_b64_tr_b16 v[164:165], v11 offset:128
v_mfma_f32_16x16x32_bf16 v[32:35], v[204:207], v[172:175], v[32:35]
ds_read_b64_tr_b16 v[166:167], v11 offset:3712
v_mfma_f32_16x16x32_bf16 v[60:63], v[204:207], v[176:179], v[60:63]
ds_read_b64_tr_b16 v[168:169], v10 offset:192
v_mfma_f32_16x16x32_bf16 v[88:91], v[204:207], v[180:183], v[88:91]
ds_read_b64_tr_b16 v[170:171], v10 offset:3776
v_mfma_f32_16x16x32_bf16 v[116:119], v[204:207], v[184:187], v[116:119]
s_sub_u32 s33, s33, 1
s_cmp_lg_u32 s33, 0
v_mfma_f32_16x16x32_bf16 v[36:39], v[208:211], v[172:175], v[36:39]
v_mfma_f32_16x16x32_bf16 v[64:67], v[208:211], v[176:179], v[64:67]
v_mfma_f32_16x16x32_bf16 v[92:95], v[208:211], v[180:183], v[92:95]
v_mfma_f32_16x16x32_bf16 v[120:123], v[208:211], v[184:187], v[120:123]
v_mfma_f32_16x16x32_bf16 v[40:43], v[212:215], v[172:175], v[40:43]
v_mfma_f32_16x16x32_bf16 v[68:71], v[212:215], v[176:179], v[68:71]
v_mfma_f32_16x16x32_bf16 v[96:99], v[212:215], v[180:183], v[96:99]
v_mfma_f32_16x16x32_bf16 v[124:127], v[212:215], v[184:187], v[124:127]
s_cbranch_scc1 Lp4_loop
s_waitcnt lgkmcnt(0)
s_nop 7
s_lshl_b32 s3, s30, 15
s_add_u32 s3, s3, 16384
v_lshlrev_b32 v202, 4, v1
v_add_u32 v202, s3, v202
v_xor_b32 v203, 0x8000, v202
s_cmp_eq_u32 s63, 0
s_cbranch_scc1 Lp4_s0
ds_write_b128 v202, v[16:19] offset:0
ds_write_b128 v202, v[20:23] offset:1024
ds_write_b128 v202, v[24:27] offset:2048
ds_write_b128 v202, v[28:31] offset:3072
ds_write_b128 v202, v[32:35] offset:4096
ds_write_b128 v202, v[36:39] offset:5120
ds_write_b128 v202, v[40:43] offset:6144
ds_write_b128 v202, v[44:47] offset:7168
ds_write_b128 v202, v[48:51] offset:8192
ds_write_b128 v202, v[52:55] offset:9216
ds_write_b128 v202, v[56:59] offset:10240
ds_write_b128 v202, v[60:63] offset:11264
ds_write_b128 v202, v[64:67] offset:12288
ds_write_b128 v202, v[68:71] offset:13312
s_waitcnt lgkmcnt(0)
s_barrier
ds_read_b128 v[16:19], v203 offset:0
ds_read_b128 v[20:23], v203 offset:1024
ds_read_b128 v[24:27], v203 offset:2048
ds_read_b128 v[28:31], v203 offset:3072
ds_read_b128 v[32:35], v203 offset:4096
ds_read_b128 v[36:39], v203 offset:5120
ds_read_b128 v[40:43], v203 offset:6144
ds_read_b128 v[44:47], v203 offset:7168
ds_read_b128 v[48:51], v203 offset:8192
ds_read_b128 v[52:55], v203 offset:9216
ds_read_b128 v[56:59], v203 offset:10240
ds_read_b128 v[60:63], v203 offset:11264
ds_read_b128 v[64:67], v203 offset:12288
ds_read_b128 v[68:71], v203 offset:13312
s_branch Lp4_s1
Lp4_s0:
ds_write_b128 v202, v[72:75] offset:0
ds_write_b128 v202, v[76:79] offset:1024
ds_write_b128 v202, v[80:83] offset:2048
ds_write_b128 v202, v[84:87] offset:3072
ds_write_b128 v202, v[88:91] offset:4096
ds_write_b128 v202, v[92:95] offset:5120
ds_write_b128 v202, v[96:99] offset:6144
ds_write_b128 v202, v[100:103] offset:7168
ds_write_b128 v202, v[104:107] offset:8192
ds_write_b128 v202, v[108:111] offset:9216
ds_write_b128 v202, v[112:115] offset:10240
ds_write_b128 v202, v[116:119] offset:11264
ds_write_b128 v202, v[120:123] offset:12288
ds_write_b128 v202, v[124:127] offset:13312
s_waitcnt lgkmcnt(0)
s_barrier
ds_read_b128 v[72:75], v203 offset:0
ds_read_b128 v[76:79], v203 offset:1024
ds_read_b128 v[80:83], v203 offset:2048
ds_read_b128 v[84:87], v203 offset:3072
ds_read_b128 v[88:91], v203 offset:4096
ds_read_b128 v[92:95], v203 offset:5120
ds_read_b128 v[96:99], v203 offset:6144
ds_read_b128 v[100:103], v203 offset:7168
ds_read_b128 v[104:107], v203 offset:8192
ds_read_b128 v[108:111], v203 offset:9216
ds_read_b128 v[112:115], v203 offset:10240
ds_read_b128 v[116:119], v203 offset:11264
ds_read_b128 v[120:123], v203 offset:12288
ds_read_b128 v[124:127], v203 offset:13312
Lp4_s1:
v_and_b32 v12, 1, v3
v_lshrrev_b32 v13, 1, v3
v_lshl_add_u32 v12, v12, 1, v13
v_mul_u32_u24 v204, 32, v12
v_mul_u32_u24 v205, 16, v3
s_lshl_b32 s3, s30, 8
s_add_u32 s3, s3, 64512
v_lshlrev_b32 v202, 3, v2
v_add_u32 v202, s3, v202
v_add_u32 v204, 63488, v204
v_add_u32 v205, 63488, v205
s_waitcnt lgkmcnt(0)
ds_read_b64 v[216:217], v202 offset:0
ds_read_b64 v[218:219], v202 offset:128
ds_read_b128 v[156:159], v204 offset:512
ds_read_b128 v[160:163], v204 offset:528
ds_read_b128 v[164:167], v204 offset:640
ds_read_b128 v[168:171], v204 offset:656
ds_read_b128 v[172:175], v204 offset:768
ds_read_b128 v[176:179], v204 offset:784
ds_read_b128 v[180:183], v205 offset:896
s_waitcnt lgkmcnt(0)
ds_read_b128 v[128:131], v204 offset:0
ds_read_b128 v[132:135], v204 offset:16
ds_read_b128 v[136:139], v204 offset:128
ds_read_b128 v[140:143], v204 offset:144
ds_read_b128 v[144:147], v204 offset:256
ds_read_b128 v[148:151], v204 offset:272
ds_read_b128 v[152:155], v205 offset:384
v_mov_b32 v192, 0xc0135761
v_mov_b32 v193, 0xc0135761
s_mov_b32 s72, 0xbdd2d3e8
s_mov_b32 s73, s72
v_permlane16_swap_b32 v72, v76
v_permlane16_swap_b32 v73, v77
v_permlane16_swap_b32 v74, v78
v_permlane16_swap_b32 v75, v79
v_permlane16_swap_b32 v80, v84
v_permlane16_swap_b32 v81, v85
v_permlane16_swap_b32 v82, v86
v_permlane16_swap_b32 v83, v87
v_permlane16_swap_b32 v88, v92
v_permlane16_swap_b32 v89, v93
v_permlane16_swap_b32 v90, v94
v_permlane16_swap_b32 v91, v95
s_nop 1
v_pk_mul_f32 v[72:73], v[72:73], v[216:217] op_sel_hi:[1,0]
v_pk_mul_f32 v[74:75], v[74:75], v[216:217] op_sel_hi:[1,0]
v_pk_mul_f32 v[76:77], v[76:77], v[216:217] op_sel_hi:[1,0]
v_pk_mul_f32 v[78:79], v[78:79], v[216:217] op_sel_hi:[1,0]
v_pk_fma_f32 v[72:73], v[156:157], v[216:217], v[72:73] op_sel:[0,1,0] op_sel_hi:[1,1,1]
v_pk_fma_f32 v[74:75], v[158:159], v[216:217], v[74:75] op_sel:[0,1,0] op_sel_hi:[1,1,1]
v_pk_fma_f32 v[76:77], v[160:161], v[216:217], v[76:77] op_sel:[0,1,0] op_sel_hi:[1,1,1]
v_pk_fma_f32 v[78:79], v[162:163], v[216:217], v[78:79] op_sel:[0,1,0] op_sel_hi:[1,1,1]
v_pk_mul_f32 v[184:185], v[72:73], v[72:73]
v_pk_mul_f32 v[186:187], v[74:75], v[74:75]
v_pk_mul_f32 v[188:189], v[76:77], v[76:77]
v_pk_mul_f32 v[190:191], v[78:79], v[78:79]
v_pk_fma_f32 v[184:185], v[184:185], s[72:73], v[192:193]
v_pk_fma_f32 v[186:187], v[186:187], s[72:73], v[192:193]
v_pk_fma_f32 v[188:189], v[188:189], s[72:73], v[192:193]
v_pk_fma_f32 v[190:191], v[190:191], s[72:73], v[192:193]
v_pk_mul_f32 v[184:185], v[184:185], v[72:73]
v_pk_mul_f32 v[186:187], v[186:187], v[74:75]
v_pk_mul_f32 v[188:189], v[188:189], v[76:77]
v_pk_mul_f32 v[190:191], v[190:191], v[78:79]
v_exp_f32 v184, v184
v_exp_f32 v185, v185
v_exp_f32 v186, v186
v_exp_f32 v187, v187
v_exp_f32 v188, v188
v_exp_f32 v189, v189
v_exp_f32 v190, v190
v_exp_f32 v191, v191
s_nop 0
v_pk_add_f32 v[184:185], v[184:185], 1.0 op_sel_hi:[1,0]
v_pk_add_f32 v[186:187], v[186:187], 1.0 op_sel_hi:[1,0]
v_pk_add_f32 v[188:189], v[188:189], 1.0 op_sel_hi:[1,0]
v_pk_add_f32 v[190:191], v[190:191], 1.0 op_sel_hi:[1,0]
v_rcp_f32 v184, v184
v_rcp_f32 v185, v185
v_rcp_f32 v186, v186
v_rcp_f32 v187, v187
v_rcp_f32 v188, v188
v_rcp_f32 v189, v189
v_rcp_f32 v190, v190
v_rcp_f32 v191, v191
s_nop 0
v_pk_mul_f32 v[72:73], v[72:73], v[184:185]
v_pk_mul_f32 v[74:75], v[74:75], v[186:187]
v_pk_mul_f32 v[76:77], v[76:77], v[188:189]
v_pk_mul_f32 v[78:79], v[78:79], v[190:191]
v_pk_mul_f32 v[80:81], v[80:81], v[216:217] op_sel_hi:[1,0]
v_pk_mul_f32 v[82:83], v[82:83], v[216:217] op_sel_hi:[1,0]
v_pk_mul_f32 v[84:85], v[84:85], v[216:217] op_sel_hi:[1,0]
v_pk_mul_f32 v[86:87], v[86:87], v[216:217] op_sel_hi:[1,0]
v_pk_fma_f32 v[80:81], v[164:165], v[216:217], v[80:81] op_sel:[0,1,0] op_sel_hi:[1,1,1]
v_pk_fma_f32 v[82:83], v[166:167], v[216:217], v[82:83] op_sel:[0,1,0] op_sel_hi:[1,1,1]
v_pk_fma_f32 v[84:85], v[168:169], v[216:217], v[84:85] op_sel:[0,1,0] op_sel_hi:[1,1,1]
v_pk_fma_f32 v[86:87], v[170:171], v[216:217], v[86:87] op_sel:[0,1,0] op_sel_hi:[1,1,1]
v_pk_mul_f32 v[184:185], v[80:81], v[80:81]
v_pk_mul_f32 v[186:187], v[82:83], v[82:83]
v_pk_mul_f32 v[188:189], v[84:85], v[84:85]
v_pk_mul_f32 v[190:191], v[86:87], v[86:87]
v_pk_fma_f32 v[184:185], v[184:185], s[72:73], v[192:193]
v_pk_fma_f32 v[186:187], v[186:187], s[72:73], v[192:193]
v_pk_fma_f32 v[188:189], v[188:189], s[72:73], v[192:193]
v_pk_fma_f32 v[190:191], v[190:191], s[72:73], v[192:193]
v_pk_mul_f32 v[184:185], v[184:185], v[80:81]
v_pk_mul_f32 v[186:187], v[186:187], v[82:83]
v_pk_mul_f32 v[188:189], v[188:189], v[84:85]
v_pk_mul_f32 v[190:191], v[190:191], v[86:87]
v_exp_f32 v184, v184
v_exp_f32 v185, v185
v_exp_f32 v186, v186
v_exp_f32 v187, v187
v_exp_f32 v188, v188
v_exp_f32 v189, v189
v_exp_f32 v190, v190
v_exp_f32 v191, v191
s_nop 0
v_pk_add_f32 v[184:185], v[184:185], 1.0 op_sel_hi:[1,0]
v_pk_add_f32 v[186:187], v[186:187], 1.0 op_sel_hi:[1,0]
v_pk_add_f32 v[188:189], v[188:189], 1.0 op_sel_hi:[1,0]
v_pk_add_f32 v[190:191], v[190:191], 1.0 op_sel_hi:[1,0]
v_rcp_f32 v184, v184
v_rcp_f32 v185, v185
v_rcp_f32 v186, v186
v_rcp_f32 v187, v187
v_rcp_f32 v188, v188
v_rcp_f32 v189, v189
v_rcp_f32 v190, v190
v_rcp_f32 v191, v191
s_nop 0
v_pk_mul_f32 v[80:81], v[80:81], v[184:185]
v_pk_mul_f32 v[82:83], v[82:83], v[186:187]
v_pk_mul_f32 v[84:85], v[84:85], v[188:189]
v_pk_mul_f32 v[86:87], v[86:87], v[190:191]
v_pk_mul_f32 v[88:89], v[88:89], v[216:217] op_sel_hi:[1,0]
v_pk_mul_f32 v[90:91], v[90:91], v[216:217] op_sel_hi:[1,0]
v_pk_mul_f32 v[92:93], v[92:93], v[216:217] op_sel_hi:[1,0]
v_pk_mul_f32 v[94:95], v[94:95], v[216:217] op_sel_hi:[1,0]
v_pk_fma_f32 v[88:89], v[172:173], v[216:217], v[88:89] op_sel:[0,1,0] op_sel_hi:[1,1,1]
v_pk_fma_f32 v[90:91], v[174:175], v[216:217], v[90:91] op_sel:[0,1,0] op_sel_hi:[1,1,1]
v_pk_fma_f32 v[92:93], v[176:177], v[216:217], v[92:93] op_sel:[0,1,0] op_sel_hi:[1,1,1]
v_pk_fma_f32 v[94:95], v[178:179], v[216:217], v[94:95] op_sel:[0,1,0] op_sel_hi:[1,1,1]
v_pk_mul_f32 v[184:185], v[88:89], v[88:89]
v_pk_mul_f32 v[186:187], v[90:91], v[90:91]
v_pk_mul_f32 v[188:189], v[92:93], v[92:93]
v_pk_mul_f32 v[190:191], v[94:95], v[94:95]
v_pk_fma_f32 v[184:185], v[184:185], s[72:73], v[192:193]
v_pk_fma_f32 v[186:187], v[186:187], s[72:73], v[192:193]
v_pk_fma_f32 v[188:189], v[188:189], s[72:73], v[192:193]
v_pk_fma_f32 v[190:191], v[190:191], s[72:73], v[192:193]
v_pk_mul_f32 v[184:185], v[184:185], v[88:89]
v_pk_mul_f32 v[186:187], v[186:187], v[90:91]
v_pk_mul_f32 v[188:189], v[188:189], v[92:93]
v_pk_mul_f32 v[190:191], v[190:191], v[94:95]
v_exp_f32 v184, v184
v_exp_f32 v185, v185
v_exp_f32 v186, v186
v_exp_f32 v187, v187
v_exp_f32 v188, v188
v_exp_f32 v189, v189
v_exp_f32 v190, v190
v_exp_f32 v191, v191
s_nop 0
v_pk_add_f32 v[184:185], v[184:185], 1.0 op_sel_hi:[1,0]
v_pk_add_f32 v[186:187], v[186:187], 1.0 op_sel_hi:[1,0]
v_pk_add_f32 v[188:189], v[188:189], 1.0 op_sel_hi:[1,0]
v_pk_add_f32 v[190:191], v[190:191], 1.0 op_sel_hi:[1,0]
v_rcp_f32 v184, v184
v_rcp_f32 v185, v185
v_rcp_f32 v186, v186
v_rcp_f32 v187, v187
v_rcp_f32 v188, v188
v_rcp_f32 v189, v189
v_rcp_f32 v190, v190
v_rcp_f32 v191, v191
s_nop 0
v_pk_mul_f32 v[88:89], v[88:89], v[184:185]
v_pk_mul_f32 v[90:91], v[90:91], v[186:187]
v_pk_mul_f32 v[92:93], v[92:93], v[188:189]
v_pk_mul_f32 v[94:95], v[94:95], v[190:191]
v_pk_mul_f32 v[96:97], v[96:97], v[216:217] op_sel_hi:[1,0]
v_pk_mul_f32 v[98:99], v[98:99], v[216:217] op_sel_hi:[1,0]
v_pk_fma_f32 v[96:97], v[180:181], v[216:217], v[96:97] op_sel:[0,1,0] op_sel_hi:[1,1,1]
v_pk_fma_f32 v[98:99], v[182:183], v[216:217], v[98:99] op_sel:[0,1,0] op_sel_hi:[1,1,1]
v_pk_mul_f32 v[184:185], v[96:97], v[96:97]
v_pk_mul_f32 v[186:187], v[98:99], v[98:99]
v_pk_fma_f32 v[184:185], v[184:185], s[72:73], v[192:193]
v_pk_fma_f32 v[186:187], v[186:187], s[72:73], v[192:193]
v_pk_mul_f32 v[184:185], v[184:185], v[96:97]
v_pk_mul_f32 v[186:187], v[186:187], v[98:99]
v_exp_f32 v184, v184
v_exp_f32 v185, v185
v_exp_f32 v186, v186
v_exp_f32 v187, v187
s_nop 0
v_pk_add_f32 v[184:185], v[184:185], 1.0 op_sel_hi:[1,0]
v_pk_add_f32 v[186:187], v[186:187], 1.0 op_sel_hi:[1,0]
v_rcp_f32 v184, v184
v_rcp_f32 v185, v185
v_rcp_f32 v186, v186
v_rcp_f32 v187, v187
s_nop 0
v_pk_mul_f32 v[96:97], v[96:97], v[184:185]
v_pk_mul_f32 v[98:99], v[98:99], v[186:187]
v_pk_mul_f32 v[196:197], v[72:73], v[72:73]
v_mov_b32 v194, v72
v_mov_b32 v195, v73
v_pk_fma_f32 v[196:197], v[74:75], v[74:75], v[196:197]
v_pk_add_f32 v[194:195], v[194:195], v[74:75]
v_pk_fma_f32 v[196:197], v[76:77], v[76:77], v[196:197]
v_pk_add_f32 v[194:195], v[194:195], v[76:77]
v_pk_fma_f32 v[196:197], v[78:79], v[78:79], v[196:197]
v_pk_add_f32 v[194:195], v[194:195], v[78:79]
v_pk_fma_f32 v[196:197], v[80:81], v[80:81], v[196:197]
v_pk_add_f32 v[194:195], v[194:195], v[80:81]
v_pk_fma_f32 v[196:197], v[82:83], v[82:83], v[196:197]
v_pk_add_f32 v[194:195], v[194:195], v[82:83]
v_pk_fma_f32 v[196:197], v[84:85], v[84:85], v[196:197]
v_pk_add_f32 v[194:195], v[194:195], v[84:85]
v_pk_fma_f32 v[196:197], v[86:87], v[86:87], v[196:197]
v_pk_add_f32 v[194:195], v[194:195], v[86:87]
v_pk_fma_f32 v[196:197], v[88:89], v[88:89], v[196:197]
v_pk_add_f32 v[194:195], v[194:195], v[88:89]
v_pk_fma_f32 v[196:197], v[90:91], v[90:91], v[196:197]
v_pk_add_f32 v[194:195], v[194:195], v[90:91]
v_pk_fma_f32 v[196:197], v[92:93], v[92:93], v[196:197]
v_pk_add_f32 v[194:195], v[194:195], v[92:93]
v_pk_fma_f32 v[196:197], v[94:95], v[94:95], v[196:197]
v_pk_add_f32 v[194:195], v[194:195], v[94:95]
v_pk_fma_f32 v[196:197], v[96:97], v[96:97], v[196:197]
v_pk_add_f32 v[194:195], v[194:195], v[96:97]
v_pk_fma_f32 v[196:197], v[98:99], v[98:99], v[196:197]
v_pk_add_f32 v[194:195], v[194:195], v[98:99]
v_add_f32 v194, v194, v195
v_add_f32 v195, v196, v197
v_permlane16_swap_b32 v100, v104
v_permlane16_swap_b32 v101, v105
v_permlane16_swap_b32 v102, v106
v_permlane16_swap_b32 v103, v107
v_permlane16_swap_b32 v108, v112
v_permlane16_swap_b32 v109, v113
v_permlane16_swap_b32 v110, v114
v_permlane16_swap_b32 v111, v115
v_permlane16_swap_b32 v116, v120
v_permlane16_swap_b32 v117, v121
v_permlane16_swap_b32 v118, v122
v_permlane16_swap_b32 v119, v123
s_nop 1
v_pk_mul_f32 v[100:101], v[100:101], v[218:219] op_sel_hi:[1,0]
v_pk_mul_f32 v[102:103], v[102:103], v[218:219] op_sel_hi:[1,0]
v_pk_mul_f32 v[104:105], v[104:105], v[218:219] op_sel_hi:[1,0]
v_pk_mul_f32 v[106:107], v[106:107], v[218:219] op_sel_hi:[1,0]
v_pk_fma_f32 v[100:101], v[156:157], v[218:219], v[100:101] op_sel:[0,1,0] op_sel_hi:[1,1,1]
v_pk_fma_f32 v[102:103], v[158:159], v[218:219], v[102:103] op_sel:[0,1,0] op_sel_hi:[1,1,1]
v_pk_fma_f32 v[104:105], v[160:161], v[218:219], v[104:105] op_sel:[0,1,0] op_sel_hi:[1,1,1]
v_pk_fma_f32 v[106:107], v[162:163], v[218:219], v[106:107] op_sel:[0,1,0] op_sel_hi:[1,1,1]
v_pk_mul_f32 v[184:185], v[100:101], v[100:101]
v_pk_mul_f32 v[186:187], v[102:103], v[102:103]
v_pk_mul_f32 v[188:189], v[104:105], v[104:105]
v_pk_mul_f32 v[190:191], v[106:107], v[106:107]
v_pk_fma_f32 v[184:185], v[184:185], s[72:73], v[192:193]
v_pk_fma_f32 v[186:187], v[186:187], s[72:73], v[192:193]
v_pk_fma_f32 v[188:189], v[188:189], s[72:73], v[192:193]
v_pk_fma_f32 v[190:191], v[190:191], s[72:73], v[192:193]
v_pk_mul_f32 v[184:185], v[184:185], v[100:101]
v_pk_mul_f32 v[186:187], v[186:187], v[102:103]
v_pk_mul_f32 v[188:189], v[188:189], v[104:105]
v_pk_mul_f32 v[190:191], v[190:191], v[106:107]
v_exp_f32 v184, v184
v_exp_f32 v185, v185
v_exp_f32 v186, v186
v_exp_f32 v187, v187
v_exp_f32 v188, v188
v_exp_f32 v189, v189
v_exp_f32 v190, v190
v_exp_f32 v191, v191
s_nop 0
v_pk_add_f32 v[184:185], v[184:185], 1.0 op_sel_hi:[1,0]
v_pk_add_f32 v[186:187], v[186:187], 1.0 op_sel_hi:[1,0]
v_pk_add_f32 v[188:189], v[188:189], 1.0 op_sel_hi:[1,0]
v_pk_add_f32 v[190:191], v[190:191], 1.0 op_sel_hi:[1,0]
v_rcp_f32 v184, v184
v_rcp_f32 v185, v185
v_rcp_f32 v186, v186
v_rcp_f32 v187, v187
v_rcp_f32 v188, v188
v_rcp_f32 v189, v189
v_rcp_f32 v190, v190
v_rcp_f32 v191, v191
s_nop 0
v_pk_mul_f32 v[100:101], v[100:101], v[184:185]
v_pk_mul_f32 v[102:103], v[102:103], v[186:187]
v_pk_mul_f32 v[104:105], v[104:105], v[188:189]
v_pk_mul_f32 v[106:107], v[106:107], v[190:191]
v_pk_mul_f32 v[108:109], v[108:109], v[218:219] op_sel_hi:[1,0]
v_pk_mul_f32 v[110:111], v[110:111], v[218:219] op_sel_hi:[1,0]
v_pk_mul_f32 v[112:113], v[112:113], v[218:219] op_sel_hi:[1,0]
v_pk_mul_f32 v[114:115], v[114:115], v[218:219] op_sel_hi:[1,0]
v_pk_fma_f32 v[108:109], v[164:165], v[218:219], v[108:109] op_sel:[0,1,0] op_sel_hi:[1,1,1]
v_pk_fma_f32 v[110:111], v[166:167], v[218:219], v[110:111] op_sel:[0,1,0] op_sel_hi:[1,1,1]
v_pk_fma_f32 v[112:113], v[168:169], v[218:219], v[112:113] op_sel:[0,1,0] op_sel_hi:[1,1,1]
v_pk_fma_f32 v[114:115], v[170:171], v[218:219], v[114:115] op_sel:[0,1,0] op_sel_hi:[1,1,1]
v_pk_mul_f32 v[184:185], v[108:109], v[108:109]
v_pk_mul_f32 v[186:187], v[110:111], v[110:111]
v_pk_mul_f32 v[188:189], v[112:113], v[112:113]
v_pk_mul_f32 v[190:191], v[114:115], v[114:115]
v_pk_fma_f32 v[184:185], v[184:185], s[72:73], v[192:193]
v_pk_fma_f32 v[186:187], v[186:187], s[72:73], v[192:193]
v_pk_fma_f32 v[188:189], v[188:189], s[72:73], v[192:193]
v_pk_fma_f32 v[190:191], v[190:191], s[72:73], v[192:193]
v_pk_mul_f32 v[184:185], v[184:185], v[108:109]
v_pk_mul_f32 v[186:187], v[186:187], v[110:111]
v_pk_mul_f32 v[188:189], v[188:189], v[112:113]
v_pk_mul_f32 v[190:191], v[190:191], v[114:115]
v_exp_f32 v184, v184
v_exp_f32 v185, v185
v_exp_f32 v186, v186
v_exp_f32 v187, v187
v_exp_f32 v188, v188
v_exp_f32 v189, v189
v_exp_f32 v190, v190
v_exp_f32 v191, v191
s_nop 0
v_pk_add_f32 v[184:185], v[184:185], 1.0 op_sel_hi:[1,0]
v_pk_add_f32 v[186:187], v[186:187], 1.0 op_sel_hi:[1,0]
v_pk_add_f32 v[188:189], v[188:189], 1.0 op_sel_hi:[1,0]
v_pk_add_f32 v[190:191], v[190:191], 1.0 op_sel_hi:[1,0]
v_rcp_f32 v184, v184
v_rcp_f32 v185, v185
v_rcp_f32 v186, v186
v_rcp_f32 v187, v187
v_rcp_f32 v188, v188
v_rcp_f32 v189, v189
v_rcp_f32 v190, v190
v_rcp_f32 v191, v191
s_nop 0
v_pk_mul_f32 v[108:109], v[108:109], v[184:185]
v_pk_mul_f32 v[110:111], v[110:111], v[186:187]
v_pk_mul_f32 v[112:113], v[112:113], v[188:189]
v_pk_mul_f32 v[114:115], v[114:115], v[190:191]
v_pk_mul_f32 v[116:117], v[116:117], v[218:219] op_sel_hi:[1,0]
v_pk_mul_f32 v[118:119], v[118:119], v[218:219] op_sel_hi:[1,0]
v_pk_mul_f32 v[120:121], v[120:121], v[218:219] op_sel_hi:[1,0]
v_pk_mul_f32 v[122:123], v[122:123], v[218:219] op_sel_hi:[1,0]
v_pk_fma_f32 v[116:117], v[172:173], v[218:219], v[116:117] op_sel:[0,1,0] op_sel_hi:[1,1,1]
v_pk_fma_f32 v[118:119], v[174:175], v[218:219], v[118:119] op_sel:[0,1,0] op_sel_hi:[1,1,1]
v_pk_fma_f32 v[120:121], v[176:177], v[218:219], v[120:121] op_sel:[0,1,0] op_sel_hi:[1,1,1]
v_pk_fma_f32 v[122:123], v[178:179], v[218:219], v[122:123] op_sel:[0,1,0] op_sel_hi:[1,1,1]
v_pk_mul_f32 v[184:185], v[116:117], v[116:117]
v_pk_mul_f32 v[186:187], v[118:119], v[118:119]
v_pk_mul_f32 v[188:189], v[120:121], v[120:121]
v_pk_mul_f32 v[190:191], v[122:123], v[122:123]
v_pk_fma_f32 v[184:185], v[184:185], s[72:73], v[192:193]
v_pk_fma_f32 v[186:187], v[186:187], s[72:73], v[192:193]
v_pk_fma_f32 v[188:189], v[188:189], s[72:73], v[192:193]
v_pk_fma_f32 v[190:191], v[190:191], s[72:73], v[192:193]
v_pk_mul_f32 v[184:185], v[184:185], v[116:117]
v_pk_mul_f32 v[186:187], v[186:187], v[118:119]
v_pk_mul_f32 v[188:189], v[188:189], v[120:121]
v_pk_mul_f32 v[190:191], v[190:191], v[122:123]
v_exp_f32 v184, v184
v_exp_f32 v185, v185
v_exp_f32 v186, v186
v_exp_f32 v187, v187
v_exp_f32 v188, v188
v_exp_f32 v189, v189
v_exp_f32 v190, v190
v_exp_f32 v191, v191
s_nop 0
v_pk_add_f32 v[184:185], v[184:185], 1.0 op_sel_hi:[1,0]
v_pk_add_f32 v[186:187], v[186:187], 1.0 op_sel_hi:[1,0]
v_pk_add_f32 v[188:189], v[188:189], 1.0 op_sel_hi:[1,0]
v_pk_add_f32 v[190:191], v[190:191], 1.0 op_sel_hi:[1,0]
v_rcp_f32 v184, v184
v_rcp_f32 v185, v185
v_rcp_f32 v186, v186
v_rcp_f32 v187, v187
v_rcp_f32 v188, v188
v_rcp_f32 v189, v189
v_rcp_f32 v190, v190
v_rcp_f32 v191, v191
s_nop 0
v_pk_mul_f32 v[116:117], v[116:117], v[184:185]
v_pk_mul_f32 v[118:119], v[118:119], v[186:187]
v_pk_mul_f32 v[120:121], v[120:121], v[188:189]
v_pk_mul_f32 v[122:123], v[122:123], v[190:191]
v_pk_mul_f32 v[124:125], v[124:125], v[218:219] op_sel_hi:[1,0]
v_pk_mul_f32 v[126:127], v[126:127], v[218:219] op_sel_hi:[1,0]
v_pk_fma_f32 v[124:125], v[180:181], v[218:219], v[124:125] op_sel:[0,1,0] op_sel_hi:[1,1,1]
v_pk_fma_f32 v[126:127], v[182:183], v[218:219], v[126:127] op_sel:[0,1,0] op_sel_hi:[1,1,1]
v_pk_mul_f32 v[184:185], v[124:125], v[124:125]
v_pk_mul_f32 v[186:187], v[126:127], v[126:127]
v_pk_fma_f32 v[184:185], v[184:185], s[72:73], v[192:193]
v_pk_fma_f32 v[186:187], v[186:187], s[72:73], v[192:193]
v_pk_mul_f32 v[184:185], v[184:185], v[124:125]
v_pk_mul_f32 v[186:187], v[186:187], v[126:127]
v_exp_f32 v184, v184
v_exp_f32 v185, v185
v_exp_f32 v186, v186
v_exp_f32 v187, v187
s_nop 0
v_pk_add_f32 v[184:185], v[184:185], 1.0 op_sel_hi:[1,0]
v_pk_add_f32 v[186:187], v[186:187], 1.0 op_sel_hi:[1,0]
v_rcp_f32 v184, v184
v_rcp_f32 v185, v185
v_rcp_f32 v186, v186
v_rcp_f32 v187, v187
s_nop 0
v_pk_mul_f32 v[124:125], v[124:125], v[184:185]
v_pk_mul_f32 v[126:127], v[126:127], v[186:187]
v_pk_mul_f32 v[200:201], v[100:101], v[100:101]
v_mov_b32 v198, v100
v_mov_b32 v199, v101
v_pk_fma_f32 v[200:201], v[102:103], v[102:103], v[200:201]
v_pk_add_f32 v[198:199], v[198:199], v[102:103]
v_pk_fma_f32 v[200:201], v[104:105], v[104:105], v[200:201]
v_pk_add_f32 v[198:199], v[198:199], v[104:105]
v_pk_fma_f32 v[200:201], v[106:107], v[106:107], v[200:201]
v_pk_add_f32 v[198:199], v[198:199], v[106:107]
v_pk_fma_f32 v[200:201], v[108:109], v[108:109], v[200:201]
v_pk_add_f32 v[198:199], v[198:199], v[108:109]
v_pk_fma_f32 v[200:201], v[110:111], v[110:111], v[200:201]
v_pk_add_f32 v[198:199], v[198:199], v[110:111]
v_pk_fma_f32 v[200:201], v[112:113], v[112:113], v[200:201]
v_pk_add_f32 v[198:199], v[198:199], v[112:113]
v_pk_fma_f32 v[200:201], v[114:115], v[114:115], v[200:201]
v_pk_add_f32 v[198:199], v[198:199], v[114:115]
v_pk_fma_f32 v[200:201], v[116:117], v[116:117], v[200:201]
v_pk_add_f32 v[198:199], v[198:199], v[116:117]
v_pk_fma_f32 v[200:201], v[118:119], v[118:119], v[200:201]
v_pk_add_f32 v[198:199], v[198:199], v[118:119]
v_pk_fma_f32 v[200:201], v[120:121], v[120:121], v[200:201]
v_pk_add_f32 v[198:199], v[198:199], v[120:121]
v_pk_fma_f32 v[200:201], v[122:123], v[122:123], v[200:201]
v_pk_add_f32 v[198:199], v[198:199], v[122:123]
v_pk_fma_f32 v[200:201], v[124:125], v[124:125], v[200:201]
v_pk_add_f32 v[198:199], v[198:199], v[124:125]
v_pk_fma_f32 v[200:201], v[126:127], v[126:127], v[200:201]
v_pk_add_f32 v[198:199], v[198:199], v[126:127]
v_add_f32 v198, v198, v199
v_add_f32 v199, v200, v201
v_mov_b32 v196, v194
v_mov_b32 v197, v195
v_mov_b32 v200, v198
v_mov_b32 v201, v199
s_nop 1
v_permlane16_swap_b32 v194, v196
v_permlane16_swap_b32 v195, v197
v_permlane16_swap_b32 v198, v200
v_permlane16_swap_b32 v199, v201
s_nop 1
v_add_f32 v194, v194, v196
v_add_f32 v195, v195, v197
v_add_f32 v198, v198, v200
v_add_f32 v199, v199, v201
v_mov_b32 v196, v194
v_mov_b32 v197, v195
v_mov_b32 v200, v198
v_mov_b32 v201, v199
s_nop 1
v_permlane32_swap_b32 v194, v196
v_permlane32_swap_b32 v195, v197
v_permlane32_swap_b32 v198, v200
v_permlane32_swap_b32 v199, v201
s_nop 1
v_add_f32 v194, v194, v196
v_add_f32 v195, v195, v197
v_add_f32 v198, v198, v200
v_add_f32 v199, v199, v201
v_lshlrev_b32 v202, 3, v1
v_cmp_eq_u32 vcc, 1, v3
s_nop 1
v_cndmask_b32 v194, v194, v198, vcc
v_cndmask_b32 v195, v195, v199, vcc
s_mov_b32 exec_hi, 0
buffer_store_dwordx2 v[194:195], v202, s[24:27], s69 offen sc1
s_mov_b64 exec, -1
s_waitcnt lgkmcnt(0)
s_waitcnt vmcnt(1)
v_permlane16_swap_b32 v16, v20
v_permlane16_swap_b32 v17, v21
v_permlane16_swap_b32 v18, v22
v_permlane16_swap_b32 v19, v23
v_permlane16_swap_b32 v24, v28
v_permlane16_swap_b32 v25, v29
v_permlane16_swap_b32 v26, v30
v_permlane16_swap_b32 v27, v31
v_permlane16_swap_b32 v32, v36
v_permlane16_swap_b32 v33, v37
v_permlane16_swap_b32 v34, v38
v_permlane16_swap_b32 v35, v39
s_nop 1
v_pk_mul_f32 v[16:17], v[16:17], v[216:217] op_sel_hi:[1,0]
v_pk_mul_f32 v[18:19], v[18:19], v[216:217] op_sel_hi:[1,0]
v_pk_mul_f32 v[20:21], v[20:21], v[216:217] op_sel_hi:[1,0]
v_pk_mul_f32 v[22:23], v[22:23], v[216:217] op_sel_hi:[1,0]
v_pk_fma_f32 v[16:17], v[128:129], v[216:217], v[16:17] op_sel:[0,1,0] op_sel_hi:[1,1,1]
v_pk_fma_f32 v[18:19], v[130:131], v[216:217], v[18:19] op_sel:[0,1,0] op_sel_hi:[1,1,1]
v_pk_fma_f32 v[20:21], v[132:133], v[216:217], v[20:21] op_sel:[0,1,0] op_sel_hi:[1,1,1]
v_pk_fma_f32 v[22:23], v[134:135], v[216:217], v[22:23] op_sel:[0,1,0] op_sel_hi:[1,1,1]
v_pk_mul_f32 v[184:185], v[16:17], v[16:17]
v_pk_mul_f32 v[186:187], v[18:19], v[18:19]
v_pk_mul_f32 v[188:189], v[20:21], v[20:21]
v_pk_mul_f32 v[190:191], v[22:23], v[22:23]
v_pk_fma_f32 v[184:185], v[184:185], s[72:73], v[192:193]
v_pk_fma_f32 v[186:187], v[186:187], s[72:73], v[192:193]
v_pk_fma_f32 v[188:189], v[188:189], s[72:73], v[192:193]
v_pk_fma_f32 v[190:191], v[190:191], s[72:73], v[192:193]
v_pk_mul_f32 v[184:185], v[184:185], v[16:17]
v_pk_mul_f32 v[186:187], v[186:187], v[18:19]
v_pk_mul_f32 v[188:189], v[188:189], v[20:21]
v_pk_mul_f32 v[190:191], v[190:191], v[22:23]
v_exp_f32 v184, v184
v_exp_f32 v185, v185
v_exp_f32 v186, v186
v_exp_f32 v187, v187
v_exp_f32 v188, v188
v_exp_f32 v189, v189
v_exp_f32 v190, v190
v_exp_f32 v191, v191
s_nop 0
v_pk_add_f32 v[184:185], v[184:185], 1.0 op_sel_hi:[1,0]
v_pk_add_f32 v[186:187], v[186:187], 1.0 op_sel_hi:[1,0]
v_pk_add_f32 v[188:189], v[188:189], 1.0 op_sel_hi:[1,0]
v_pk_add_f32 v[190:191], v[190:191], 1.0 op_sel_hi:[1,0]
v_rcp_f32 v184, v184
v_rcp_f32 v185, v185
v_rcp_f32 v186, v186
v_rcp_f32 v187, v187
v_rcp_f32 v188, v188
v_rcp_f32 v189, v189
v_rcp_f32 v190, v190
v_rcp_f32 v191, v191
s_nop 0
v_pk_mul_f32 v[16:17], v[16:17], v[184:185]
v_pk_mul_f32 v[18:19], v[18:19], v[186:187]
v_pk_mul_f32 v[20:21], v[20:21], v[188:189]
v_pk_mul_f32 v[22:23], v[22:23], v[190:191]
v_pk_mul_f32 v[24:25], v[24:25], v[216:217] op_sel_hi:[1,0]
v_pk_mul_f32 v[26:27], v[26:27], v[216:217] op_sel_hi:[1,0]
v_pk_mul_f32 v[28:29], v[28:29], v[216:217] op_sel_hi:[1,0]
v_pk_mul_f32 v[30:31], v[30:31], v[216:217] op_sel_hi:[1,0]
v_pk_fma_f32 v[24:25], v[136:137], v[216:217], v[24:25] op_sel:[0,1,0] op_sel_hi:[1,1,1]
v_pk_fma_f32 v[26:27], v[138:139], v[216:217], v[26:27] op_sel:[0,1,0] op_sel_hi:[1,1,1]
v_pk_fma_f32 v[28:29], v[140:141], v[216:217], v[28:29] op_sel:[0,1,0] op_sel_hi:[1,1,1]
v_pk_fma_f32 v[30:31], v[142:143], v[216:217], v[30:31] op_sel:[0,1,0] op_sel_hi:[1,1,1]
v_pk_mul_f32 v[184:185], v[24:25], v[24:25]
v_pk_mul_f32 v[186:187], v[26:27], v[26:27]
v_pk_mul_f32 v[188:189], v[28:29], v[28:29]
v_pk_mul_f32 v[190:191], v[30:31], v[30:31]
v_pk_fma_f32 v[184:185], v[184:185], s[72:73], v[192:193]
v_pk_fma_f32 v[186:187], v[186:187], s[72:73], v[192:193]
v_pk_fma_f32 v[188:189], v[188:189], s[72:73], v[192:193]
v_pk_fma_f32 v[190:191], v[190:191], s[72:73], v[192:193]
v_pk_mul_f32 v[184:185], v[184:185], v[24:25]
v_pk_mul_f32 v[186:187], v[186:187], v[26:27]
v_pk_mul_f32 v[188:189], v[188:189], v[28:29]
v_pk_mul_f32 v[190:191], v[190:191], v[30:31]
v_exp_f32 v184, v184
v_exp_f32 v185, v185
v_exp_f32 v186, v186
v_exp_f32 v187, v187
v_exp_f32 v188, v188
v_exp_f32 v189, v189
v_exp_f32 v190, v190
v_exp_f32 v191, v191
s_nop 0
v_pk_add_f32 v[184:185], v[184:185], 1.0 op_sel_hi:[1,0]
v_pk_add_f32 v[186:187], v[186:187], 1.0 op_sel_hi:[1,0]
v_pk_add_f32 v[188:189], v[188:189], 1.0 op_sel_hi:[1,0]
v_pk_add_f32 v[190:191], v[190:191], 1.0 op_sel_hi:[1,0]
v_rcp_f32 v184, v184
v_rcp_f32 v185, v185
v_rcp_f32 v186, v186
v_rcp_f32 v187, v187
v_rcp_f32 v188, v188
v_rcp_f32 v189, v189
v_rcp_f32 v190, v190
v_rcp_f32 v191, v191
s_nop 0
v_pk_mul_f32 v[24:25], v[24:25], v[184:185]
v_pk_mul_f32 v[26:27], v[26:27], v[186:187]
v_pk_mul_f32 v[28:29], v[28:29], v[188:189]
v_pk_mul_f32 v[30:31], v[30:31], v[190:191]
v_pk_mul_f32 v[32:33], v[32:33], v[216:217] op_sel_hi:[1,0]
v_pk_mul_f32 v[34:35], v[34:35], v[216:217] op_sel_hi:[1,0]
v_pk_mul_f32 v[36:37], v[36:37], v[216:217] op_sel_hi:[1,0]
v_pk_mul_f32 v[38:39], v[38:39], v[216:217] op_sel_hi:[1,0]
v_pk_fma_f32 v[32:33], v[144:145], v[216:217], v[32:33] op_sel:[0,1,0] op_sel_hi:[1,1,1]
v_pk_fma_f32 v[34:35], v[146:147], v[216:217], v[34:35] op_sel:[0,1,0] op_sel_hi:[1,1,1]
v_pk_fma_f32 v[36:37], v[148:149], v[216:217], v[36:37] op_sel:[0,1,0] op_sel_hi:[1,1,1]
v_pk_fma_f32 v[38:39], v[150:151], v[216:217], v[38:39] op_sel:[0,1,0] op_sel_hi:[1,1,1]
v_pk_mul_f32 v[184:185], v[32:33], v[32:33]
v_pk_mul_f32 v[186:187], v[34:35], v[34:35]
v_pk_mul_f32 v[188:189], v[36:37], v[36:37]
v_pk_mul_f32 v[190:191], v[38:39], v[38:39]
v_pk_fma_f32 v[184:185], v[184:185], s[72:73], v[192:193]
v_pk_fma_f32 v[186:187], v[186:187], s[72:73], v[192:193]
v_pk_fma_f32 v[188:189], v[188:189], s[72:73], v[192:193]
v_pk_fma_f32 v[190:191], v[190:191], s[72:73], v[192:193]
v_pk_mul_f32 v[184:185], v[184:185], v[32:33]
v_pk_mul_f32 v[186:187], v[186:187], v[34:35]
v_pk_mul_f32 v[188:189], v[188:189], v[36:37]
v_pk_mul_f32 v[190:191], v[190:191], v[38:39]
v_exp_f32 v184, v184
v_exp_f32 v185, v185
v_exp_f32 v186, v186
v_exp_f32 v187, v187
v_exp_f32 v188, v188
v_exp_f32 v189, v189
v_exp_f32 v190, v190
v_exp_f32 v191, v191
s_nop 0
v_pk_add_f32 v[184:185], v[184:185], 1.0 op_sel_hi:[1,0]
v_pk_add_f32 v[186:187], v[186:187], 1.0 op_sel_hi:[1,0]
v_pk_add_f32 v[188:189], v[188:189], 1.0 op_sel_hi:[1,0]
v_pk_add_f32 v[190:191], v[190:191], 1.0 op_sel_hi:[1,0]
v_rcp_f32 v184, v184
v_rcp_f32 v185, v185
v_rcp_f32 v186, v186
v_rcp_f32 v187, v187
v_rcp_f32 v188, v188
v_rcp_f32 v189, v189
v_rcp_f32 v190, v190
v_rcp_f32 v191, v191
s_nop 0
v_pk_mul_f32 v[32:33], v[32:33], v[184:185]
v_pk_mul_f32 v[34:35], v[34:35], v[186:187]
v_pk_mul_f32 v[36:37], v[36:37], v[188:189]
v_pk_mul_f32 v[38:39], v[38:39], v[190:191]
v_pk_mul_f32 v[40:41], v[40:41], v[216:217] op_sel_hi:[1,0]
v_pk_mul_f32 v[42:43], v[42:43], v[216:217] op_sel_hi:[1,0]
v_pk_fma_f32 v[40:41], v[152:153], v[216:217], v[40:41] op_sel:[0,1,0] op_sel_hi:[1,1,1]
v_pk_fma_f32 v[42:43], v[154:155], v[216:217], v[42:43] op_sel:[0,1,0] op_sel_hi:[1,1,1]
v_pk_mul_f32 v[184:185], v[40:41], v[40:41]
v_pk_mul_f32 v[186:187], v[42:43], v[42:43]
v_pk_fma_f32 v[184:185], v[184:185], s[72:73], v[192:193]
v_pk_fma_f32 v[186:187], v[186:187], s[72:73], v[192:193]
v_pk_mul_f32 v[184:185], v[184:185], v[40:41]
v_pk_mul_f32 v[186:187], v[186:187], v[42:43]
v_exp_f32 v184, v184
v_exp_f32 v185, v185
v_exp_f32 v186, v186
v_exp_f32 v187, v187
s_nop 0
v_pk_add_f32 v[184:185], v[184:185], 1.0 op_sel_hi:[1,0]
v_pk_add_f32 v[186:187], v[186:187], 1.0 op_sel_hi:[1,0]
v_rcp_f32 v184, v184
v_rcp_f32 v185, v185
v_rcp_f32 v186, v186
v_rcp_f32 v187, v187
s_nop 0
v_pk_mul_f32 v[40:41], v[40:41], v[184:185]
v_pk_mul_f32 v[42:43], v[42:43], v[186:187]
v_cvt_pk_bf16_f32 v224, v16, v17
v_cvt_pk_bf16_f32 v225, v18, v19
v_cvt_pk_bf16_f32 v226, v20, v21
v_cvt_pk_bf16_f32 v227, v22, v23
v_cvt_pk_bf16_f32 v228, v24, v25
v_cvt_pk_bf16_f32 v229, v26, v27
v_cvt_pk_bf16_f32 v230, v28, v29
v_cvt_pk_bf16_f32 v231, v30, v31
v_cvt_pk_bf16_f32 v232, v32, v33
v_cvt_pk_bf16_f32 v233, v34, v35
v_cvt_pk_bf16_f32 v234, v36, v37
v_cvt_pk_bf16_f32 v235, v38, v39
v_cvt_pk_bf16_f32 v236, v40, v41
v_cvt_pk_bf16_f32 v237, v42, v43
v_permlane16_swap_b32 v44, v48
v_permlane16_swap_b32 v45, v49
v_permlane16_swap_b32 v46, v50
v_permlane16_swap_b32 v47, v51
v_permlane16_swap_b32 v52, v56
v_permlane16_swap_b32 v53, v57
v_permlane16_swap_b32 v54, v58
v_permlane16_swap_b32 v55, v59
v_permlane16_swap_b32 v60, v64
v_permlane16_swap_b32 v61, v65
v_permlane16_swap_b32 v62, v66
v_permlane16_swap_b32 v63, v67
s_nop 1
v_pk_mul_f32 v[44:45], v[44:45], v[218:219] op_sel_hi:[1,0]
v_pk_mul_f32 v[46:47], v[46:47], v[218:219] op_sel_hi:[1,0]
v_pk_mul_f32 v[48:49], v[48:49], v[218:219] op_sel_hi:[1,0]
v_pk_mul_f32 v[50:51], v[50:51], v[218:219] op_sel_hi:[1,0]
v_pk_fma_f32 v[44:45], v[128:129], v[218:219], v[44:45] op_sel:[0,1,0] op_sel_hi:[1,1,1]
v_pk_fma_f32 v[46:47], v[130:131], v[218:219], v[46:47] op_sel:[0,1,0] op_sel_hi:[1,1,1]
v_pk_fma_f32 v[48:49], v[132:133], v[218:219], v[48:49] op_sel:[0,1,0] op_sel_hi:[1,1,1]
v_pk_fma_f32 v[50:51], v[134:135], v[218:219], v[50:51] op_sel:[0,1,0] op_sel_hi:[1,1,1]
v_pk_mul_f32 v[184:185], v[44:45], v[44:45]
v_pk_mul_f32 v[186:187], v[46:47], v[46:47]
v_pk_mul_f32 v[188:189], v[48:49], v[48:49]
v_pk_mul_f32 v[190:191], v[50:51], v[50:51]
v_pk_fma_f32 v[184:185], v[184:185], s[72:73], v[192:193]
v_pk_fma_f32 v[186:187], v[186:187], s[72:73], v[192:193]
v_pk_fma_f32 v[188:189], v[188:189], s[72:73], v[192:193]
v_pk_fma_f32 v[190:191], v[190:191], s[72:73], v[192:193]
v_pk_mul_f32 v[184:185], v[184:185], v[44:45]
v_pk_mul_f32 v[186:187], v[186:187], v[46:47]
v_pk_mul_f32 v[188:189], v[188:189], v[48:49]
v_pk_mul_f32 v[190:191], v[190:191], v[50:51]
v_exp_f32 v184, v184
v_exp_f32 v185, v185
v_exp_f32 v186, v186
v_exp_f32 v187, v187
v_exp_f32 v188, v188
v_exp_f32 v189, v189
v_exp_f32 v190, v190
v_exp_f32 v191, v191
s_nop 0
v_pk_add_f32 v[184:185], v[184:185], 1.0 op_sel_hi:[1,0]
v_pk_add_f32 v[186:187], v[186:187], 1.0 op_sel_hi:[1,0]
v_pk_add_f32 v[188:189], v[188:189], 1.0 op_sel_hi:[1,0]
v_pk_add_f32 v[190:191], v[190:191], 1.0 op_sel_hi:[1,0]
v_rcp_f32 v184, v184
v_rcp_f32 v185, v185
v_rcp_f32 v186, v186
v_rcp_f32 v187, v187
v_rcp_f32 v188, v188
v_rcp_f32 v189, v189
v_rcp_f32 v190, v190
v_rcp_f32 v191, v191
s_nop 0
v_pk_mul_f32 v[44:45], v[44:45], v[184:185]
v_pk_mul_f32 v[46:47], v[46:47], v[186:187]
v_pk_mul_f32 v[48:49], v[48:49], v[188:189]
v_pk_mul_f32 v[50:51], v[50:51], v[190:191]
v_pk_mul_f32 v[52:53], v[52:53], v[218:219] op_sel_hi:[1,0]
v_pk_mul_f32 v[54:55], v[54:55], v[218:219] op_sel_hi:[1,0]
v_pk_mul_f32 v[56:57], v[56:57], v[218:219] op_sel_hi:[1,0]
v_pk_mul_f32 v[58:59], v[58:59], v[218:219] op_sel_hi:[1,0]
v_pk_fma_f32 v[52:53], v[136:137], v[218:219], v[52:53] op_sel:[0,1,0] op_sel_hi:[1,1,1]
v_pk_fma_f32 v[54:55], v[138:139], v[218:219], v[54:55] op_sel:[0,1,0] op_sel_hi:[1,1,1]
v_pk_fma_f32 v[56:57], v[140:141], v[218:219], v[56:57] op_sel:[0,1,0] op_sel_hi:[1,1,1]
v_pk_fma_f32 v[58:59], v[142:143], v[218:219], v[58:59] op_sel:[0,1,0] op_sel_hi:[1,1,1]
v_pk_mul_f32 v[184:185], v[52:53], v[52:53]
v_pk_mul_f32 v[186:187], v[54:55], v[54:55]
v_pk_mul_f32 v[188:189], v[56:57], v[56:57]
v_pk_mul_f32 v[190:191], v[58:59], v[58:59]
v_pk_fma_f32 v[184:185], v[184:185], s[72:73], v[192:193]
v_pk_fma_f32 v[186:187], v[186:187], s[72:73], v[192:193]
v_pk_fma_f32 v[188:189], v[188:189], s[72:73], v[192:193]
v_pk_fma_f32 v[190:191], v[190:191], s[72:73], v[192:193]
v_pk_mul_f32 v[184:185], v[184:185], v[52:53]
v_pk_mul_f32 v[186:187], v[186:187], v[54:55]
v_pk_mul_f32 v[188:189], v[188:189], v[56:57]
v_pk_mul_f32 v[190:191], v[190:191], v[58:59]
v_exp_f32 v184, v184
v_exp_f32 v185, v185
v_exp_f32 v186, v186
v_exp_f32 v187, v187
v_exp_f32 v188, v188
v_exp_f32 v189, v189
v_exp_f32 v190, v190
v_exp_f32 v191, v191
s_nop 0
v_pk_add_f32 v[184:185], v[184:185], 1.0 op_sel_hi:[1,0]
v_pk_add_f32 v[186:187], v[186:187], 1.0 op_sel_hi:[1,0]
v_pk_add_f32 v[188:189], v[188:189], 1.0 op_sel_hi:[1,0]
v_pk_add_f32 v[190:191], v[190:191], 1.0 op_sel_hi:[1,0]
v_rcp_f32 v184, v184
v_rcp_f32 v185, v185
v_rcp_f32 v186, v186
v_rcp_f32 v187, v187
v_rcp_f32 v188, v188
v_rcp_f32 v189, v189
v_rcp_f32 v190, v190
v_rcp_f32 v191, v191
s_nop 0
v_pk_mul_f32 v[52:53], v[52:53], v[184:185]
v_pk_mul_f32 v[54:55], v[54:55], v[186:187]
v_pk_mul_f32 v[56:57], v[56:57], v[188:189]
v_pk_mul_f32 v[58:59], v[58:59], v[190:191]
v_pk_mul_f32 v[60:61], v[60:61], v[218:219] op_sel_hi:[1,0]
v_pk_mul_f32 v[62:63], v[62:63], v[218:219] op_sel_hi:[1,0]
v_pk_mul_f32 v[64:65], v[64:65], v[218:219] op_sel_hi:[1,0]
v_pk_mul_f32 v[66:67], v[66:67], v[218:219] op_sel_hi:[1,0]
v_pk_fma_f32 v[60:61], v[144:145], v[218:219], v[60:61] op_sel:[0,1,0] op_sel_hi:[1,1,1]
v_pk_fma_f32 v[62:63], v[146:147], v[218:219], v[62:63] op_sel:[0,1,0] op_sel_hi:[1,1,1]
v_pk_fma_f32 v[64:65], v[148:149], v[218:219], v[64:65] op_sel:[0,1,0] op_sel_hi:[1,1,1]
v_pk_fma_f32 v[66:67], v[150:151], v[218:219], v[66:67] op_sel:[0,1,0] op_sel_hi:[1,1,1]
v_pk_mul_f32 v[184:185], v[60:61], v[60:61]
v_pk_mul_f32 v[186:187], v[62:63], v[62:63]
v_pk_mul_f32 v[188:189], v[64:65], v[64:65]
v_pk_mul_f32 v[190:191], v[66:67], v[66:67]
v_pk_fma_f32 v[184:185], v[184:185], s[72:73], v[192:193]
v_pk_fma_f32 v[186:187], v[186:187], s[72:73], v[192:193]
v_pk_fma_f32 v[188:189], v[188:189], s[72:73], v[192:193]
v_pk_fma_f32 v[190:191], v[190:191], s[72:73], v[192:193]
v_pk_mul_f32 v[184:185], v[184:185], v[60:61]
v_pk_mul_f32 v[186:187], v[186:187], v[62:63]
v_pk_mul_f32 v[188:189], v[188:189], v[64:65]
v_pk_mul_f32 v[190:191], v[190:191], v[66:67]
v_exp_f32 v184, v184
v_exp_f32 v185, v185
v_exp_f32 v186, v186
v_exp_f32 v187, v187
v_exp_f32 v188, v188
v_exp_f32 v189, v189
v_exp_f32 v190, v190
v_exp_f32 v191, v191
s_nop 0
v_pk_add_f32 v[184:185], v[184:185], 1.0 op_sel_hi:[1,0]
v_pk_add_f32 v[186:187], v[186:187], 1.0 op_sel_hi:[1,0]
v_pk_add_f32 v[188:189], v[188:189], 1.0 op_sel_hi:[1,0]
v_pk_add_f32 v[190:191], v[190:191], 1.0 op_sel_hi:[1,0]
v_rcp_f32 v184, v184
v_rcp_f32 v185, v185
v_rcp_f32 v186, v186
v_rcp_f32 v187, v187
v_rcp_f32 v188, v188
v_rcp_f32 v189, v189
v_rcp_f32 v190, v190
v_rcp_f32 v191, v191
s_nop 0
v_pk_mul_f32 v[60:61], v[60:61], v[184:185]
v_pk_mul_f32 v[62:63], v[62:63], v[186:187]
v_pk_mul_f32 v[64:65], v[64:65], v[188:189]
v_pk_mul_f32 v[66:67], v[66:67], v[190:191]
v_pk_mul_f32 v[68:69], v[68:69], v[218:219] op_sel_hi:[1,0]
v_pk_mul_f32 v[70:71], v[70:71], v[218:219] op_sel_hi:[1,0]
v_pk_fma_f32 v[68:69], v[152:153], v[218:219], v[68:69] op_sel:[0,1,0] op_sel_hi:[1,1,1]
v_pk_fma_f32 v[70:71], v[154:155], v[218:219], v[70:71] op_sel:[0,1,0] op_sel_hi:[1,1,1]
v_pk_mul_f32 v[184:185], v[68:69], v[68:69]
v_pk_mul_f32 v[186:187], v[70:71], v[70:71]
v_pk_fma_f32 v[184:185], v[184:185], s[72:73], v[192:193]
v_pk_fma_f32 v[186:187], v[186:187], s[72:73], v[192:193]
v_pk_mul_f32 v[184:185], v[184:185], v[68:69]
v_pk_mul_f32 v[186:187], v[186:187], v[70:71]
v_exp_f32 v184, v184
v_exp_f32 v185, v185
v_exp_f32 v186, v186
v_exp_f32 v187, v187
s_nop 0
v_pk_add_f32 v[184:185], v[184:185], 1.0 op_sel_hi:[1,0]
v_pk_add_f32 v[186:187], v[186:187], 1.0 op_sel_hi:[1,0]
v_rcp_f32 v184, v184
v_rcp_f32 v185, v185
v_rcp_f32 v186, v186
v_rcp_f32 v187, v187
s_nop 0
v_pk_mul_f32 v[68:69], v[68:69], v[184:185]
v_pk_mul_f32 v[70:71], v[70:71], v[186:187]
v_cvt_pk_bf16_f32 v240, v44, v45
v_cvt_pk_bf16_f32 v241, v46, v47
v_cvt_pk_bf16_f32 v242, v48, v49
v_cvt_pk_bf16_f32 v243, v50, v51
v_cvt_pk_bf16_f32 v244, v52, v53
v_cvt_pk_bf16_f32 v245, v54, v55
v_cvt_pk_bf16_f32 v246, v56, v57
v_cvt_pk_bf16_f32 v247, v58, v59
v_cvt_pk_bf16_f32 v248, v60, v61
v_cvt_pk_bf16_f32 v249, v62, v63
v_cvt_pk_bf16_f32 v250, v64, v65
v_cvt_pk_bf16_f32 v251, v66, v67
v_cvt_pk_bf16_f32 v252, v68, v69
v_cvt_pk_bf16_f32 v253, v70, v71
v_and_b32 v203, 31, v1
v_lshlrev_b32 v203, 3, v203
v_lshrrev_b32 v202, 5, v1
v_lshl_add_u32 v203, v202, 11, v203
v_and_b32 v204, 31, v1
v_lshlrev_b32 v204, 7, v204
s_branch Lp4_p1
Lp4_poll:
s_sleep 4
buffer_load_dword v202, v204, s[24:27], s68 offen sc1
s_waitcnt vmcnt(0)
v_cmp_eq_u32 vcc, -1, v202
s_nop 4
s_cbranch_vccnz Lp4_poll
Lp4_p1:
buffer_load_dwordx2 v[128:129], v203, s[24:27], s68 offen offset:0 sc1
buffer_load_dwordx2 v[130:131], v203, s[24:27], s68 offen offset:256 sc1
buffer_load_dwordx2 v[132:133], v203, s[24:27], s68 offen offset:512 sc1
buffer_load_dwordx2 v[134:135], v203, s[24:27], s68 offen offset:768 sc1
buffer_load_dwordx2 v[136:137], v203, s[24:27], s68 offen offset:1024 sc1
buffer_load_dwordx2 v[138:139], v203, s[24:27], s68 offen offset:1280 sc1
buffer_load_dwordx2 v[140:141], v203, s[24:27], s68 offen offset:1536 sc1
buffer_load_dwordx2 v[142:143], v203, s[24:27], s68 offen offset:1792 sc1
s_waitcnt vmcnt(0)
v_max_u32 v202, v128, v129
v_max3_u32 v202, v130, v131, v202
v_max3_u32 v202, v132, v133, v202
v_max3_u32 v202, v134, v135, v202
v_max3_u32 v202, v136, v137, v202
v_max3_u32 v202, v138, v139, v202
v_max3_u32 v202, v140, v141, v202
v_max3_u32 v202, v142, v143, v202
v_cmp_eq_u32 vcc, -1, v202
s_nop 4
s_cbranch_vccnz Lp4_poll
v_pk_add_f32 v[128:129], v[128:129], v[130:131]
v_pk_add_f32 v[128:129], v[128:129], v[132:133]
v_pk_add_f32 v[128:129], v[128:129], v[134:135]
v_pk_add_f32 v[128:129], v[128:129], v[136:137]
v_pk_add_f32 v[128:129], v[128:129], v[138:139]
v_pk_add_f32 v[128:129], v[128:129], v[140:141]
v_pk_add_f32 v[128:129], v[128:129], v[142:143]
v_mov_b64 v[130:131], v[128:129]
s_nop 1
v_permlane32_swap_b32 v128, v130
v_permlane32_swap_b32 v129, v131
s_nop 1
v_pk_add_f32 v[128:129], v[128:129], v[130:131]
v_mul_f32 v128, 0x3a124925, v128
v_mul_f32 v129, 0x3a124925, v129
v_fma_f32 v129, -v128, v128, v129
v_max_f32 v129, 0, v129
v_add_f32 v129, 0x3727c5ac, v129
v_rsq_f32 v130, v129
s_nop 0
v_mul_f32 v131, -v128, v130
v_lshlrev_b32 v202, 2, v2
ds_bpermute_b32 v216, v202, v130 offset:0
ds_bpermute_b32 v217, v202, v131 offset:0
ds_bpermute_b32 v218, v202, v130 offset:64
ds_bpermute_b32 v219, v202, v131 offset:64
s_waitcnt lgkmcnt(0)
v_pk_fma_f32 v[72:73], v[72:73], v[216:217], v[216:217] op_sel:[0,0,1] op_sel_hi:[1,0,1]
v_pk_fma_f32 v[74:75], v[74:75], v[216:217], v[216:217] op_sel:[0,0,1] op_sel_hi:[1,0,1]
v_pk_fma_f32 v[76:77], v[76:77], v[216:217], v[216:217] op_sel:[0,0,1] op_sel_hi:[1,0,1]
v_pk_fma_f32 v[78:79], v[78:79], v[216:217], v[216:217] op_sel:[0,0,1] op_sel_hi:[1,0,1]
v_cvt_pk_bf16_f32 v72, v72, v73
v_cvt_pk_bf16_f32 v73, v74, v75
v_cvt_pk_bf16_f32 v74, v76, v77
v_cvt_pk_bf16_f32 v75, v78, v79
buffer_store_dwordx4 v[72:75], v220, s[16:19], s64 offen offset:0  sc1
v_pk_fma_f32 v[80:81], v[80:81], v[216:217], v[216:217] op_sel:[0,0,1] op_sel_hi:[1,0,1]
v_pk_fma_f32 v[82:83], v[82:83], v[216:217], v[216:217] op_sel:[0,0,1] op_sel_hi:[1,0,1]
v_pk_fma_f32 v[84:85], v[84:85], v[216:217], v[216:217] op_sel:[0,0,1] op_sel_hi:[1,0,1]
v_pk_fma_f32 v[86:87], v[86:87], v[216:217], v[216:217] op_sel:[0,0,1] op_sel_hi:[1,0,1]
v_cvt_pk_bf16_f32 v80, v80, v81
v_cvt_pk_bf16_f32 v81, v82, v83
v_cvt_pk_bf16_f32 v82, v84, v85
v_cvt_pk_bf16_f32 v83, v86, v87
buffer_store_dwordx4 v[80:83], v220, s[16:19], s65 offen offset:0  sc1
v_pk_fma_f32 v[88:89], v[88:89], v[216:217], v[216:217] op_sel:[0,0,1] op_sel_hi:[1,0,1]
v_pk_fma_f32 v[90:91], v[90:91], v[216:217], v[216:217] op_sel:[0,0,1] op_sel_hi:[1,0,1]
v_pk_fma_f32 v[92:93], v[92:93], v[216:217], v[216:217] op_sel:[0,0,1] op_sel_hi:[1,0,1]
v_pk_fma_f32 v[94:95], v[94:95], v[216:217], v[216:217] op_sel:[0,0,1] op_sel_hi:[1,0,1]
v_cvt_pk_bf16_f32 v88, v88, v89
v_cvt_pk_bf16_f32 v89, v90, v91
v_cvt_pk_bf16_f32 v90, v92, v93
v_cvt_pk_bf16_f32 v91, v94, v95
buffer_store_dwordx4 v[88:91], v220, s[16:19], s66 offen offset:0  sc1
v_pk_fma_f32 v[96:97], v[96:97], v[216:217], v[216:217] op_sel:[0,0,1] op_sel_hi:[1,0,1]
v_pk_fma_f32 v[98:99], v[98:99], v[216:217], v[216:217] op_sel:[0,0,1] op_sel_hi:[1,0,1]
v_cvt_pk_bf16_f32 v96, v96, v97
v_cvt_pk_bf16_f32 v97, v98, v99
buffer_store_dwordx2 v[96:97], v221, s[16:19], s67 offen offset:0  sc1
v_pk_fma_f32 v[100:101], v[100:101], v[218:219], v[218:219] op_sel:[0,0,1] op_sel_hi:[1,0,1]
v_pk_fma_f32 v[102:103], v[102:103], v[218:219], v[218:219] op_sel:[0,0,1] op_sel_hi:[1,0,1]
v_pk_fma_f32 v[104:105], v[104:105], v[218:219], v[218:219] op_sel:[0,0,1] op_sel_hi:[1,0,1]
v_pk_fma_f32 v[106:107], v[106:107], v[218:219], v[218:219] op_sel:[0,0,1] op_sel_hi:[1,0,1]
v_cvt_pk_bf16_f32 v100, v100, v101
v_cvt_pk_bf16_f32 v101, v102, v103
v_cvt_pk_bf16_f32 v102, v104, v105
v_cvt_pk_bf16_f32 v103, v106, v107
buffer_store_dwordx4 v[100:103], v220, s[16:19], s64 offen offset:1024  sc1
v_pk_fma_f32 v[108:109], v[108:109], v[218:219], v[218:219] op_sel:[0,0,1] op_sel_hi:[1,0,1]
v_pk_fma_f32 v[110:111], v[110:111], v[218:219], v[218:219] op_sel:[0,0,1] op_sel_hi:[1,0,1]
v_pk_fma_f32 v[112:113], v[112:113], v[218:219], v[218:219] op_sel:[0,0,1] op_sel_hi:[1,0,1]
v_pk_fma_f32 v[114:115], v[114:115], v[218:219], v[218:219] op_sel:[0,0,1] op_sel_hi:[1,0,1]
v_cvt_pk_bf16_f32 v108, v108, v109
v_cvt_pk_bf16_f32 v109, v110, v111
v_cvt_pk_bf16_f32 v110, v112, v113
v_cvt_pk_bf16_f32 v111, v114, v115
buffer_store_dwordx4 v[108:111], v220, s[16:19], s65 offen offset:1024  sc1
v_pk_fma_f32 v[116:117], v[116:117], v[218:219], v[218:219] op_sel:[0,0,1] op_sel_hi:[1,0,1]
v_pk_fma_f32 v[118:119], v[118:119], v[218:219], v[218:219] op_sel:[0,0,1] op_sel_hi:[1,0,1]
v_pk_fma_f32 v[120:121], v[120:121], v[218:219], v[218:219] op_sel:[0,0,1] op_sel_hi:[1,0,1]
v_pk_fma_f32 v[122:123], v[122:123], v[218:219], v[218:219] op_sel:[0,0,1] op_sel_hi:[1,0,1]
v_cvt_pk_bf16_f32 v116, v116, v117
v_cvt_pk_bf16_f32 v117, v118, v119
v_cvt_pk_bf16_f32 v118, v120, v121
v_cvt_pk_bf16_f32 v119, v122, v123
buffer_store_dwordx4 v[116:119], v220, s[16:19], s66 offen offset:1024  sc1
v_pk_fma_f32 v[124:125], v[124:125], v[218:219], v[218:219] op_sel:[0,0,1] op_sel_hi:[1,0,1]
v_pk_fma_f32 v[126:127], v[126:127], v[218:219], v[218:219] op_sel:[0,0,1] op_sel_hi:[1,0,1]
v_cvt_pk_bf16_f32 v124, v124, v125
v_cvt_pk_bf16_f32 v125, v126, v127
buffer_store_dwordx2 v[124:125], v221, s[16:19], s67 offen offset:512  sc1
s_lshl_b32 s3, s28, 4
s_add_u32 s3, s3, s29
s_lshl_b32 s3, s3, 3
s_add_u32 s3, s3, s30
s_lshl_b32 s3, s3, 2
s_add_u32 s3, s3, 32768
v_mov_b32 v12, s100
s_mov_b64 exec, 1
s_waitcnt vmcnt(0)
buffer_store_dword v12, off, s[96:99], s3 sc1
s_mov_b64 exec, -1
s_and_b32 s3, s2, 7
s_lshr_b32 s4, s2, 3
s_and_b32 s28, s3, 1
s_lshl_b32 s28, s28, 3
s_and_b32 s5, s4, 7
s_add_u32 s28, s28, s5
s_lshr_b32 s29, s3, 1
s_lshl_b32 s29, s29, 2
s_lshr_b32 s5, s4, 3
s_add_u32 s29, s29, s5
s_mov_b32 s62, s30
s_mov_b32 s63, 0
s_mul_i32 s5, s62, 4096
v_bfe_u32 v16, v2, 1, 3
v_xor_b32 v16, v16, v3
v_lshlrev_b32 v16, 4, v16
v_lshl_add_u32 v16, v2, 7, v16
v_add_u32 v4, s5, v16
v_xor_b32 v5, 64, v4
v_bfe_u32 v16, v1, 2, 3
v_bfe_u32 v17, v1, 5, 1
v_lshl_add_u32 v17, v17, 4, v16
v_mul_u32_u24 v17, 64, v17
v_and_b32 v18, 3, v1
v_lshl_add_u32 v17, v18, 3, v17
v_add_u32 v17, 16384, v17
s_mul_i32 s5, s63, 7
v_lshlrev_b32 v19, 2, v18
v_lshrrev_b32 v8, 1, v17
v_add_u32 v8, v8, v19
v_add_u32 v8, 20480, v8
v_bfe_u32 v18, v16, 2, 1
s_add_u32 s6, s5, 0
v_xor_b32 v19, s6, v18
v_lshl_add_u32 v6, v19, 5, v17
s_add_u32 s6, s5, 1
v_xor_b32 v19, s6, v18
v_lshl_add_u32 v7, v19, 5, v17
s_add_u32 s16, s60, 41943040
s_addc_u32 s17, s61, 0
s_mov_b32 s18, 7340032
s_mov_b32 s19, 0x00020000
s_mov_b32 s24, s52
s_mov_b32 s25, s53
s_mov_b32 s26, 4096
s_mov_b32 s27, 0x00020000
s_lshr_b32 s3, s29, 1
s_mul_i32 s3, s3, 917504
s_lshl_b32 s4, s28, 12
s_lshl_b32 s5, s30, 10
s_add_u32 s5, s5, s4
s_add_u32 s67, s3, s5
s_add_u32 s3, s67, s5
s_and_b32 s4, s29, 1
s_lshl_b32 s5, s4, 16
s_add_u32 s67, s67, s5
s_add_u32 s67, s67, 0x60000
s_lshl_b32 s4, s4, 19
s_add_u32 s64, s3, s4
s_add_u32 s65, s64, 0x20000
s_add_u32 s66, s64, 0x40000
v_and_b32 v16, 1, v3
v_lshrrev_b32 v17, 1, v3
v_lshl_add_u32 v16, v16, 1, v17
v_mul_u32_u24 v148, 16, v16
v_mul_u32_u24 v149, 8, v3
v_mul_u32_u24 v16, 64, v2
v_add_u32 v148, v148, v16
v_lshrrev_b32 v16, 1, v16
v_add_u32 v149, v149, v16
s_lshl_b32 s5, s28, 2
s_add_u32 s5, s5, s30
s_lshl_b32 s5, s5, 6
v_lshlrev_b32 v16, 1, v2
buffer_load_ushort v152, v16, s[24:27], s5 offen offset:0
buffer_load_ushort v154, v16, s[24:27], s5 offen offset:32
v_lshlrev_b32 v16, 7, v1
s_lshl_b32 s88, s2, 2
s_add_u32 s88, s88, s30
v_mov_b64 v[20:21], 0
v_mov_b64 v[22:23], 0
v_mov_b64 v[24:25], 0
v_mov_b64 v[26:27], 0
v_mov_b64 v[28:29], 0
v_mov_b64 v[30:31], 0
v_mov_b64 v[32:33], 0
v_mov_b64 v[34:35], 0
v_mov_b64 v[36:37], 0
v_mov_b64 v[38:39], 0
v_mov_b64 v[40:41], 0
v_mov_b64 v[42:43], 0
v_mov_b64 v[44:45], 0
v_mov_b64 v[46:47], 0
v_mov_b64 v[48:49], 0
v_mov_b64 v[50:51], 0
v_mov_b64 v[52:53], 0
v_mov_b64 v[54:55], 0
v_mov_b64 v[56:57], 0
v_mov_b64 v[58:59], 0
v_mov_b64 v[60:61], 0
v_mov_b64 v[62:63], 0
v_mov_b64 v[64:65], 0
v_mov_b64 v[66:67], 0
v_mov_b64 v[68:69], 0
v_mov_b64 v[70:71], 0
v_mov_b64 v[72:73], 0
v_mov_b64 v[74:75], 0
s_mov_b32 s33, 32
s_mov_b32 s34, 0
s_mov_b32 s35, 0
v_add_u32 v12, s34, v6
v_add_u32 v13, s34, v7
v_add_u32 v14, s34, v8
v_add_u32 v10, s34, v4
v_add_u32 v11, s34, v5
s_barrier
s_barrier
ds_read_b64_tr_b16 v[84:85], v12 offset:0
ds_read_b64_tr_b16 v[86:87], v12 offset:512
ds_read_b128 v[76:79], v10 offset:0
ds_read_b128 v[80:83], v10 offset:2048
ds_read_b64_tr_b16 v[88:89], v13 offset:0
ds_read_b64_tr_b16 v[90:91], v13 offset:512
ds_read_b64_tr_b16 v[92:93], v12 offset:4096
ds_read_b64_tr_b16 v[94:95], v12 offset:4608
ds_read_b64_tr_b16 v[96:97], v13 offset:4096
ds_read_b64_tr_b16 v[98:99], v13 offset:4608
ds_read_b64_tr_b16 v[100:101], v12 offset:8192
ds_read_b64_tr_b16 v[102:103], v12 offset:8704
ds_read_b64_tr_b16 v[104:105], v13 offset:8192
ds_read_b64_tr_b16 v[106:107], v13 offset:8704
ds_read_b64_tr_b16 v[108:109], v14 offset:0
ds_read_b64_tr_b16 v[110:111], v14 offset:256
Lp5_loop:
s_waitcnt lgkmcnt(0)
v_mfma_f32_16x16x32_bf16 v[20:23], v[84:87], v[76:79], v[20:23]
ds_read_b64_tr_b16 v[120:121], v12 offset:2048
ds_read_b64_tr_b16 v[122:123], v12 offset:2560
v_mfma_f32_16x16x32_bf16 v[48:51], v[84:87], v[80:83], v[48:51]
ds_read_b128 v[112:115], v11 offset:0
ds_read_b128 v[116:119], v11 offset:2048
v_mfma_f32_16x16x32_bf16 v[24:27], v[88:91], v[76:79], v[24:27]
ds_read_b64_tr_b16 v[124:125], v13 offset:2048
ds_read_b64_tr_b16 v[126:127], v13 offset:2560
v_mfma_f32_16x16x32_bf16 v[52:55], v[88:91], v[80:83], v[52:55]
ds_read_b64_tr_b16 v[128:129], v12 offset:6144
ds_read_b64_tr_b16 v[130:131], v12 offset:6656
v_mfma_f32_16x16x32_bf16 v[28:31], v[92:95], v[76:79], v[28:31]
ds_read_b64_tr_b16 v[132:133], v13 offset:6144
ds_read_b64_tr_b16 v[134:135], v13 offset:6656
v_mfma_f32_16x16x32_bf16 v[56:59], v[92:95], v[80:83], v[56:59]
ds_read_b64_tr_b16 v[136:137], v12 offset:10240
ds_read_b64_tr_b16 v[138:139], v12 offset:10752
v_mfma_f32_16x16x32_bf16 v[32:35], v[96:99], v[76:79], v[32:35]
ds_read_b64_tr_b16 v[140:141], v13 offset:10240
ds_read_b64_tr_b16 v[142:143], v13 offset:10752
v_mfma_f32_16x16x32_bf16 v[60:63], v[96:99], v[80:83], v[60:63]
ds_read_b64_tr_b16 v[144:145], v14 offset:1024
ds_read_b64_tr_b16 v[146:147], v14 offset:1280
v_mfma_f32_16x16x32_bf16 v[36:39], v[100:103], v[76:79], v[36:39]
s_add_u32 s34, s34, 32768
s_cmp_eq_u32 s34, 163840
s_cselect_b32 s34, 0, s34
v_add_u32 v12, s34, v6
v_mfma_f32_16x16x32_bf16 v[64:67], v[100:103], v[80:83], v[64:67]
v_add_u32 v13, s34, v7
v_add_u32 v14, s34, v8
v_mfma_f32_16x16x32_bf16 v[40:43], v[104:107], v[76:79], v[40:43]
v_add_u32 v10, s34, v4
v_add_u32 v11, s34, v5
v_mfma_f32_16x16x32_bf16 v[68:71], v[104:107], v[80:83], v[68:71]
v_mfma_f32_16x16x32_bf16 v[44:47], v[108:111], v[76:79], v[44:47]
v_mfma_f32_16x16x32_bf16 v[72:75], v[108:111], v[80:83], v[72:75]
s_waitcnt lgkmcnt(0)
v_mfma_f32_16x16x32_bf16 v[20:23], v[120:123], v[112:115], v[20:23]
s_barrier
v_mfma_f32_16x16x32_bf16 v[48:51], v[120:123], v[116:119], v[48:51]
ds_read_b64_tr_b16 v[84:85], v12 offset:0
ds_read_b64_tr_b16 v[86:87], v12 offset:512
v_mfma_f32_16x16x32_bf16 v[24:27], v[124:127], v[112:115], v[24:27]
ds_read_b128 v[76:79], v10 offset:0
ds_read_b128 v[80:83], v10 offset:2048
v_mfma_f32_16x16x32_bf16 v[52:55], v[124:127], v[116:119], v[52:55]
ds_read_b64_tr_b16 v[88:89], v13 offset:0
ds_read_b64_tr_b16 v[90:91], v13 offset:512
v_mfma_f32_16x16x32_bf16 v[28:31], v[128:131], v[112:115], v[28:31]
ds_read_b64_tr_b16 v[92:93], v12 offset:4096
ds_read_b64_tr_b16 v[94:95], v12 offset:4608
v_mfma_f32_16x16x32_bf16 v[56:59], v[128:131], v[116:119], v[56:59]
ds_read_b64_tr_b16 v[96:97], v13 offset:4096
ds_read_b64_tr_b16 v[98:99], v13 offset:4608
v_mfma_f32_16x16x32_bf16 v[32:35], v[132:135], v[112:115], v[32:35]
ds_read_b64_tr_b16 v[100:101], v12 offset:8192
ds_read_b64_tr_b16 v[102:103], v12 offset:8704
v_mfma_f32_16x16x32_bf16 v[60:63], v[132:135], v[116:119], v[60:63]
ds_read_b64_tr_b16 v[104:105], v13 offset:8192
ds_read_b64_tr_b16 v[106:107], v13 offset:8704
v_mfma_f32_16x16x32_bf16 v[36:39], v[136:139], v[112:115], v[36:39]
ds_read_b64_tr_b16 v[108:109], v14 offset:0
ds_read_b64_tr_b16 v[110:111], v14 offset:256
v_mfma_f32_16x16x32_bf16 v[64:67], v[136:139], v[116:119], v[64:67]
s_sub_u32 s33, s33, 1
s_cmp_lg_u32 s33, 0
v_mfma_f32_16x16x32_bf16 v[40:43], v[140:143], v[112:115], v[40:43]
v_mfma_f32_16x16x32_bf16 v[68:71], v[140:143], v[116:119], v[68:71]
v_mfma_f32_16x16x32_bf16 v[44:47], v[144:147], v[112:115], v[44:47]
v_mfma_f32_16x16x32_bf16 v[72:75], v[144:147], v[116:119], v[72:75]
s_cbranch_scc1 Lp5_loop
s_waitcnt lgkmcnt(0)
s_nop 7
s_waitcnt vmcnt(0)
v_lshlrev_b32 v152, 16, v152
v_permlane16_swap_b32 v20, v24
v_permlane16_swap_b32 v21, v25
v_permlane16_swap_b32 v22, v26
v_permlane16_swap_b32 v23, v27
v_permlane16_swap_b32 v28, v32
v_permlane16_swap_b32 v29, v33
v_permlane16_swap_b32 v30, v34
v_permlane16_swap_b32 v31, v35
v_permlane16_swap_b32 v36, v40
v_permlane16_swap_b32 v37, v41
v_permlane16_swap_b32 v38, v42
v_permlane16_swap_b32 v39, v43
s_nop 1
v_lshlrev_b32 v76, 16, v224
v_and_b32 v77, 0xffff0000, v224
v_lshlrev_b32 v78, 16, v225
v_and_b32 v79, 0xffff0000, v225
v_lshlrev_b32 v80, 16, v226
v_and_b32 v81, 0xffff0000, v226
v_lshlrev_b32 v82, 16, v227
v_and_b32 v83, 0xffff0000, v227
v_pk_add_f32 v[20:21], v[20:21], v[152:153] op_sel_hi:[1,0]
v_pk_mul_f32 v[20:21], v[20:21], v[76:77]
v_pk_add_f32 v[22:23], v[22:23], v[152:153] op_sel_hi:[1,0]
v_pk_mul_f32 v[22:23], v[22:23], v[78:79]
v_pk_add_f32 v[24:25], v[24:25], v[152:153] op_sel_hi:[1,0]
v_pk_mul_f32 v[24:25], v[24:25], v[80:81]
v_pk_add_f32 v[26:27], v[26:27], v[152:153] op_sel_hi:[1,0]
v_pk_mul_f32 v[26:27], v[26:27], v[82:83]
v_cvt_pk_bf16_f32 v20, v20, v21
v_cvt_pk_bf16_f32 v21, v22, v23
v_cvt_pk_bf16_f32 v22, v24, v25
v_cvt_pk_bf16_f32 v23, v26, v27
buffer_store_dwordx4 v[20:23], v148, s[16:19], s64 offen offset:0  sc1
v_lshlrev_b32 v76, 16, v228
v_and_b32 v77, 0xffff0000, v228
v_lshlrev_b32 v78, 16, v229
v_and_b32 v79, 0xffff0000, v229
v_lshlrev_b32 v80, 16, v230
v_and_b32 v81, 0xffff0000, v230
v_lshlrev_b32 v82, 16, v231
v_and_b32 v83, 0xffff0000, v231
v_pk_add_f32 v[28:29], v[28:29], v[152:153] op_sel_hi:[1,0]
v_pk_mul_f32 v[28:29], v[28:29], v[76:77]
v_pk_add_f32 v[30:31], v[30:31], v[152:153] op_sel_hi:[1,0]
v_pk_mul_f32 v[30:31], v[30:31], v[78:79]
v_pk_add_f32 v[32:33], v[32:33], v[152:153] op_sel_hi:[1,0]
v_pk_mul_f32 v[32:33], v[32:33], v[80:81]
v_pk_add_f32 v[34:35], v[34:35], v[152:153] op_sel_hi:[1,0]
v_pk_mul_f32 v[34:35], v[34:35], v[82:83]
v_cvt_pk_bf16_f32 v28, v28, v29
v_cvt_pk_bf16_f32 v29, v30, v31
v_cvt_pk_bf16_f32 v30, v32, v33
v_cvt_pk_bf16_f32 v31, v34, v35
buffer_store_dwordx4 v[28:31], v148, s[16:19], s65 offen offset:0  sc1
v_lshlrev_b32 v76, 16, v232
v_and_b32 v77, 0xffff0000, v232
v_lshlrev_b32 v78, 16, v233
v_and_b32 v79, 0xffff0000, v233
v_lshlrev_b32 v80, 16, v234
v_and_b32 v81, 0xffff0000, v234
v_lshlrev_b32 v82, 16, v235
v_and_b32 v83, 0xffff0000, v235
v_pk_add_f32 v[36:37], v[36:37], v[152:153] op_sel_hi:[1,0]
v_pk_mul_f32 v[36:37], v[36:37], v[76:77]
v_pk_add_f32 v[38:39], v[38:39], v[152:153] op_sel_hi:[1,0]
v_pk_mul_f32 v[38:39], v[38:39], v[78:79]
v_pk_add_f32 v[40:41], v[40:41], v[152:153] op_sel_hi:[1,0]
v_pk_mul_f32 v[40:41], v[40:41], v[80:81]
v_pk_add_f32 v[42:43], v[42:43], v[152:153] op_sel_hi:[1,0]
v_pk_mul_f32 v[42:43], v[42:43], v[82:83]
v_cvt_pk_bf16_f32 v36, v36, v37
v_cvt_pk_bf16_f32 v37, v38, v39
v_cvt_pk_bf16_f32 v38, v40, v41
v_cvt_pk_bf16_f32 v39, v42, v43
buffer_store_dwordx4 v[36:39], v148, s[16:19], s66 offen offset:0  sc1
v_lshlrev_b32 v76, 16, v236
v_and_b32 v77, 0xffff0000, v236
v_lshlrev_b32 v78, 16, v237
v_and_b32 v79, 0xffff0000, v237
v_pk_add_f32 v[44:45], v[44:45], v[152:153] op_sel_hi:[1,0]
v_pk_mul_f32 v[44:45], v[44:45], v[76:77]
v_pk_add_f32 v[46:47], v[46:47], v[152:153] op_sel_hi:[1,0]
v_pk_mul_f32 v[46:47], v[46:47], v[78:79]
v_cvt_pk_bf16_f32 v44, v44, v45
v_cvt_pk_bf16_f32 v45, v46, v47
buffer_store_dwordx2 v[44:45], v149, s[16:19], s67 offen offset:0  sc1
v_lshlrev_b32 v154, 16, v154
v_permlane16_swap_b32 v48, v52
v_permlane16_swap_b32 v49, v53
v_permlane16_swap_b32 v50, v54
v_permlane16_swap_b32 v51, v55
v_permlane16_swap_b32 v56, v60
v_permlane16_swap_b32 v57, v61
v_permlane16_swap_b32 v58, v62
v_permlane16_swap_b32 v59, v63
v_permlane16_swap_b32 v64, v68
v_permlane16_swap_b32 v65, v69
v_permlane16_swap_b32 v66, v70
v_permlane16_swap_b32 v67, v71
s_nop 1
v_lshlrev_b32 v76, 16, v240
v_and_b32 v77, 0xffff0000, v240
v_lshlrev_b32 v78, 16, v241
v_and_b32 v79, 0xffff0000, v241
v_lshlrev_b32 v80, 16, v242
v_and_b32 v81, 0xffff0000, v242
v_lshlrev_b32 v82, 16, v243
v_and_b32 v83, 0xffff0000, v243
v_pk_add_f32 v[48:49], v[48:49], v[154:155] op_sel_hi:[1,0]
v_pk_mul_f32 v[48:49], v[48:49], v[76:77]
v_pk_add_f32 v[50:51], v[50:51], v[154:155] op_sel_hi:[1,0]
v_pk_mul_f32 v[50:51], v[50:51], v[78:79]
v_pk_add_f32 v[52:53], v[52:53], v[154:155] op_sel_hi:[1,0]
v_pk_mul_f32 v[52:53], v[52:53], v[80:81]
v_pk_add_f32 v[54:55], v[54:55], v[154:155] op_sel_hi:[1,0]
v_pk_mul_f32 v[54:55], v[54:55], v[82:83]
v_cvt_pk_bf16_f32 v48, v48, v49
v_cvt_pk_bf16_f32 v49, v50, v51
v_cvt_pk_bf16_f32 v50, v52, v53
v_cvt_pk_bf16_f32 v51, v54, v55
buffer_store_dwordx4 v[48:51], v148, s[16:19], s64 offen offset:1024  sc1
v_lshlrev_b32 v76, 16, v244
v_and_b32 v77, 0xffff0000, v244
v_lshlrev_b32 v78, 16, v245
v_and_b32 v79, 0xffff0000, v245
v_lshlrev_b32 v80, 16, v246
v_and_b32 v81, 0xffff0000, v246
v_lshlrev_b32 v82, 16, v247
v_and_b32 v83, 0xffff0000, v247
v_pk_add_f32 v[56:57], v[56:57], v[154:155] op_sel_hi:[1,0]
v_pk_mul_f32 v[56:57], v[56:57], v[76:77]
v_pk_add_f32 v[58:59], v[58:59], v[154:155] op_sel_hi:[1,0]
v_pk_mul_f32 v[58:59], v[58:59], v[78:79]
v_pk_add_f32 v[60:61], v[60:61], v[154:155] op_sel_hi:[1,0]
v_pk_mul_f32 v[60:61], v[60:61], v[80:81]
v_pk_add_f32 v[62:63], v[62:63], v[154:155] op_sel_hi:[1,0]
v_pk_mul_f32 v[62:63], v[62:63], v[82:83]
v_cvt_pk_bf16_f32 v56, v56, v57
v_cvt_pk_bf16_f32 v57, v58, v59
v_cvt_pk_bf16_f32 v58, v60, v61
v_cvt_pk_bf16_f32 v59, v62, v63
buffer_store_dwordx4 v[56:59], v148, s[16:19], s65 offen offset:1024  sc1
v_lshlrev_b32 v76, 16, v248
v_and_b32 v77, 0xffff0000, v248
v_lshlrev_b32 v78, 16, v249
v_and_b32 v79, 0xffff0000, v249
v_lshlrev_b32 v80, 16, v250
v_and_b32 v81, 0xffff0000, v250
v_lshlrev_b32 v82, 16, v251
v_and_b32 v83, 0xffff0000, v251
v_pk_add_f32 v[64:65], v[64:65], v[154:155] op_sel_hi:[1,0]
v_pk_mul_f32 v[64:65], v[64:65], v[76:77]
v_pk_add_f32 v[66:67], v[66:67], v[154:155] op_sel_hi:[1,0]
v_pk_mul_f32 v[66:67], v[66:67], v[78:79]
v_pk_add_f32 v[68:69], v[68:69], v[154:155] op_sel_hi:[1,0]
v_pk_mul_f32 v[68:69], v[68:69], v[80:81]
v_pk_add_f32 v[70:71], v[70:71], v[154:155] op_sel_hi:[1,0]
v_pk_mul_f32 v[70:71], v[70:71], v[82:83]
v_cvt_pk_bf16_f32 v64, v64, v65
v_cvt_pk_bf16_f32 v65, v66, v67
v_cvt_pk_bf16_f32 v66, v68, v69
v_cvt_pk_bf16_f32 v67, v70, v71
buffer_store_dwordx4 v[64:67], v148, s[16:19], s66 offen offset:1024  sc1
v_lshlrev_b32 v76, 16, v252
v_and_b32 v77, 0xffff0000, v252
v_lshlrev_b32 v78, 16, v253
v_and_b32 v79, 0xffff0000, v253
v_pk_add_f32 v[72:73], v[72:73], v[154:155] op_sel_hi:[1,0]
v_pk_mul_f32 v[72:73], v[72:73], v[76:77]
v_pk_add_f32 v[74:75], v[74:75], v[154:155] op_sel_hi:[1,0]
v_pk_mul_f32 v[74:75], v[74:75], v[78:79]
v_cvt_pk_bf16_f32 v72, v72, v73
v_cvt_pk_bf16_f32 v73, v74, v75
buffer_store_dwordx2 v[72:73], v149, s[16:19], s67 offen offset:512  sc1
s_barrier
s_lshl_b32 s3, s28, 4
s_add_u32 s3, s3, s29
s_lshl_b32 s3, s3, 3
s_add_u32 s3, s3, s30
s_lshl_b32 s3, s3, 2
s_add_u32 s3, s3, 40960
v_mov_b32 v16, s100
s_mov_b64 exec, 1
s_waitcnt vmcnt(0)
buffer_store_dword v16, off, s[96:99], s3 sc1
s_mov_b64 exec, -1
s_and_b32 s3, s2, 7
s_lshr_b32 s4, s2, 3
s_and_b32 s28, s3, 3
s_lshl_b32 s28, s28, 2
s_and_b32 s5, s4, 3
s_add_u32 s28, s28, s5
s_lshr_b32 s29, s3, 2
s_lshl_b32 s29, s29, 3
s_lshr_b32 s5, s4, 2
s_add_u32 s29, s29, s5
s_mov_b32 s62, s30
s_mov_b32 s63, 0
s_mul_i32 s5, s62, 4096
v_bfe_u32 v20, v2, 1, 3
v_xor_b32 v20, v20, v3
v_lshlrev_b32 v20, 4, v20
v_lshl_add_u32 v20, v2, 7, v20
v_add_u32 v4, s5, v20
v_xor_b32 v5, 64, v4
v_bfe_u32 v20, v1, 2, 3
v_bfe_u32 v21, v1, 5, 1
v_lshl_add_u32 v21, v21, 4, v20
v_mul_u32_u24 v21, 128, v21
v_and_b32 v22, 3, v1
v_lshl_add_u32 v21, v22, 3, v21
v_add_u32 v21, 65536, v21
s_mul_i32 s5, s63, 4
v_bfe_u32 v22, v20, 1, 2
s_add_u32 s6, s5, 0
v_xor_b32 v23, s6, v22
v_lshl_add_u32 v8, v23, 5, v21
s_add_u32 s6, s5, 1
v_xor_b32 v23, s6, v22
v_lshl_add_u32 v9, v23, 5, v21
s_add_u32 s6, s5, 2
v_xor_b32 v23, s6, v22
v_lshl_add_u32 v10, v23, 5, v21
s_add_u32 s6, s5, 3
v_xor_b32 v23, s6, v22
v_lshl_add_u32 v11, v23, 5, v21
s_mov_b32 s16, s56
s_mov_b32 s17, s57
s_mov_b32 s18, 4194304
s_mov_b32 s19, 0x00020000
s_add_u32 s20, s60, 20971520
s_addc_u32 s21, s61, 0
s_mov_b32 s22, 4194304
s_mov_b32 s23, 0x00020000
s_lshl_b32 s3, s28, 18
s_lshl_b32 s4, s30, 16
s_add_u32 s3, s3, s4
s_lshl_b32 s4, s29, 7
s_add_u32 s64, s3, s4
s_add_u32 s65, s64, 0x8000
v_and_b32 v20, 1, v3
v_lshrrev_b32 v21, 1, v3
v_lshl_add_u32 v20, v20, 1, v21
v_mul_u32_u24 v120, 16, v20
v_mul_u32_u24 v121, 8, v3
v_mul_u32_u24 v20, 2048, v2
v_add_u32 v120, v120, v20
v_lshrrev_b32 v20, 0, v20
v_add_u32 v121, v121, v20
s_lshl_b32 s3, s29, 18
s_lshl_b32 s4, s28, 13
s_add_u32 s3, s3, s4
s_lshl_b32 s4, s30, 11
s_add_u32 s68, s3, s4
s_add_u32 s69, s68, 0x20000
v_and_b32 v20, 1, v3
v_lshrrev_b32 v21, 1, v3
v_lshl_add_u32 v20, v20, 1, v21
v_mul_u32_u24 v122, 16, v20
v_mul_u32_u24 v123, 8, v3
v_mul_u32_u24 v20, 64, v2
v_add_u32 v122, v122, v20
v_lshrrev_b32 v20, 0, v20
v_add_u32 v123, v123, v20
buffer_load_dwordx4 v[104:107], v122, s[20:23], s68 offen offset:0 sc1
buffer_load_dwordx4 v[108:111], v122, s[20:23], s69 offen offset:0 sc1
buffer_load_dwordx4 v[112:115], v122, s[20:23], s68 offen offset:1024 sc1
buffer_load_dwordx4 v[116:119], v122, s[20:23], s69 offen offset:1024 sc1
v_lshlrev_b32 v20, 7, v1
s_lshl_b32 s88, s2, 2
s_add_u32 s88, s88, s30
v_mov_b64 v[24:25], 0
v_mov_b64 v[26:27], 0
v_mov_b64 v[28:29], 0
v_mov_b64 v[30:31], 0
v_mov_b64 v[32:33], 0
v_mov_b64 v[34:35], 0
v_mov_b64 v[36:37], 0
v_mov_b64 v[38:39], 0
v_mov_b64 v[40:41], 0
v_mov_b64 v[42:43], 0
v_mov_b64 v[44:45], 0
v_mov_b64 v[46:47], 0
v_mov_b64 v[48:49], 0
v_mov_b64 v[50:51], 0
v_mov_b64 v[52:53], 0
v_mov_b64 v[54:55], 0
s_mov_b32 s33, 28
s_mov_b32 s34, 0
s_mov_b32 s35, 0
v_add_u32 v16, s35, v8
v_add_u32 v17, s35, v9
v_add_u32 v18, s35, v10
v_add_u32 v19, s35, v11
v_add_u32 v12, s34, v4
v_add_u32 v13, s34, v5
s_barrier
s_barrier
ds_read_b64_tr_b16 v[64:65], v16 offset:0
ds_read_b64_tr_b16 v[66:67], v16 offset:1024
ds_read_b128 v[56:59], v12 offset:0
ds_read_b128 v[60:63], v12 offset:2048
ds_read_b64_tr_b16 v[68:69], v17 offset:0
ds_read_b64_tr_b16 v[70:71], v17 offset:1024
ds_read_b64_tr_b16 v[72:73], v18 offset:0
ds_read_b64_tr_b16 v[74:75], v18 offset:1024
ds_read_b64_tr_b16 v[76:77], v19 offset:0
ds_read_b64_tr_b16 v[78:79], v19 offset:1024
s_setprio 0
Lp6_loop:
s_waitcnt lgkmcnt(0)
v_mfma_f32_16x16x32_bf16 v[24:27], v[64:67], v[56:59], v[24:27]
ds_read_b64_tr_b16 v[88:89], v16 offset:4096
ds_read_b64_tr_b16 v[90:91], v16 offset:5120
ds_read_b128 v[80:83], v13 offset:0
v_mfma_f32_16x16x32_bf16 v[40:43], v[64:67], v[60:63], v[40:43]
ds_read_b128 v[84:87], v13 offset:2048
ds_read_b64_tr_b16 v[92:93], v17 offset:4096
ds_read_b64_tr_b16 v[94:95], v17 offset:5120
v_mfma_f32_16x16x32_bf16 v[28:31], v[68:71], v[56:59], v[28:31]
ds_read_b64_tr_b16 v[96:97], v18 offset:4096
ds_read_b64_tr_b16 v[98:99], v18 offset:5120
v_mfma_f32_16x16x32_bf16 v[44:47], v[68:71], v[60:63], v[44:47]
ds_read_b64_tr_b16 v[100:101], v19 offset:4096
ds_read_b64_tr_b16 v[102:103], v19 offset:5120
v_mfma_f32_16x16x32_bf16 v[32:35], v[72:75], v[56:59], v[32:35]
s_add_u32 s34, s34, 16384
s_cmp_eq_u32 s34, 65536
s_cselect_b32 s34, 0, s34
s_add_u32 s35, s35, 8192
s_cmp_eq_u32 s35, 98304
s_cselect_b32 s35, 0, s35
v_mfma_f32_16x16x32_bf16 v[48:51], v[72:75], v[60:63], v[48:51]
v_add_u32 v16, s35, v8
v_add_u32 v17, s35, v9
v_mfma_f32_16x16x32_bf16 v[36:39], v[76:79], v[56:59], v[36:39]
v_add_u32 v18, s35, v10
v_add_u32 v19, s35, v11
v_mfma_f32_16x16x32_bf16 v[52:55], v[76:79], v[60:63], v[52:55]
v_add_u32 v12, s34, v4
v_add_u32 v13, s34, v5
s_waitcnt lgkmcnt(0)
v_mfma_f32_16x16x32_bf16 v[24:27], v[88:91], v[80:83], v[24:27]
s_barrier
v_mfma_f32_16x16x32_bf16 v[40:43], v[88:91], v[84:87], v[40:43]
ds_read_b64_tr_b16 v[64:65], v16 offset:0
ds_read_b64_tr_b16 v[66:67], v16 offset:1024
v_mfma_f32_16x16x32_bf16 v[28:31], v[92:95], v[80:83], v[28:31]
ds_read_b128 v[56:59], v12 offset:0
ds_read_b128 v[60:63], v12 offset:2048
v_mfma_f32_16x16x32_bf16 v[44:47], v[92:95], v[84:87], v[44:47]
ds_read_b64_tr_b16 v[68:69], v17 offset:0
ds_read_b64_tr_b16 v[70:71], v17 offset:1024
v_mfma_f32_16x16x32_bf16 v[32:35], v[96:99], v[80:83], v[32:35]
ds_read_b64_tr_b16 v[72:73], v18 offset:0
ds_read_b64_tr_b16 v[74:75], v18 offset:1024
v_mfma_f32_16x16x32_bf16 v[48:51], v[96:99], v[84:87], v[48:51]
ds_read_b64_tr_b16 v[76:77], v19 offset:0
ds_read_b64_tr_b16 v[78:79], v19 offset:1024
v_mfma_f32_16x16x32_bf16 v[36:39], v[100:103], v[80:83], v[36:39]
s_sub_u32 s33, s33, 1
s_cmp_lg_u32 s33, 0
v_mfma_f32_16x16x32_bf16 v[52:55], v[100:103], v[84:87], v[52:55]
s_cbranch_scc1 Lp6_loop
s_waitcnt lgkmcnt(0)
s_nop 7
s_setprio 3
s_waitcnt vmcnt(0)
v_permlane16_swap_b32 v24, v28
v_permlane16_swap_b32 v25, v29
v_permlane16_swap_b32 v26, v30
v_permlane16_swap_b32 v27, v31
v_permlane16_swap_b32 v32, v36
v_permlane16_swap_b32 v33, v37
v_permlane16_swap_b32 v34, v38
v_permlane16_swap_b32 v35, v39
s_nop 1
v_lshlrev_b32 v56, 16, v104
v_and_b32 v57, 0xffff0000, v104
v_lshlrev_b32 v58, 16, v105
v_and_b32 v59, 0xffff0000, v105
v_lshlrev_b32 v60, 16, v106
v_and_b32 v61, 0xffff0000, v106
v_lshlrev_b32 v62, 16, v107
v_and_b32 v63, 0xffff0000, v107
v_pk_add_f32 v[24:25], v[24:25], v[56:57]
v_pk_add_f32 v[26:27], v[26:27], v[58:59]
v_pk_add_f32 v[28:29], v[28:29], v[60:61]
v_pk_add_f32 v[30:31], v[30:31], v[62:63]
v_cvt_pk_bf16_f32 v24, v24, v25
v_cvt_pk_bf16_f32 v25, v26, v27
v_cvt_pk_bf16_f32 v26, v28, v29
v_cvt_pk_bf16_f32 v27, v30, v31
buffer_store_dwordx4 v[24:27], v120, s[16:19], s64 offen offset:0
v_lshlrev_b32 v56, 16, v108
v_and_b32 v57, 0xffff0000, v108
v_lshlrev_b32 v58, 16, v109
v_and_b32 v59, 0xffff0000, v109
v_lshlrev_b32 v60, 16, v110
v_and_b32 v61, 0xffff0000, v110
v_lshlrev_b32 v62, 16, v111
v_and_b32 v63, 0xffff0000, v111
v_pk_add_f32 v[32:33], v[32:33], v[56:57]
v_pk_add_f32 v[34:35], v[34:35], v[58:59]
v_pk_add_f32 v[36:37], v[36:37], v[60:61]
v_pk_add_f32 v[38:39], v[38:39], v[62:63]
v_cvt_pk_bf16_f32 v32, v32, v33
v_cvt_pk_bf16_f32 v33, v34, v35
v_cvt_pk_bf16_f32 v34, v36, v37
v_cvt_pk_bf16_f32 v35, v38, v39
buffer_store_dwordx4 v[32:35], v120, s[16:19], s64 offen offset:64
v_permlane16_swap_b32 v40, v44
v_permlane16_swap_b32 v41, v45
v_permlane16_swap_b32 v42, v46
v_permlane16_swap_b32 v43, v47
v_permlane16_swap_b32 v48, v52
v_permlane16_swap_b32 v49, v53
v_permlane16_swap_b32 v50, v54
v_permlane16_swap_b32 v51, v55
s_nop 1
v_lshlrev_b32 v56, 16, v112
v_and_b32 v57, 0xffff0000, v112
v_lshlrev_b32 v58, 16, v113
v_and_b32 v59, 0xffff0000, v113
v_lshlrev_b32 v60, 16, v114
v_and_b32 v61, 0xffff0000, v114
v_lshlrev_b32 v62, 16, v115
v_and_b32 v63, 0xffff0000, v115
v_pk_add_f32 v[40:41], v[40:41], v[56:57]
v_pk_add_f32 v[42:43], v[42:43], v[58:59]
v_pk_add_f32 v[44:45], v[44:45], v[60:61]
v_pk_add_f32 v[46:47], v[46:47], v[62:63]
v_cvt_pk_bf16_f32 v40, v40, v41
v_cvt_pk_bf16_f32 v41, v42, v43
v_cvt_pk_bf16_f32 v42, v44, v45
v_cvt_pk_bf16_f32 v43, v46, v47
buffer_store_dwordx4 v[40:43], v120, s[16:19], s65 offen offset:0
v_lshlrev_b32 v56, 16, v116
v_and_b32 v57, 0xffff0000, v116
v_lshlrev_b32 v58, 16, v117
v_and_b32 v59, 0xffff0000, v117
v_lshlrev_b32 v60, 16, v118
v_and_b32 v61, 0xffff0000, v118
v_lshlrev_b32 v62, 16, v119
v_and_b32 v63, 0xffff0000, v119
v_pk_add_f32 v[48:49], v[48:49], v[56:57]
v_pk_add_f32 v[50:51], v[50:51], v[58:59]
v_pk_add_f32 v[52:53], v[52:53], v[60:61]
v_pk_add_f32 v[54:55], v[54:55], v[62:63]
v_cvt_pk_bf16_f32 v48, v48, v49
v_cvt_pk_bf16_f32 v49, v50, v51
v_cvt_pk_bf16_f32 v50, v52, v53
v_cvt_pk_bf16_f32 v51, v54, v55
buffer_store_dwordx4 v[48:51], v120, s[16:19], s65 offen offset:64
s_endpgm
Lld3:
s_setprio 1
s_and_b32 s3, s2, 7
s_lshr_b32 s4, s2, 3
s_and_b32 s28, s3, 3
s_lshl_b32 s28, s28, 2
s_and_b32 s5, s4, 3
s_add_u32 s28, s28, s5
s_lshr_b32 s29, s3, 2
s_lshl_b32 s29, s29, 3
s_lshr_b32 s5, s4, 2
s_add_u32 s29, s29, s5
s_lshl_b32 s5, s30, 5
v_lshrrev_b32 v20, 3, v1
v_add_u32 v20, s5, v20
s_mov_b32 s6, 64
v_mul_lo_u32 v20, v20, s6
v_and_b32 v21, 7, v1
v_xor_b32 v21, v21, v3
v_lshrrev_b32 v22, 2, v21
v_lshlrev_b32 v22, 17, v22
v_and_b32 v21, 3, v21
v_lshl_add_u32 v21, v21, 4, v22
v_xor_b32 v22, 0, v21
v_add_u32 v22, v20, v22
v_add_u32 v4, 0, v22
v_xor_b32 v22, 131072, v21
v_add_u32 v22, v20, v22
v_add_u32 v5, 512, v22
v_xor_b32 v22, 0, v21
v_add_u32 v22, v20, v22
v_add_u32 v6, 1024, v22
v_xor_b32 v22, 131072, v21
v_add_u32 v22, v20, v22
v_add_u32 v7, 1536, v22
s_and_b32 s7, s29, 1
s_mul_i32 s35, s7, 14
s_lshl_b32 s7, s7, 1
s_lshl_b32 s5, s30, 6
s_mov_b32 s6, 2048
v_add_u32 v20, s5, v1
v_add_u32 v20, 0, v20
v_mul_u32_u24 v21, 131072, v20
v_lshrrev_b32 v21, 20, v21
v_mul_u32_u24 v22, 8, v21
v_sub_u32 v22, v20, v22
v_bfe_u32 v23, v21, 1, 2
v_lshlrev_b32 v23, 1, v23
v_xor_b32 v22, v22, v23
v_and_b32 v23, 0x33, v21
v_bfe_u32 v24, v21, 2, 1
v_lshl_or_b32 v23, v24, 3, v23
v_bfe_u32 v24, v21, 3, 1
v_lshl_or_b32 v23, v24, 2, v23
v_mul_lo_u32 v23, v23, s6
v_lshl_add_u32 v16, v22, 4, v23
v_add_u32 v20, s5, v1
v_add_u32 v20, 256, v20
v_mul_u32_u24 v21, 131072, v20
v_lshrrev_b32 v21, 20, v21
v_mul_u32_u24 v22, 8, v21
v_sub_u32 v22, v20, v22
v_bfe_u32 v23, v21, 1, 2
v_lshlrev_b32 v23, 1, v23
v_xor_b32 v22, v22, v23
v_and_b32 v23, 0x33, v21
v_bfe_u32 v24, v21, 2, 1
v_lshl_or_b32 v23, v24, 3, v23
v_bfe_u32 v24, v21, 3, 1
v_lshl_or_b32 v23, v24, 2, v23
v_mul_lo_u32 v23, v23, s6
v_lshl_add_u32 v17, v22, 4, v23
s_add_u32 s8, s60, 16777216
s_addc_u32 s9, s61, 0
s_mov_b32 s10, 4194304
s_mov_b32 s11, 0x00020000
s_mov_b32 s12, s44
s_mov_b32 s13, s45
s_mov_b32 s14, 2097152
s_mov_b32 s15, 0x00020000
s_mul_i32 s31, s28, 8192
s_lshr_b32 s32, s29, 0
s_mul_i32 s32, s32, 128
s_lshl_b32 s36, s30, 12
s_lshl_b32 s37, s30, 10
s_add_u32 s37, s37, 16384
s_mov_b32 s35, s32
s_barrier
s_add_u32 s39, s37, 49152
s_add_u32 m0, s39, 0
s_nop 0
buffer_load_dwordx4 v16, s[12:15], s32 offen lds
s_add_u32 m0, s39, 4096
s_nop 0
buffer_load_dwordx4 v17, s[12:15], s32 offen lds
s_add_u32 s32, s32, 131072
s_add_u32 s39, s37, 57344
s_add_u32 m0, s39, 0
s_nop 0
buffer_load_dwordx4 v16, s[12:15], s32 offen lds
s_add_u32 m0, s39, 4096
s_nop 0
buffer_load_dwordx4 v17, s[12:15], s32 offen lds
s_add_u32 s32, s32, 131072
s_add_u32 s39, s37, 65536
s_add_u32 m0, s39, 0
s_nop 0
buffer_load_dwordx4 v16, s[12:15], s32 offen lds
s_add_u32 m0, s39, 4096
s_nop 0
buffer_load_dwordx4 v17, s[12:15], s32 offen lds
s_add_u32 s32, s32, 131072
s_add_u32 s39, s37, 73728
s_add_u32 m0, s39, 0
s_nop 0
buffer_load_dwordx4 v16, s[12:15], s32 offen lds
s_add_u32 m0, s39, 4096
s_nop 0
buffer_load_dwordx4 v17, s[12:15], s32 offen lds
s_add_u32 s32, s32, 131072
s_add_u32 s39, s37, 81920
s_add_u32 m0, s39, 0
s_nop 0
buffer_load_dwordx4 v16, s[12:15], s32 offen lds
s_add_u32 m0, s39, 4096
s_nop 0
buffer_load_dwordx4 v17, s[12:15], s32 offen lds
s_add_u32 s32, s32, 131072
s_add_u32 s39, s37, 90112
s_add_u32 m0, s39, 0
s_nop 0
buffer_load_dwordx4 v16, s[12:15], s32 offen lds
s_add_u32 m0, s39, 4096
s_nop 0
buffer_load_dwordx4 v17, s[12:15], s32 offen lds
s_add_u32 s32, s32, 131072
s_add_u32 s39, s37, 98304
s_add_u32 m0, s39, 0
s_nop 0
buffer_load_dwordx4 v16, s[12:15], s32 offen lds
s_add_u32 m0, s39, 4096
s_nop 0
buffer_load_dwordx4 v17, s[12:15], s32 offen lds
s_add_u32 s32, s32, 131072
s_add_u32 s39, s37, 106496
s_add_u32 m0, s39, 0
s_nop 0
buffer_load_dwordx4 v16, s[12:15], s32 offen lds
s_add_u32 m0, s39, 4096
s_nop 0
buffer_load_dwordx4 v17, s[12:15], s32 offen lds
s_add_u32 s32, s32, 131072
s_add_u32 s39, s37, 114688
s_add_u32 m0, s39, 0
s_nop 0
buffer_load_dwordx4 v16, s[12:15], s32 offen lds
s_add_u32 m0, s39, 4096
s_nop 0
buffer_load_dwordx4 v17, s[12:15], s32 offen lds
s_add_u32 s32, s32, 131072
s_add_u32 s39, s37, 122880
s_add_u32 m0, s39, 0
s_nop 0
buffer_load_dwordx4 v16, s[12:15], s32 offen lds
s_add_u32 m0, s39, 4096
s_nop 0
buffer_load_dwordx4 v17, s[12:15], s32 offen lds
s_add_u32 s32, s32, 131072
s_add_u32 s39, s37, 131072
s_add_u32 m0, s39, 0
s_nop 0
buffer_load_dwordx4 v16, s[12:15], s32 offen lds
s_add_u32 m0, s39, 4096
s_nop 0
buffer_load_dwordx4 v17, s[12:15], s32 offen lds
s_add_u32 s32, s32, 131072
s_cmp_lg_u32 s30, 0
s_cbranch_scc1 Lp3_p0_ok
v_lshlrev_b32 v20, 3, v1
s_lshl_b32 s3, s28, 9
s_add_u32 s3, s3, 16384
Lp3_p0:
buffer_load_dwordx2 v[22:23], v20, s[96:99], s3 offen sc1
s_waitcnt vmcnt(0)
v_xor_b32 v22, s100, v22
v_xor_b32 v23, s100, v23
v_or_b32 v22, v22, v23
v_cmp_ne_u32 vcc, 0, v22
s_nop 4
s_cbranch_vccz Lp3_p0_ok
s_sleep 4
s_branch Lp3_p0
Lp3_p0_ok:
s_barrier
s_add_u32 s38, s36, 0
s_add_u32 m0, s38, 0
s_nop 0
buffer_load_dwordx4 v4, s[8:11], s31 offen sc1 lds
s_add_u32 m0, s38, 1024
s_nop 0
buffer_load_dwordx4 v5, s[8:11], s31 offen sc1 lds
s_add_u32 m0, s38, 2048
s_nop 0
buffer_load_dwordx4 v6, s[8:11], s31 offen sc1 lds
s_add_u32 m0, s38, 3072
s_nop 0
buffer_load_dwordx4 v7, s[8:11], s31 offen sc1 lds
s_add_u32 s31, s31, 262144
s_add_u32 s38, s36, 16384
s_add_u32 m0, s38, 0
s_nop 0
buffer_load_dwordx4 v4, s[8:11], s31 offen sc1 lds
s_add_u32 m0, s38, 1024
s_nop 0
buffer_load_dwordx4 v5, s[8:11], s31 offen sc1 lds
s_add_u32 m0, s38, 2048
s_nop 0
buffer_load_dwordx4 v6, s[8:11], s31 offen sc1 lds
s_add_u32 m0, s38, 3072
s_nop 0
buffer_load_dwordx4 v7, s[8:11], s31 offen sc1 lds
s_add_u32 s31, s31, 262144
s_add_u32 s38, s36, 32768
s_add_u32 m0, s38, 0
s_nop 0
buffer_load_dwordx4 v4, s[8:11], s31 offen sc1 lds
s_add_u32 m0, s38, 1024
s_nop 0
buffer_load_dwordx4 v5, s[8:11], s31 offen sc1 lds
s_add_u32 m0, s38, 2048
s_nop 0
buffer_load_dwordx4 v6, s[8:11], s31 offen sc1 lds
s_add_u32 m0, s38, 3072
s_nop 0
buffer_load_dwordx4 v7, s[8:11], s31 offen sc1 lds
s_add_u32 s31, s31, 262144
s_waitcnt vmcnt(8)
s_barrier
s_add_u32 s38, s36, 49152
s_add_u32 m0, s38, 0
s_nop 0
buffer_load_dwordx4 v4, s[8:11], s31 offen sc1 lds
s_add_u32 m0, s38, 1024
s_nop 0
buffer_load_dwordx4 v5, s[8:11], s31 offen sc1 lds
s_add_u32 m0, s38, 2048
s_nop 0
buffer_load_dwordx4 v6, s[8:11], s31 offen sc1 lds
s_add_u32 m0, s38, 3072
s_nop 0
buffer_load_dwordx4 v7, s[8:11], s31 offen sc1 lds
s_add_u32 s31, s31, 262144
s_add_u32 s39, s37, 139264
s_add_u32 m0, s39, 0
s_nop 0
buffer_load_dwordx4 v16, s[12:15], s32 offen lds
s_add_u32 m0, s39, 4096
s_nop 0
buffer_load_dwordx4 v17, s[12:15], s32 offen lds
s_add_u32 s32, s32, 131072
s_waitcnt vmcnt(10)
s_barrier
s_add_u32 s38, s36, 0
s_add_u32 m0, s38, 0
s_nop 0
buffer_load_dwordx4 v4, s[8:11], s31 offen sc1 lds
s_add_u32 m0, s38, 1024
s_nop 0
buffer_load_dwordx4 v5, s[8:11], s31 offen sc1 lds
s_add_u32 m0, s38, 2048
s_nop 0
buffer_load_dwordx4 v6, s[8:11], s31 offen sc1 lds
s_add_u32 m0, s38, 3072
s_nop 0
buffer_load_dwordx4 v7, s[8:11], s31 offen sc1 lds
s_add_u32 s31, s31, 262144
s_add_u32 s39, s37, 49152
s_add_u32 m0, s39, 0
s_nop 0
buffer_load_dwordx4 v16, s[12:15], s32 offen lds
s_add_u32 m0, s39, 4096
s_nop 0
buffer_load_dwordx4 v17, s[12:15], s32 offen lds
s_add_u32 s32, s32, 131072
s_waitcnt vmcnt(12)
s_barrier
s_add_u32 s38, s36, 16384
s_add_u32 m0, s38, 0
s_nop 0
buffer_load_dwordx4 v4, s[8:11], s31 offen sc1 lds
s_add_u32 m0, s38, 1024
s_nop 0
buffer_load_dwordx4 v5, s[8:11], s31 offen sc1 lds
s_add_u32 m0, s38, 2048
s_nop 0
buffer_load_dwordx4 v6, s[8:11], s31 offen sc1 lds
s_add_u32 m0, s38, 3072
s_nop 0
buffer_load_dwordx4 v7, s[8:11], s31 offen sc1 lds
s_add_u32 s31, s31, 262144
s_add_u32 s39, s37, 57344
s_add_u32 m0, s39, 0
s_nop 0
buffer_load_dwordx4 v16, s[12:15], s32 offen lds
s_add_u32 m0, s39, 4096
s_nop 0
buffer_load_dwordx4 v17, s[12:15], s32 offen lds
s_add_u32 s32, s32, 131072
s_waitcnt vmcnt(14)
s_barrier
s_add_u32 s38, s36, 32768
s_add_u32 m0, s38, 0
s_nop 0
buffer_load_dwordx4 v4, s[8:11], s31 offen sc1 lds
s_add_u32 m0, s38, 1024
s_nop 0
buffer_load_dwordx4 v5, s[8:11], s31 offen sc1 lds
s_add_u32 m0, s38, 2048
s_nop 0
buffer_load_dwordx4 v6, s[8:11], s31 offen sc1 lds
s_add_u32 m0, s38, 3072
s_nop 0
buffer_load_dwordx4 v7, s[8:11], s31 offen sc1 lds
s_add_u32 s31, s31, 262144
s_add_u32 s39, s37, 65536
s_add_u32 m0, s39, 0
s_nop 0
buffer_load_dwordx4 v16, s[12:15], s32 offen lds
s_add_u32 m0, s39, 4096
s_nop 0
buffer_load_dwordx4 v17, s[12:15], s32 offen lds
s_add_u32 s32, s32, 131072
s_waitcnt vmcnt(14)
s_barrier
s_add_u32 s38, s36, 49152
s_add_u32 m0, s38, 0
s_nop 0
buffer_load_dwordx4 v4, s[8:11], s31 offen sc1 lds
s_add_u32 m0, s38, 1024
s_nop 0
buffer_load_dwordx4 v5, s[8:11], s31 offen sc1 lds
s_add_u32 m0, s38, 2048
s_nop 0
buffer_load_dwordx4 v6, s[8:11], s31 offen sc1 lds
s_add_u32 m0, s38, 3072
s_nop 0
buffer_load_dwordx4 v7, s[8:11], s31 offen sc1 lds
s_add_u32 s31, s31, 262144
s_add_u32 s39, s37, 73728
s_add_u32 m0, s39, 0
s_nop 0
buffer_load_dwordx4 v16, s[12:15], s32 offen lds
s_add_u32 m0, s39, 4096
s_nop 0
buffer_load_dwordx4 v17, s[12:15], s32 offen lds
s_add_u32 s32, s32, 131072
s_waitcnt vmcnt(14)
s_barrier
s_add_u32 s38, s36, 0
s_add_u32 m0, s38, 0
s_nop 0
buffer_load_dwordx4 v4, s[8:11], s31 offen sc1 lds
s_add_u32 m0, s38, 1024
s_nop 0
buffer_load_dwordx4 v5, s[8:11], s31 offen sc1 lds
s_add_u32 m0, s38, 2048
s_nop 0
buffer_load_dwordx4 v6, s[8:11], s31 offen sc1 lds
s_add_u32 m0, s38, 3072
s_nop 0
buffer_load_dwordx4 v7, s[8:11], s31 offen sc1 lds
s_add_u32 s31, s31, 262144
s_waitcnt vmcnt(12)
s_barrier
s_add_u32 s38, s36, 16384
s_add_u32 m0, s38, 0
s_nop 0
buffer_load_dwordx4 v4, s[8:11], s31 offen sc1 lds
s_add_u32 m0, s38, 1024
s_nop 0
buffer_load_dwordx4 v5, s[8:11], s31 offen sc1 lds
s_add_u32 m0, s38, 2048
s_nop 0
buffer_load_dwordx4 v6, s[8:11], s31 offen sc1 lds
s_add_u32 m0, s38, 3072
s_nop 0
buffer_load_dwordx4 v7, s[8:11], s31 offen sc1 lds
s_add_u32 s31, s31, 262144
s_waitcnt vmcnt(10)
s_barrier
s_add_u32 s38, s36, 32768
s_add_u32 m0, s38, 0
s_nop 0
buffer_load_dwordx4 v4, s[8:11], s31 offen sc1 lds
s_add_u32 m0, s38, 1024
s_nop 0
buffer_load_dwordx4 v5, s[8:11], s31 offen sc1 lds
s_add_u32 m0, s38, 2048
s_nop 0
buffer_load_dwordx4 v6, s[8:11], s31 offen sc1 lds
s_add_u32 m0, s38, 3072
s_nop 0
buffer_load_dwordx4 v7, s[8:11], s31 offen sc1 lds
s_add_u32 s31, s31, 262144
s_waitcnt vmcnt(8)
s_barrier
s_add_u32 s38, s36, 49152
s_add_u32 m0, s38, 0
s_nop 0
buffer_load_dwordx4 v4, s[8:11], s31 offen sc1 lds
s_add_u32 m0, s38, 1024
s_nop 0
buffer_load_dwordx4 v5, s[8:11], s31 offen sc1 lds
s_add_u32 m0, s38, 2048
s_nop 0
buffer_load_dwordx4 v6, s[8:11], s31 offen sc1 lds
s_add_u32 m0, s38, 3072
s_nop 0
buffer_load_dwordx4 v7, s[8:11], s31 offen sc1 lds
s_add_u32 s31, s31, 262144
s_waitcnt vmcnt(8)
s_barrier
s_add_u32 s38, s36, 0
s_add_u32 m0, s38, 0
s_nop 0
buffer_load_dwordx4 v4, s[8:11], s31 offen sc1 lds
s_add_u32 m0, s38, 1024
s_nop 0
buffer_load_dwordx4 v5, s[8:11], s31 offen sc1 lds
s_add_u32 m0, s38, 2048
s_nop 0
buffer_load_dwordx4 v6, s[8:11], s31 offen sc1 lds
s_add_u32 m0, s38, 3072
s_nop 0
buffer_load_dwordx4 v7, s[8:11], s31 offen sc1 lds
s_add_u32 s31, s31, 262144
s_waitcnt vmcnt(8)
s_barrier
s_add_u32 s38, s36, 16384
s_add_u32 m0, s38, 0
s_nop 0
buffer_load_dwordx4 v4, s[8:11], s31 offen sc1 lds
s_add_u32 m0, s38, 1024
s_nop 0
buffer_load_dwordx4 v5, s[8:11], s31 offen sc1 lds
s_add_u32 m0, s38, 2048
s_nop 0
buffer_load_dwordx4 v6, s[8:11], s31 offen sc1 lds
s_add_u32 m0, s38, 3072
s_nop 0
buffer_load_dwordx4 v7, s[8:11], s31 offen sc1 lds
s_add_u32 s31, s31, 262144
s_waitcnt vmcnt(8)
s_barrier
s_add_u32 s38, s36, 32768
s_add_u32 m0, s38, 0
s_nop 0
buffer_load_dwordx4 v4, s[8:11], s31 offen sc1 lds
s_add_u32 m0, s38, 1024
s_nop 0
buffer_load_dwordx4 v5, s[8:11], s31 offen sc1 lds
s_add_u32 m0, s38, 2048
s_nop 0
buffer_load_dwordx4 v6, s[8:11], s31 offen sc1 lds
s_add_u32 m0, s38, 3072
s_nop 0
buffer_load_dwordx4 v7, s[8:11], s31 offen sc1 lds
s_add_u32 s31, s31, 262144
s_waitcnt vmcnt(8)
s_barrier
s_add_u32 s38, s36, 49152
s_add_u32 m0, s38, 0
s_nop 0
buffer_load_dwordx4 v4, s[8:11], s31 offen sc1 lds
s_add_u32 m0, s38, 1024
s_nop 0
buffer_load_dwordx4 v5, s[8:11], s31 offen sc1 lds
s_add_u32 m0, s38, 2048
s_nop 0
buffer_load_dwordx4 v6, s[8:11], s31 offen sc1 lds
s_add_u32 m0, s38, 3072
s_nop 0
buffer_load_dwordx4 v7, s[8:11], s31 offen sc1 lds
s_add_u32 s31, s31, 262144
s_waitcnt vmcnt(8)
s_barrier
s_waitcnt vmcnt(4)
s_barrier
s_waitcnt vmcnt(0)
s_barrier
s_barrier
s_and_b32 s3, s2, 7
s_lshr_b32 s4, s2, 3
s_and_b32 s28, s3, 1
s_lshl_b32 s28, s28, 3
s_and_b32 s5, s4, 7
s_add_u32 s28, s28, s5
s_lshr_b32 s29, s3, 1
s_lshl_b32 s29, s29, 2
s_lshr_b32 s5, s4, 3
s_add_u32 s29, s29, s5
s_lshl_b32 s5, s30, 5
v_lshrrev_b32 v24, 3, v1
v_add_u32 v24, s5, v24
s_mov_b32 s6, 64
v_mul_lo_u32 v24, v24, s6
v_and_b32 v25, 7, v1
v_xor_b32 v25, v25, v3
v_lshrrev_b32 v26, 2, v25
v_lshlrev_b32 v26, 17, v26
v_and_b32 v25, 3, v25
v_lshl_add_u32 v25, v25, 4, v26
v_xor_b32 v26, 0, v25
v_add_u32 v26, v24, v26
v_add_u32 v4, 0, v26
v_xor_b32 v26, 131072, v25
v_add_u32 v26, v24, v26
v_add_u32 v5, 512, v26
v_xor_b32 v26, 0, v25
v_add_u32 v26, v24, v26
v_add_u32 v6, 1024, v26
v_xor_b32 v26, 131072, v25
v_add_u32 v26, v24, v26
v_add_u32 v7, 1536, v26
s_and_b32 s7, s29, 1
s_mul_i32 s35, s7, 14
s_lshl_b32 s7, s7, 1
s_lshl_b32 s5, s30, 6
s_mov_b32 s6, 7168
v_add_u32 v24, s5, v1
v_add_u32 v24, 0, v24
v_mul_u32_u24 v25, 37450, v24
v_lshrrev_b32 v25, 20, v25
v_mul_u32_u24 v26, 28, v25
v_sub_u32 v26, v24, v26
v_bfe_u32 v27, v25, 2, 1
v_lshlrev_b32 v27, 1, v27
v_xor_b32 v26, v26, v27
v_and_b32 v27, 0x33, v25
v_bfe_u32 v28, v25, 2, 1
v_lshl_or_b32 v27, v28, 3, v27
v_bfe_u32 v28, v25, 3, 1
v_lshl_or_b32 v27, v28, 2, v27
v_mul_lo_u32 v27, v27, s6
v_cmp_lt_u32 vcc, 13, v26
v_subrev_u32 v28, 14, v26
v_add_u32 v29, 3584, v27
v_cndmask_b32 v26, v26, v28, vcc
v_cndmask_b32 v27, v27, v29, vcc
v_add_u32 v26, s7, v26
v_cmp_lt_u32 vcc, 13, v26
v_subrev_u32 v28, 14, v26
s_nop 0
v_cndmask_b32 v26, v26, v28, vcc
v_lshl_add_u32 v16, v26, 4, v27
v_add_u32 v24, s5, v1
v_add_u32 v24, 256, v24
v_mul_u32_u24 v25, 37450, v24
v_lshrrev_b32 v25, 20, v25
v_mul_u32_u24 v26, 28, v25
v_sub_u32 v26, v24, v26
v_bfe_u32 v27, v25, 2, 1
v_lshlrev_b32 v27, 1, v27
v_xor_b32 v26, v26, v27
v_and_b32 v27, 0x33, v25
v_bfe_u32 v28, v25, 2, 1
v_lshl_or_b32 v27, v28, 3, v27
v_bfe_u32 v28, v25, 3, 1
v_lshl_or_b32 v27, v28, 2, v27
v_mul_lo_u32 v27, v27, s6
v_cmp_lt_u32 vcc, 13, v26
v_subrev_u32 v28, 14, v26
v_add_u32 v29, 3584, v27
v_cndmask_b32 v26, v26, v28, vcc
v_cndmask_b32 v27, v27, v29, vcc
v_add_u32 v26, s7, v26
v_cmp_lt_u32 vcc, 13, v26
v_subrev_u32 v28, 14, v26
s_nop 0
v_cndmask_b32 v26, v26, v28, vcc
v_lshl_add_u32 v17, v26, 4, v27
v_add_u32 v24, s5, v1
v_add_u32 v24, 512, v24
v_mul_u32_u24 v25, 37450, v24
v_lshrrev_b32 v25, 20, v25
v_mul_u32_u24 v26, 28, v25
v_sub_u32 v26, v24, v26
v_bfe_u32 v27, v25, 2, 1
v_lshlrev_b32 v27, 1, v27
v_xor_b32 v26, v26, v27
v_and_b32 v27, 0x33, v25
v_bfe_u32 v28, v25, 2, 1
v_lshl_or_b32 v27, v28, 3, v27
v_bfe_u32 v28, v25, 3, 1
v_lshl_or_b32 v27, v28, 2, v27
v_mul_lo_u32 v27, v27, s6
v_cmp_lt_u32 vcc, 13, v26
v_subrev_u32 v28, 14, v26
v_add_u32 v29, 3584, v27
v_cndmask_b32 v26, v26, v28, vcc
v_cndmask_b32 v27, v27, v29, vcc
v_add_u32 v26, s7, v26
v_cmp_lt_u32 vcc, 13, v26
v_subrev_u32 v28, 14, v26
s_nop 0
v_cndmask_b32 v26, v26, v28, vcc
v_lshl_add_u32 v18, v26, 4, v27
v_add_u32 v24, s5, v1
v_add_u32 v24, 768, v24
v_mul_u32_u24 v25, 37450, v24
v_lshrrev_b32 v25, 20, v25
v_mul_u32_u24 v26, 28, v25
v_sub_u32 v26, v24, v26
v_bfe_u32 v27, v25, 2, 1
v_lshlrev_b32 v27, 1, v27
v_xor_b32 v26, v26, v27
v_and_b32 v27, 0x33, v25
v_bfe_u32 v28, v25, 2, 1
v_lshl_or_b32 v27, v28, 3, v27
v_bfe_u32 v28, v25, 3, 1
v_lshl_or_b32 v27, v28, 2, v27
v_mul_lo_u32 v27, v27, s6
v_cmp_lt_u32 vcc, 13, v26
v_subrev_u32 v28, 14, v26
v_add_u32 v29, 3584, v27
v_cndmask_b32 v26, v26, v28, vcc
v_cndmask_b32 v27, v27, v29, vcc
v_add_u32 v26, s7, v26
v_cmp_lt_u32 vcc, 13, v26
v_subrev_u32 v28, 14, v26
s_nop 0
v_cndmask_b32 v26, v26, v28, vcc
v_lshl_add_u32 v19, v26, 4, v27
v_add_u32 v24, s5, v1
v_add_u32 v24, 1024, v24
v_mul_u32_u24 v25, 37450, v24
v_lshrrev_b32 v25, 20, v25
v_mul_u32_u24 v26, 28, v25
v_sub_u32 v26, v24, v26
v_bfe_u32 v27, v25, 2, 1
v_lshlrev_b32 v27, 1, v27
v_xor_b32 v26, v26, v27
v_and_b32 v27, 0x33, v25
v_bfe_u32 v28, v25, 2, 1
v_lshl_or_b32 v27, v28, 3, v27
v_bfe_u32 v28, v25, 3, 1
v_lshl_or_b32 v27, v28, 2, v27
v_mul_lo_u32 v27, v27, s6
v_cmp_lt_u32 vcc, 13, v26
v_subrev_u32 v28, 14, v26
v_add_u32 v29, 3584, v27
v_cndmask_b32 v26, v26, v28, vcc
v_cndmask_b32 v27, v27, v29, vcc
v_add_u32 v26, s7, v26
v_cmp_lt_u32 vcc, 13, v26
v_subrev_u32 v28, 14, v26
s_nop 0
v_cndmask_b32 v26, v26, v28, vcc
v_lshl_add_u32 v20, v26, 4, v27
v_add_u32 v24, s5, v1
v_add_u32 v24, 1280, v24
v_mul_u32_u24 v25, 37450, v24
v_lshrrev_b32 v25, 20, v25
v_mul_u32_u24 v26, 28, v25
v_sub_u32 v26, v24, v26
v_bfe_u32 v27, v25, 2, 1
v_lshlrev_b32 v27, 1, v27
v_xor_b32 v26, v26, v27
v_and_b32 v27, 0x33, v25
v_bfe_u32 v28, v25, 2, 1
v_lshl_or_b32 v27, v28, 3, v27
v_bfe_u32 v28, v25, 3, 1
v_lshl_or_b32 v27, v28, 2, v27
v_mul_lo_u32 v27, v27, s6
v_cmp_lt_u32 vcc, 13, v26
v_subrev_u32 v28, 14, v26
v_add_u32 v29, 3584, v27
v_cndmask_b32 v26, v26, v28, vcc
v_cndmask_b32 v27, v27, v29, vcc
v_add_u32 v26, s7, v26
v_cmp_lt_u32 vcc, 13, v26
v_subrev_u32 v28, 14, v26
s_nop 0
v_cndmask_b32 v26, v26, v28, vcc
v_lshl_add_u32 v21, v26, 4, v27
v_add_u32 v24, s5, v1
v_add_u32 v24, 1536, v24
v_mul_u32_u24 v25, 37450, v24
v_lshrrev_b32 v25, 20, v25
v_mul_u32_u24 v26, 28, v25
v_sub_u32 v26, v24, v26
v_bfe_u32 v27, v25, 2, 1
v_lshlrev_b32 v27, 1, v27
v_xor_b32 v26, v26, v27
v_and_b32 v27, 0x33, v25
v_bfe_u32 v28, v25, 2, 1
v_lshl_or_b32 v27, v28, 3, v27
v_bfe_u32 v28, v25, 3, 1
v_lshl_or_b32 v27, v28, 2, v27
v_mul_lo_u32 v27, v27, s6
v_cmp_lt_u32 vcc, 13, v26
v_subrev_u32 v28, 14, v26
v_add_u32 v29, 3584, v27
v_cndmask_b32 v26, v26, v28, vcc
v_cndmask_b32 v27, v27, v29, vcc
v_add_u32 v26, s7, v26
v_cmp_lt_u32 vcc, 13, v26
v_subrev_u32 v28, 14, v26
s_nop 0
v_cndmask_b32 v26, v26, v28, vcc
v_lshl_add_u32 v22, v26, 4, v27
s_add_u32 s8, s60, 20971520
s_addc_u32 s9, s61, 0
s_mov_b32 s10, 4194304
s_mov_b32 s11, 0x00020000
s_mov_b32 s12, s48
s_mov_b32 s13, s49
s_mov_b32 s14, 7340032
s_mov_b32 s15, 0x00020000
s_mul_i32 s31, s28, 8192
s_lshr_b32 s32, s29, 0
s_mul_i32 s32, s32, 224
s_lshl_b32 s36, s30, 12
s_lshl_b32 s37, s30, 10
s_add_u32 s37, s37, 16384
s_mov_b32 s35, s32
s_barrier
s_add_u32 s39, s37, 32768
s_add_u32 m0, s39, 0
s_nop 0
buffer_load_dwordx4 v16, s[12:15], s32 offen lds
s_add_u32 m0, s39, 4096
s_nop 0
buffer_load_dwordx4 v17, s[12:15], s32 offen lds
s_add_u32 m0, s39, 8192
s_nop 0
buffer_load_dwordx4 v18, s[12:15], s32 offen lds
s_add_u32 m0, s39, 12288
s_nop 0
buffer_load_dwordx4 v19, s[12:15], s32 offen lds
s_add_u32 m0, s39, 16384
s_nop 0
buffer_load_dwordx4 v20, s[12:15], s32 offen lds
s_add_u32 m0, s39, 20480
s_nop 0
buffer_load_dwordx4 v21, s[12:15], s32 offen lds
s_add_u32 m0, s39, 24576
s_nop 0
buffer_load_dwordx4 v22, s[12:15], s32 offen lds
s_add_u32 s32, s32, 458752
s_add_u32 s39, s37, 61440
s_add_u32 m0, s39, 0
s_nop 0
buffer_load_dwordx4 v16, s[12:15], s32 offen lds
s_add_u32 m0, s39, 4096
s_nop 0
buffer_load_dwordx4 v17, s[12:15], s32 offen lds
s_add_u32 m0, s39, 8192
s_nop 0
buffer_load_dwordx4 v18, s[12:15], s32 offen lds
s_add_u32 m0, s39, 12288
s_nop 0
buffer_load_dwordx4 v19, s[12:15], s32 offen lds
s_add_u32 m0, s39, 16384
s_nop 0
buffer_load_dwordx4 v20, s[12:15], s32 offen lds
s_add_u32 m0, s39, 20480
s_nop 0
buffer_load_dwordx4 v21, s[12:15], s32 offen lds
s_add_u32 m0, s39, 24576
s_nop 0
buffer_load_dwordx4 v22, s[12:15], s32 offen lds
s_add_u32 s32, s32, 458752
s_add_u32 s39, s37, 90112
s_add_u32 m0, s39, 0
s_nop 0
buffer_load_dwordx4 v16, s[12:15], s32 offen lds
s_add_u32 m0, s39, 4096
s_nop 0
buffer_load_dwordx4 v17, s[12:15], s32 offen lds
s_add_u32 m0, s39, 8192
s_nop 0
buffer_load_dwordx4 v18, s[12:15], s32 offen lds
s_add_u32 m0, s39, 12288
s_nop 0
buffer_load_dwordx4 v19, s[12:15], s32 offen lds
s_add_u32 m0, s39, 16384
s_nop 0
buffer_load_dwordx4 v20, s[12:15], s32 offen lds
s_add_u32 m0, s39, 20480
s_nop 0
buffer_load_dwordx4 v21, s[12:15], s32 offen lds
s_add_u32 m0, s39, 24576
s_nop 0
buffer_load_dwordx4 v22, s[12:15], s32 offen lds
s_add_u32 s32, s32, 458752
s_cmp_lg_u32 s30, 0
s_cbranch_scc1 Lp4_p0_ok
v_lshrrev_b32 v24, 2, v1
v_and_b32 v26, 3, v1
v_lshlrev_b32 v26, 2, v26
v_lshl_add_u32 v25, v24, 9, v26
v_lshl_add_u32 v24, v24, 5, v26
s_lshl_b32 s3, s28, 9
s_add_u32 s3, s3, 24576
s_lshr_b32 s4, s29, 1
s_lshl_b32 s4, s4, 5
s_add_u32 s5, s4, 256
Lp4_p0c:
buffer_load_dword v27, v25, s[96:99], s4 offen sc1
buffer_load_dword v28, v25, s[96:99], s5 offen sc1
s_waitcnt vmcnt(0)
v_xor_b32 v27, s100, v27
v_xor_b32 v28, s100, v28
v_or_b32 v27, v27, v28
v_cmp_ne_u32 vcc, 0, v27
s_nop 4
s_cbranch_vccz Lp4_p0c_ok
s_sleep 4
s_branch Lp4_p0c
Lp4_p0c_ok:
Lp4_p0:
buffer_load_dword v26, v24, s[96:99], s3 offen sc1
s_waitcnt vmcnt(0)
v_xor_b32 v26, s100, v26
v_cmp_ne_u32 vcc, 0, v26
s_nop 4
s_cbranch_vccz Lp4_p0_ok
s_sleep 4
s_branch Lp4_p0
Lp4_p0_ok:
s_barrier
s_add_u32 s20, s60, 50331648
s_addc_u32 s21, s61, 0
s_mov_b32 s22, 229376
s_mov_b32 s23, 0x00020000
s_add_u32 s24, s60, 51380224
s_addc_u32 s25, s61, 0
s_mov_b32 s26, 262144
s_mov_b32 s27, 0x00020000
v_and_b32 v24, 31, v1
v_lshlrev_b32 v24, 3, v24
v_lshrrev_b32 v25, 5, v1
v_lshl_add_u32 v24, v25, 11, v24
s_lshl_b32 s3, s28, 14
s_add_u32 s3, s3, s36
s_lshr_b32 s5, s30, 1
s_mul_i32 s4, s5, 7168
s_mul_i32 s6, s29, 448
s_add_u32 s4, s4, s6
s_lshl_b32 s5, s5, 9
s_add_u32 s5, s5, 63488
s_and_b32 s6, s30, 1
s_mul_i32 s6, s6, 14
v_min_u32 v25, 13, v2
v_add_u32 v25, s6, v25
v_lshlrev_b32 v28, 4, v25
v_add_u32 v28, s5, v28
s_lshl_b32 s5, s7, 1
v_add_u32 v25, s5, v25
v_cmp_lt_u32 vcc, 27, v25
v_subrev_u32 v26, 28, v25
v_mul_u32_u24 v27, 57344, v3
v_cndmask_b32 v25, v25, v26, vcc
v_lshl_add_u32 v25, v25, 4, v27
buffer_load_dwordx2 v[32:33], v24, s[24:27], s3 offen offset:0 sc1
buffer_load_dwordx2 v[34:35], v24, s[24:27], s3 offen offset:256 sc1
buffer_load_dwordx2 v[36:37], v24, s[24:27], s3 offen offset:512 sc1
buffer_load_dwordx2 v[38:39], v24, s[24:27], s3 offen offset:768 sc1
buffer_load_dwordx2 v[40:41], v24, s[24:27], s3 offen offset:1024 sc1
buffer_load_dwordx2 v[42:43], v24, s[24:27], s3 offen offset:1280 sc1
buffer_load_dwordx2 v[44:45], v24, s[24:27], s3 offen offset:1536 sc1
buffer_load_dwordx2 v[46:47], v24, s[24:27], s3 offen offset:1792 sc1
buffer_load_dwordx4 v[48:51], v25, s[20:23], s4 offen sc1
s_add_u32 s4, s4, 14336
buffer_load_dwordx4 v[52:55], v25, s[20:23], s4 offen sc1
s_add_u32 s4, s4, 14336
buffer_load_dwordx4 v[56:59], v25, s[20:23], s4 offen sc1
s_add_u32 s4, s4, 14336
buffer_load_dwordx4 v[60:63], v25, s[20:23], s4 offen sc1
s_add_u32 s4, s4, 14336
s_add_u32 s38, s36, 0
s_add_u32 m0, s38, 0
s_nop 0
buffer_load_dwordx4 v4, s[8:11], s31 offen sc1 lds
s_add_u32 m0, s38, 1024
s_nop 0
buffer_load_dwordx4 v5, s[8:11], s31 offen sc1 lds
s_add_u32 m0, s38, 2048
s_nop 0
buffer_load_dwordx4 v6, s[8:11], s31 offen sc1 lds
s_add_u32 m0, s38, 3072
s_nop 0
buffer_load_dwordx4 v7, s[8:11], s31 offen sc1 lds
s_add_u32 s31, s31, 262144
s_add_u32 s38, s36, 16384
s_add_u32 m0, s38, 0
s_nop 0
buffer_load_dwordx4 v4, s[8:11], s31 offen sc1 lds
s_add_u32 m0, s38, 1024
s_nop 0
buffer_load_dwordx4 v5, s[8:11], s31 offen sc1 lds
s_add_u32 m0, s38, 2048
s_nop 0
buffer_load_dwordx4 v6, s[8:11], s31 offen sc1 lds
s_add_u32 m0, s38, 3072
s_nop 0
buffer_load_dwordx4 v7, s[8:11], s31 offen sc1 lds
s_add_u32 s31, s31, 262144
s_waitcnt vmcnt(4)
s_barrier
s_add_u32 s38, s36, 32768
s_add_u32 m0, s38, 0
s_nop 0
buffer_load_dwordx4 v4, s[8:11], s31 offen sc1 lds
s_add_u32 m0, s38, 1024
s_nop 0
buffer_load_dwordx4 v5, s[8:11], s31 offen sc1 lds
s_add_u32 m0, s38, 2048
s_nop 0
buffer_load_dwordx4 v6, s[8:11], s31 offen sc1 lds
s_add_u32 m0, s38, 3072
s_nop 0
buffer_load_dwordx4 v7, s[8:11], s31 offen sc1 lds
s_add_u32 s31, s31, 262144
s_add_u32 s39, s37, 118784
s_add_u32 m0, s39, 0
s_nop 0
buffer_load_dwordx4 v16, s[12:15], s32 offen lds
s_add_u32 m0, s39, 4096
s_nop 0
buffer_load_dwordx4 v17, s[12:15], s32 offen lds
s_add_u32 m0, s39, 8192
s_nop 0
buffer_load_dwordx4 v18, s[12:15], s32 offen lds
s_add_u32 m0, s39, 12288
s_nop 0
buffer_load_dwordx4 v19, s[12:15], s32 offen lds
s_add_u32 m0, s39, 16384
s_nop 0
buffer_load_dwordx4 v20, s[12:15], s32 offen lds
s_add_u32 m0, s39, 20480
s_nop 0
buffer_load_dwordx4 v21, s[12:15], s32 offen lds
s_add_u32 m0, s39, 24576
s_nop 0
buffer_load_dwordx4 v22, s[12:15], s32 offen lds
s_add_u32 s32, s32, 458752
s_waitcnt vmcnt(11)
s_barrier
s_add_u32 s38, s36, 0
s_add_u32 m0, s38, 0
s_nop 0
buffer_load_dwordx4 v4, s[8:11], s31 offen sc1 lds
s_add_u32 m0, s38, 1024
s_nop 0
buffer_load_dwordx4 v5, s[8:11], s31 offen sc1 lds
s_add_u32 m0, s38, 2048
s_nop 0
buffer_load_dwordx4 v6, s[8:11], s31 offen sc1 lds
s_add_u32 m0, s38, 3072
s_nop 0
buffer_load_dwordx4 v7, s[8:11], s31 offen sc1 lds
s_add_u32 s31, s31, 262144
s_add_u32 s39, s37, 32768
s_add_u32 m0, s39, 0
s_nop 0
buffer_load_dwordx4 v16, s[12:15], s32 offen lds
s_add_u32 m0, s39, 4096
s_nop 0
buffer_load_dwordx4 v17, s[12:15], s32 offen lds
s_add_u32 m0, s39, 8192
s_nop 0
buffer_load_dwordx4 v18, s[12:15], s32 offen lds
s_add_u32 m0, s39, 12288
s_nop 0
buffer_load_dwordx4 v19, s[12:15], s32 offen lds
s_add_u32 m0, s39, 16384
s_nop 0
buffer_load_dwordx4 v20, s[12:15], s32 offen lds
s_add_u32 m0, s39, 20480
s_nop 0
buffer_load_dwordx4 v21, s[12:15], s32 offen lds
s_add_u32 m0, s39, 24576
s_nop 0
buffer_load_dwordx4 v22, s[12:15], s32 offen lds
s_add_u32 s32, s32, 458752
s_waitcnt vmcnt(18)
s_barrier
s_add_u32 s38, s36, 16384
s_add_u32 m0, s38, 0
s_nop 0
buffer_load_dwordx4 v4, s[8:11], s31 offen sc1 lds
s_add_u32 m0, s38, 1024
s_nop 0
buffer_load_dwordx4 v5, s[8:11], s31 offen sc1 lds
s_add_u32 m0, s38, 2048
s_nop 0
buffer_load_dwordx4 v6, s[8:11], s31 offen sc1 lds
s_add_u32 m0, s38, 3072
s_nop 0
buffer_load_dwordx4 v7, s[8:11], s31 offen sc1 lds
s_add_u32 s31, s31, 262144
s_add_u32 s39, s37, 61440
s_add_u32 m0, s39, 0
s_nop 0
buffer_load_dwordx4 v16, s[12:15], s32 offen lds
s_add_u32 m0, s39, 4096
s_nop 0
buffer_load_dwordx4 v17, s[12:15], s32 offen lds
s_add_u32 m0, s39, 8192
s_nop 0
buffer_load_dwordx4 v18, s[12:15], s32 offen lds
s_add_u32 m0, s39, 12288
s_nop 0
buffer_load_dwordx4 v19, s[12:15], s32 offen lds
s_add_u32 m0, s39, 16384
s_nop 0
buffer_load_dwordx4 v20, s[12:15], s32 offen lds
s_add_u32 m0, s39, 20480
s_nop 0
buffer_load_dwordx4 v21, s[12:15], s32 offen lds
s_add_u32 m0, s39, 24576
s_nop 0
buffer_load_dwordx4 v22, s[12:15], s32 offen lds
s_add_u32 s32, s32, 458752
s_waitcnt vmcnt(18)
s_barrier
s_add_u32 s38, s36, 32768
s_add_u32 m0, s38, 0
s_nop 0
buffer_load_dwordx4 v4, s[8:11], s31 offen sc1 lds
s_add_u32 m0, s38, 1024
s_nop 0
buffer_load_dwordx4 v5, s[8:11], s31 offen sc1 lds
s_add_u32 m0, s38, 2048
s_nop 0
buffer_load_dwordx4 v6, s[8:11], s31 offen sc1 lds
s_add_u32 m0, s38, 3072
s_nop 0
buffer_load_dwordx4 v7, s[8:11], s31 offen sc1 lds
s_add_u32 s31, s31, 262144
s_add_u32 s39, s37, 90112
s_add_u32 m0, s39, 0
s_nop 0
buffer_load_dwordx4 v16, s[12:15], s32 offen lds
s_add_u32 m0, s39, 4096
s_nop 0
buffer_load_dwordx4 v17, s[12:15], s32 offen lds
s_add_u32 m0, s39, 8192
s_nop 0
buffer_load_dwordx4 v18, s[12:15], s32 offen lds
s_add_u32 m0, s39, 12288
s_nop 0
buffer_load_dwordx4 v19, s[12:15], s32 offen lds
s_add_u32 m0, s39, 16384
s_nop 0
buffer_load_dwordx4 v20, s[12:15], s32 offen lds
s_add_u32 m0, s39, 20480
s_nop 0
buffer_load_dwordx4 v21, s[12:15], s32 offen lds
s_add_u32 m0, s39, 24576
s_nop 0
buffer_load_dwordx4 v22, s[12:15], s32 offen lds
s_add_u32 s32, s32, 458752
s_waitcnt vmcnt(18)
s_barrier
s_add_u32 s38, s36, 0
s_add_u32 m0, s38, 0
s_nop 0
buffer_load_dwordx4 v4, s[8:11], s31 offen sc1 lds
s_add_u32 m0, s38, 1024
s_nop 0
buffer_load_dwordx4 v5, s[8:11], s31 offen sc1 lds
s_add_u32 m0, s38, 2048
s_nop 0
buffer_load_dwordx4 v6, s[8:11], s31 offen sc1 lds
s_add_u32 m0, s38, 3072
s_nop 0
buffer_load_dwordx4 v7, s[8:11], s31 offen sc1 lds
s_add_u32 s31, s31, 262144
s_add_u32 s39, s37, 118784
s_add_u32 m0, s39, 0
s_nop 0
buffer_load_dwordx4 v16, s[12:15], s32 offen lds
s_add_u32 m0, s39, 4096
s_nop 0
buffer_load_dwordx4 v17, s[12:15], s32 offen lds
s_add_u32 m0, s39, 8192
s_nop 0
buffer_load_dwordx4 v18, s[12:15], s32 offen lds
s_add_u32 m0, s39, 12288
s_nop 0
buffer_load_dwordx4 v19, s[12:15], s32 offen lds
s_add_u32 m0, s39, 16384
s_nop 0
buffer_load_dwordx4 v20, s[12:15], s32 offen lds
s_add_u32 m0, s39, 20480
s_nop 0
buffer_load_dwordx4 v21, s[12:15], s32 offen lds
s_add_u32 m0, s39, 24576
s_nop 0
buffer_load_dwordx4 v22, s[12:15], s32 offen lds
s_add_u32 s32, s32, 458752
s_waitcnt vmcnt(18)
s_barrier
s_add_u32 s38, s36, 16384
s_add_u32 m0, s38, 0
s_nop 0
buffer_load_dwordx4 v4, s[8:11], s31 offen sc1 lds
s_add_u32 m0, s38, 1024
s_nop 0
buffer_load_dwordx4 v5, s[8:11], s31 offen sc1 lds
s_add_u32 m0, s38, 2048
s_nop 0
buffer_load_dwordx4 v6, s[8:11], s31 offen sc1 lds
s_add_u32 m0, s38, 3072
s_nop 0
buffer_load_dwordx4 v7, s[8:11], s31 offen sc1 lds
s_add_u32 s31, s31, 262144
s_add_u32 s39, s37, 32768
s_add_u32 m0, s39, 0
s_nop 0
buffer_load_dwordx4 v16, s[12:15], s32 offen lds
s_add_u32 m0, s39, 4096
s_nop 0
buffer_load_dwordx4 v17, s[12:15], s32 offen lds
s_add_u32 m0, s39, 8192
s_nop 0
buffer_load_dwordx4 v18, s[12:15], s32 offen lds
s_add_u32 m0, s39, 12288
s_nop 0
buffer_load_dwordx4 v19, s[12:15], s32 offen lds
s_add_u32 m0, s39, 16384
s_nop 0
buffer_load_dwordx4 v20, s[12:15], s32 offen lds
s_add_u32 m0, s39, 20480
s_nop 0
buffer_load_dwordx4 v21, s[12:15], s32 offen lds
s_add_u32 m0, s39, 24576
s_nop 0
buffer_load_dwordx4 v22, s[12:15], s32 offen lds
s_add_u32 s32, s32, 458752
s_waitcnt vmcnt(18)
s_barrier
s_add_u32 s38, s36, 32768
s_add_u32 m0, s38, 0
s_nop 0
buffer_load_dwordx4 v4, s[8:11], s31 offen sc1 lds
s_add_u32 m0, s38, 1024
s_nop 0
buffer_load_dwordx4 v5, s[8:11], s31 offen sc1 lds
s_add_u32 m0, s38, 2048
s_nop 0
buffer_load_dwordx4 v6, s[8:11], s31 offen sc1 lds
s_add_u32 m0, s38, 3072
s_nop 0
buffer_load_dwordx4 v7, s[8:11], s31 offen sc1 lds
s_add_u32 s31, s31, 262144
s_add_u32 s39, s37, 61440
s_add_u32 m0, s39, 0
s_nop 0
buffer_load_dwordx4 v16, s[12:15], s32 offen lds
s_add_u32 m0, s39, 4096
s_nop 0
buffer_load_dwordx4 v17, s[12:15], s32 offen lds
s_add_u32 m0, s39, 8192
s_nop 0
buffer_load_dwordx4 v18, s[12:15], s32 offen lds
s_add_u32 m0, s39, 12288
s_nop 0
buffer_load_dwordx4 v19, s[12:15], s32 offen lds
s_add_u32 m0, s39, 16384
s_nop 0
buffer_load_dwordx4 v20, s[12:15], s32 offen lds
s_add_u32 m0, s39, 20480
s_nop 0
buffer_load_dwordx4 v21, s[12:15], s32 offen lds
s_add_u32 m0, s39, 24576
s_nop 0
buffer_load_dwordx4 v22, s[12:15], s32 offen lds
s_add_u32 s32, s32, 458752
s_waitcnt vmcnt(18)
s_barrier
s_add_u32 s38, s36, 0
s_add_u32 m0, s38, 0
s_nop 0
buffer_load_dwordx4 v4, s[8:11], s31 offen sc1 lds
s_add_u32 m0, s38, 1024
s_nop 0
buffer_load_dwordx4 v5, s[8:11], s31 offen sc1 lds
s_add_u32 m0, s38, 2048
s_nop 0
buffer_load_dwordx4 v6, s[8:11], s31 offen sc1 lds
s_add_u32 m0, s38, 3072
s_nop 0
buffer_load_dwordx4 v7, s[8:11], s31 offen sc1 lds
s_add_u32 s31, s31, 262144
s_add_u32 s39, s37, 90112
s_add_u32 m0, s39, 0
s_nop 0
buffer_load_dwordx4 v16, s[12:15], s32 offen lds
s_add_u32 m0, s39, 4096
s_nop 0
buffer_load_dwordx4 v17, s[12:15], s32 offen lds
s_add_u32 m0, s39, 8192
s_nop 0
buffer_load_dwordx4 v18, s[12:15], s32 offen lds
s_add_u32 m0, s39, 12288
s_nop 0
buffer_load_dwordx4 v19, s[12:15], s32 offen lds
s_add_u32 m0, s39, 16384
s_nop 0
buffer_load_dwordx4 v20, s[12:15], s32 offen lds
s_add_u32 m0, s39, 20480
s_nop 0
buffer_load_dwordx4 v21, s[12:15], s32 offen lds
s_add_u32 m0, s39, 24576
s_nop 0
buffer_load_dwordx4 v22, s[12:15], s32 offen lds
s_add_u32 s32, s32, 458752
s_waitcnt vmcnt(18)
s_barrier
s_add_u32 s38, s36, 16384
s_add_u32 m0, s38, 0
s_nop 0
buffer_load_dwordx4 v4, s[8:11], s31 offen sc1 lds
s_add_u32 m0, s38, 1024
s_nop 0
buffer_load_dwordx4 v5, s[8:11], s31 offen sc1 lds
s_add_u32 m0, s38, 2048
s_nop 0
buffer_load_dwordx4 v6, s[8:11], s31 offen sc1 lds
s_add_u32 m0, s38, 3072
s_nop 0
buffer_load_dwordx4 v7, s[8:11], s31 offen sc1 lds
s_add_u32 s31, s31, 262144
s_add_u32 s39, s37, 118784
s_add_u32 m0, s39, 0
s_nop 0
buffer_load_dwordx4 v16, s[12:15], s32 offen lds
s_add_u32 m0, s39, 4096
s_nop 0
buffer_load_dwordx4 v17, s[12:15], s32 offen lds
s_add_u32 m0, s39, 8192
s_nop 0
buffer_load_dwordx4 v18, s[12:15], s32 offen lds
s_add_u32 m0, s39, 12288
s_nop 0
buffer_load_dwordx4 v19, s[12:15], s32 offen lds
s_add_u32 m0, s39, 16384
s_nop 0
buffer_load_dwordx4 v20, s[12:15], s32 offen lds
s_add_u32 m0, s39, 20480
s_nop 0
buffer_load_dwordx4 v21, s[12:15], s32 offen lds
s_add_u32 m0, s39, 24576
s_nop 0
buffer_load_dwordx4 v22, s[12:15], s32 offen lds
s_add_u32 s32, s32, 458752
s_waitcnt vmcnt(18)
s_barrier
s_add_u32 s38, s36, 32768
s_add_u32 m0, s38, 0
s_nop 0
buffer_load_dwordx4 v4, s[8:11], s31 offen sc1 lds
s_add_u32 m0, s38, 1024
s_nop 0
buffer_load_dwordx4 v5, s[8:11], s31 offen sc1 lds
s_add_u32 m0, s38, 2048
s_nop 0
buffer_load_dwordx4 v6, s[8:11], s31 offen sc1 lds
s_add_u32 m0, s38, 3072
s_nop 0
buffer_load_dwordx4 v7, s[8:11], s31 offen sc1 lds
s_add_u32 s31, s31, 262144
s_add_u32 s39, s37, 32768
s_add_u32 m0, s39, 0
s_nop 0
buffer_load_dwordx4 v16, s[12:15], s32 offen lds
s_add_u32 m0, s39, 4096
s_nop 0
buffer_load_dwordx4 v17, s[12:15], s32 offen lds
s_add_u32 m0, s39, 8192
s_nop 0
buffer_load_dwordx4 v18, s[12:15], s32 offen lds
s_add_u32 m0, s39, 12288
s_nop 0
buffer_load_dwordx4 v19, s[12:15], s32 offen lds
s_add_u32 m0, s39, 16384
s_nop 0
buffer_load_dwordx4 v20, s[12:15], s32 offen lds
s_add_u32 m0, s39, 20480
s_nop 0
buffer_load_dwordx4 v21, s[12:15], s32 offen lds
s_add_u32 m0, s39, 24576
s_nop 0
buffer_load_dwordx4 v22, s[12:15], s32 offen lds
s_add_u32 s32, s32, 458752
s_waitcnt vmcnt(18)
s_barrier
s_add_u32 s38, s36, 0
s_add_u32 m0, s38, 0
s_nop 0
buffer_load_dwordx4 v4, s[8:11], s31 offen sc1 lds
s_add_u32 m0, s38, 1024
s_nop 0
buffer_load_dwordx4 v5, s[8:11], s31 offen sc1 lds
s_add_u32 m0, s38, 2048
s_nop 0
buffer_load_dwordx4 v6, s[8:11], s31 offen sc1 lds
s_add_u32 m0, s38, 3072
s_nop 0
buffer_load_dwordx4 v7, s[8:11], s31 offen sc1 lds
s_add_u32 s31, s31, 262144
s_add_u32 s39, s37, 61440
s_add_u32 m0, s39, 0
s_nop 0
buffer_load_dwordx4 v16, s[12:15], s32 offen lds
s_add_u32 m0, s39, 4096
s_nop 0
buffer_load_dwordx4 v17, s[12:15], s32 offen lds
s_add_u32 m0, s39, 8192
s_nop 0
buffer_load_dwordx4 v18, s[12:15], s32 offen lds
s_add_u32 m0, s39, 12288
s_nop 0
buffer_load_dwordx4 v19, s[12:15], s32 offen lds
s_add_u32 m0, s39, 16384
s_nop 0
buffer_load_dwordx4 v20, s[12:15], s32 offen lds
s_add_u32 m0, s39, 20480
s_nop 0
buffer_load_dwordx4 v21, s[12:15], s32 offen lds
s_add_u32 m0, s39, 24576
s_nop 0
buffer_load_dwordx4 v22, s[12:15], s32 offen lds
s_add_u32 s32, s32, 458752
s_waitcnt vmcnt(18)
s_barrier
s_add_u32 s38, s36, 16384
s_add_u32 m0, s38, 0
s_nop 0
buffer_load_dwordx4 v4, s[8:11], s31 offen sc1 lds
s_add_u32 m0, s38, 1024
s_nop 0
buffer_load_dwordx4 v5, s[8:11], s31 offen sc1 lds
s_add_u32 m0, s38, 2048
s_nop 0
buffer_load_dwordx4 v6, s[8:11], s31 offen sc1 lds
s_add_u32 m0, s38, 3072
s_nop 0
buffer_load_dwordx4 v7, s[8:11], s31 offen sc1 lds
s_add_u32 s31, s31, 262144
s_add_u32 s39, s37, 90112
s_add_u32 m0, s39, 0
s_nop 0
buffer_load_dwordx4 v16, s[12:15], s32 offen lds
s_add_u32 m0, s39, 4096
s_nop 0
buffer_load_dwordx4 v17, s[12:15], s32 offen lds
s_add_u32 m0, s39, 8192
s_nop 0
buffer_load_dwordx4 v18, s[12:15], s32 offen lds
s_add_u32 m0, s39, 12288
s_nop 0
buffer_load_dwordx4 v19, s[12:15], s32 offen lds
s_add_u32 m0, s39, 16384
s_nop 0
buffer_load_dwordx4 v20, s[12:15], s32 offen lds
s_add_u32 m0, s39, 20480
s_nop 0
buffer_load_dwordx4 v21, s[12:15], s32 offen lds
s_add_u32 m0, s39, 24576
s_nop 0
buffer_load_dwordx4 v22, s[12:15], s32 offen lds
s_add_u32 s32, s32, 458752
s_waitcnt vmcnt(18)
s_barrier
s_add_u32 s38, s36, 32768
s_add_u32 m0, s38, 0
s_nop 0
buffer_load_dwordx4 v4, s[8:11], s31 offen sc1 lds
s_add_u32 m0, s38, 1024
s_nop 0
buffer_load_dwordx4 v5, s[8:11], s31 offen sc1 lds
s_add_u32 m0, s38, 2048
s_nop 0
buffer_load_dwordx4 v6, s[8:11], s31 offen sc1 lds
s_add_u32 m0, s38, 3072
s_nop 0
buffer_load_dwordx4 v7, s[8:11], s31 offen sc1 lds
s_add_u32 s31, s31, 262144
s_add_u32 s39, s37, 118784
s_add_u32 m0, s39, 0
s_nop 0
buffer_load_dwordx4 v16, s[12:15], s32 offen lds
s_add_u32 m0, s39, 4096
s_nop 0
buffer_load_dwordx4 v17, s[12:15], s32 offen lds
s_add_u32 m0, s39, 8192
s_nop 0
buffer_load_dwordx4 v18, s[12:15], s32 offen lds
s_add_u32 m0, s39, 12288
s_nop 0
buffer_load_dwordx4 v19, s[12:15], s32 offen lds
s_add_u32 m0, s39, 16384
s_nop 0
buffer_load_dwordx4 v20, s[12:15], s32 offen lds
s_add_u32 m0, s39, 20480
s_nop 0
buffer_load_dwordx4 v21, s[12:15], s32 offen lds
s_add_u32 m0, s39, 24576
s_nop 0
buffer_load_dwordx4 v22, s[12:15], s32 offen lds
s_add_u32 s32, s32, 458752
s_waitcnt vmcnt(18)
s_barrier
s_add_u32 s38, s36, 0
s_add_u32 m0, s38, 0
s_nop 0
buffer_load_dwordx4 v4, s[8:11], s31 offen sc1 lds
s_add_u32 m0, s38, 1024
s_nop 0
buffer_load_dwordx4 v5, s[8:11], s31 offen sc1 lds
s_add_u32 m0, s38, 2048
s_nop 0
buffer_load_dwordx4 v6, s[8:11], s31 offen sc1 lds
s_add_u32 m0, s38, 3072
s_nop 0
buffer_load_dwordx4 v7, s[8:11], s31 offen sc1 lds
s_add_u32 s31, s31, 262144
v_pk_add_f32 v[48:49], v[48:49], v[52:53]
v_pk_add_f32 v[50:51], v[50:51], v[54:55]
v_pk_add_f32 v[48:49], v[48:49], v[56:57]
v_pk_add_f32 v[50:51], v[50:51], v[58:59]
v_pk_add_f32 v[48:49], v[48:49], v[60:61]
v_pk_add_f32 v[50:51], v[50:51], v[62:63]
v_mov_b32 v52, v48
v_mov_b32 v53, v49
v_mov_b32 v54, v50
v_mov_b32 v55, v51
s_nop 1
v_permlane16_swap_b32 v48, v52
v_permlane16_swap_b32 v49, v53
v_permlane16_swap_b32 v50, v54
v_permlane16_swap_b32 v51, v55
s_nop 1
v_add_f32 v48, v48, v52
v_add_f32 v49, v49, v53
v_add_f32 v50, v50, v54
v_add_f32 v51, v51, v55
v_mov_b32 v52, v48
v_mov_b32 v53, v49
v_mov_b32 v54, v50
v_mov_b32 v55, v51
s_nop 1
v_permlane32_swap_b32 v48, v52
v_permlane32_swap_b32 v49, v53
v_permlane32_swap_b32 v50, v54
v_permlane32_swap_b32 v51, v55
s_nop 1
v_add_f32 v48, v48, v52
v_add_f32 v49, v49, v53
v_add_f32 v50, v50, v54
v_add_f32 v51, v51, v55
ds_write_b128 v28, v[48:51]
v_pk_add_f32 v[32:33], v[32:33], v[34:35]
v_pk_add_f32 v[32:33], v[32:33], v[36:37]
v_pk_add_f32 v[32:33], v[32:33], v[38:39]
v_pk_add_f32 v[32:33], v[32:33], v[40:41]
v_pk_add_f32 v[32:33], v[32:33], v[42:43]
v_pk_add_f32 v[32:33], v[32:33], v[44:45]
v_pk_add_f32 v[32:33], v[32:33], v[46:47]
v_mov_b64 v[34:35], v[32:33]
s_nop 1
v_permlane32_swap_b32 v32, v34
v_permlane32_swap_b32 v33, v35
s_nop 1
v_pk_add_f32 v[32:33], v[32:33], v[34:35]
v_mul_f32 v32, 0x3a800000, v32
v_mul_f32 v33, 0x3a800000, v33
v_fma_f32 v33, -v32, v32, v33
v_max_f32 v33, 0, v33
v_add_f32 v33, 0x3727c5ac, v33
v_rsq_f32 v34, v33
s_nop 0
v_mul_f32 v35, -v32, v34
s_lshl_b32 s3, s30, 8
s_add_u32 s3, s3, 64512
v_and_b32 v24, 31, v1
v_lshlrev_b32 v24, 3, v24
v_add_u32 v24, s3, v24
ds_write_b64 v24, v[34:35]
s_waitcnt lgkmcnt(0)
v_lshlrev_b32 v29, 7, v1
s_lshl_b32 s88, s2, 2
s_add_u32 s88, s88, s30
s_mov_b32 s84, s50
s_mov_b32 s85, s51
s_mov_b32 s86, 8388608
s_mov_b32 s87, 0x00020000
s_mul_i32 s89, s88, 8192
v_cmp_gt_u32 vcc, 8192, v29
s_nop 3
s_mov_b64 exec, vcc
buffer_load_dword v0, v29, s[84:87], s89 offen
s_add_u32 s89, s89, 8192
s_mov_b64 exec, -1
s_waitcnt vmcnt(12)
s_barrier
s_waitcnt vmcnt(1)
s_barrier
s_barrier
s_and_b32 s3, s2, 7
s_lshr_b32 s4, s2, 3
s_and_b32 s28, s3, 1
s_lshl_b32 s28, s28, 3
s_and_b32 s5, s4, 7
s_add_u32 s28, s28, s5
s_lshr_b32 s29, s3, 1
s_lshl_b32 s29, s29, 2
s_lshr_b32 s5, s4, 3
s_add_u32 s29, s29, s5
s_lshl_b32 s5, s30, 5
v_lshrrev_b32 v20, 3, v1
v_add_u32 v20, s5, v20
s_mov_b32 s6, 4096
v_mul_lo_u32 v20, v20, s6
v_and_b32 v21, 7, v1
v_xor_b32 v21, v21, v3
v_lshlrev_b32 v21, 4, v21
v_xor_b32 v22, 0, v21
v_add_u32 v22, v20, v22
v_add_u32 v4, 0, v22
v_xor_b32 v22, 64, v21
v_add_u32 v22, v20, v22
v_add_u32 v5, 32768, v22
v_xor_b32 v22, 0, v21
v_add_u32 v22, v20, v22
v_add_u32 v6, 65536, v22
v_xor_b32 v22, 64, v21
v_add_u32 v22, v20, v22
v_add_u32 v7, 98304, v22
s_and_b32 s7, s29, 1
s_mul_i32 s35, s7, 14
s_lshl_b32 s7, s7, 1
s_lshl_b32 s5, s30, 6
s_mov_b32 s6, 64
v_add_u32 v20, s5, v1
v_lshrrev_b32 v21, 2, v20
v_and_b32 v23, 0x33, v21
v_bfe_u32 v24, v21, 2, 1
v_lshl_or_b32 v23, v24, 3, v23
v_bfe_u32 v24, v21, 3, 1
v_lshl_or_b32 v23, v24, 2, v23
v_bfe_u32 v22, v1, 4, 1
v_lshlrev_b32 v22, 1, v22
v_xor_b32 v22, v22, v1
v_and_b32 v22, 3, v22
v_lshlrev_b32 v22, 4, v22
v_lshl_add_u32 v22, v23, 6, v22
s_lshl_b32 s6, s7, 18
v_add_u32 v16, s6, v22
s_add_u32 s6, s6, 0x20000
v_add_u32 v17, s6, v22
s_add_u32 s6, s6, 0x20000
v_add_u32 v18, s6, v22
s_add_u32 s6, s6, 0x20000
v_lshrrev_b32 v21, 1, v20
v_and_b32 v23, 0x33, v21
v_bfe_u32 v24, v21, 2, 1
v_lshl_or_b32 v23, v24, 3, v23
v_bfe_u32 v24, v21, 3, 1
v_lshl_or_b32 v23, v24, 2, v23
v_and_b32 v22, 1, v1
v_lshlrev_b32 v22, 4, v22
v_lshl_add_u32 v22, v23, 5, v22
s_lshl_b32 s6, s7, 15
s_add_u32 s6, s6, 0x60000
v_add_u32 v19, s6, v22
s_mov_b32 s8, s50
s_mov_b32 s9, s51
s_mov_b32 s10, 8388608
s_mov_b32 s11, 0x00020000
s_add_u32 s12, s60, 33554432
s_addc_u32 s13, s61, 0
s_mov_b32 s14, 7340032
s_mov_b32 s15, 0x00020000
s_mul_i32 s31, s28, 524288
s_lshr_b32 s32, s29, 1
s_mul_i32 s32, s32, 917504
s_lshl_b32 s36, s30, 12
s_lshl_b32 s37, s30, 10
s_add_u32 s37, s37, 16384
s_mov_b32 s35, s32
s_cmp_ge_u32 s30, 2
s_cbranch_scc1 Lp5_v1
s_barrier
s_add_u32 s38, s36, 0
s_add_u32 m0, s38, 0
s_nop 0
buffer_load_dwordx4 v4, s[8:11], s31 offen lds
s_add_u32 m0, s38, 1024
s_nop 0
buffer_load_dwordx4 v5, s[8:11], s31 offen lds
s_add_u32 m0, s38, 2048
s_nop 0
buffer_load_dwordx4 v6, s[8:11], s31 offen lds
s_add_u32 m0, s38, 3072
s_nop 0
buffer_load_dwordx4 v7, s[8:11], s31 offen lds
s_add_u32 s31, s31, 128
s_add_u32 s38, s36, 32768
s_add_u32 m0, s38, 0
s_nop 0
buffer_load_dwordx4 v4, s[8:11], s31 offen lds
s_add_u32 m0, s38, 1024
s_nop 0
buffer_load_dwordx4 v5, s[8:11], s31 offen lds
s_add_u32 m0, s38, 2048
s_nop 0
buffer_load_dwordx4 v6, s[8:11], s31 offen lds
s_add_u32 m0, s38, 3072
s_nop 0
buffer_load_dwordx4 v7, s[8:11], s31 offen lds
s_add_u32 s31, s31, 128
s_add_u32 s38, s36, 65536
s_add_u32 m0, s38, 0
s_nop 0
buffer_load_dwordx4 v4, s[8:11], s31 offen lds
s_add_u32 m0, s38, 1024
s_nop 0
buffer_load_dwordx4 v5, s[8:11], s31 offen lds
s_add_u32 m0, s38, 2048
s_nop 0
buffer_load_dwordx4 v6, s[8:11], s31 offen lds
s_add_u32 m0, s38, 3072
s_nop 0
buffer_load_dwordx4 v7, s[8:11], s31 offen lds
s_add_u32 s31, s31, 128
s_add_u32 s38, s36, 98304
s_add_u32 m0, s38, 0
s_nop 0
buffer_load_dwordx4 v4, s[8:11], s31 offen lds
s_add_u32 m0, s38, 1024
s_nop 0
buffer_load_dwordx4 v5, s[8:11], s31 offen lds
s_add_u32 m0, s38, 2048
s_nop 0
buffer_load_dwordx4 v6, s[8:11], s31 offen lds
s_add_u32 m0, s38, 3072
s_nop 0
buffer_load_dwordx4 v7, s[8:11], s31 offen lds
s_add_u32 s31, s31, 128
s_cmp_lg_u32 s30, 0
s_cbranch_scc1 Lp5_p0_ok
v_lshrrev_b32 v20, 2, v1
v_lshlrev_b32 v20, 9, v20
v_and_b32 v21, 3, v1
v_lshl_add_u32 v20, v21, 2, v20
s_lshl_b32 s3, s29, 5
s_add_u32 s3, s3, 32768
s_xor_b32 s4, s3, 32
Lp5_p0:
buffer_load_dword v22, v20, s[96:99], s3 offen sc1
s_waitcnt vmcnt(0)
v_xor_b32 v22, s100, v22
v_cmp_ne_u32 vcc, 0, v22
s_nop 4
s_cbranch_vccz Lp5_p0_ok
s_sleep 4
s_branch Lp5_p0
Lp5_p0_ok:
s_barrier
s_add_u32 s39, s37, 0
s_add_u32 m0, s39, 0
s_nop 0
buffer_load_dwordx4 v16, s[12:15], s32 offen sc1 lds
s_add_u32 m0, s39, 4096
s_nop 0
buffer_load_dwordx4 v17, s[12:15], s32 offen sc1 lds
s_add_u32 m0, s39, 8192
s_nop 0
buffer_load_dwordx4 v18, s[12:15], s32 offen sc1 lds
s_add_u32 m0, s39, 12288
s_nop 0
buffer_load_dwordx4 v19, s[12:15], s35 offen sc1 lds
s_add_u32 s32, s32, 4096
s_add_u32 s35, s35, 2048
s_add_u32 s39, s37, 32768
s_add_u32 m0, s39, 0
s_nop 0
buffer_load_dwordx4 v16, s[12:15], s32 offen sc1 lds
s_add_u32 m0, s39, 4096
s_nop 0
buffer_load_dwordx4 v17, s[12:15], s32 offen sc1 lds
s_add_u32 m0, s39, 8192
s_nop 0
buffer_load_dwordx4 v18, s[12:15], s32 offen sc1 lds
s_add_u32 m0, s39, 12288
s_nop 0
buffer_load_dwordx4 v19, s[12:15], s35 offen sc1 lds
s_add_u32 s32, s32, 4096
s_add_u32 s35, s35, 2048
s_add_u32 s39, s37, 65536
s_add_u32 m0, s39, 0
s_nop 0
buffer_load_dwordx4 v16, s[12:15], s32 offen sc1 lds
s_add_u32 m0, s39, 4096
s_nop 0
buffer_load_dwordx4 v17, s[12:15], s32 offen sc1 lds
s_add_u32 m0, s39, 8192
s_nop 0
buffer_load_dwordx4 v18, s[12:15], s32 offen sc1 lds
s_add_u32 m0, s39, 12288
s_nop 0
buffer_load_dwordx4 v19, s[12:15], s35 offen sc1 lds
s_add_u32 s32, s32, 4096
s_add_u32 s35, s35, 2048
s_add_u32 s39, s37, 98304
s_add_u32 m0, s39, 0
s_nop 0
buffer_load_dwordx4 v16, s[12:15], s32 offen sc1 lds
s_add_u32 m0, s39, 4096
s_nop 0
buffer_load_dwordx4 v17, s[12:15], s32 offen sc1 lds
s_add_u32 m0, s39, 8192
s_nop 0
buffer_load_dwordx4 v18, s[12:15], s32 offen sc1 lds
s_add_u32 m0, s39, 12288
s_nop 0
buffer_load_dwordx4 v19, s[12:15], s35 offen sc1 lds
s_add_u32 s32, s32, 4096
s_add_u32 s35, s35, 2048
s_waitcnt vmcnt(12)
s_barrier
s_add_u32 s38, s36, 131072
s_add_u32 m0, s38, 0
s_nop 0
buffer_load_dwordx4 v4, s[8:11], s31 offen lds
s_add_u32 m0, s38, 1024
s_nop 0
buffer_load_dwordx4 v5, s[8:11], s31 offen lds
s_add_u32 m0, s38, 2048
s_nop 0
buffer_load_dwordx4 v6, s[8:11], s31 offen lds
s_add_u32 m0, s38, 3072
s_nop 0
buffer_load_dwordx4 v7, s[8:11], s31 offen lds
s_add_u32 s31, s31, 128
s_add_u32 s39, s37, 131072
s_add_u32 m0, s39, 0
s_nop 0
buffer_load_dwordx4 v16, s[12:15], s32 offen sc1 lds
s_add_u32 m0, s39, 4096
s_nop 0
buffer_load_dwordx4 v17, s[12:15], s32 offen sc1 lds
s_add_u32 m0, s39, 8192
s_nop 0
buffer_load_dwordx4 v18, s[12:15], s32 offen sc1 lds
s_add_u32 m0, s39, 12288
s_nop 0
buffer_load_dwordx4 v19, s[12:15], s35 offen sc1 lds
s_add_u32 s32, s32, 4096
s_add_u32 s35, s35, 2048
s_waitcnt vmcnt(16)
s_barrier
s_add_u32 s38, s36, 0
s_add_u32 m0, s38, 0
s_nop 0
buffer_load_dwordx4 v4, s[8:11], s31 offen lds
s_add_u32 m0, s38, 1024
s_nop 0
buffer_load_dwordx4 v5, s[8:11], s31 offen lds
s_add_u32 m0, s38, 2048
s_nop 0
buffer_load_dwordx4 v6, s[8:11], s31 offen lds
s_add_u32 m0, s38, 3072
s_nop 0
buffer_load_dwordx4 v7, s[8:11], s31 offen lds
s_add_u32 s31, s31, 128
s_add_u32 s39, s37, 0
s_add_u32 m0, s39, 0
s_nop 0
buffer_load_dwordx4 v16, s[12:15], s32 offen sc1 lds
s_add_u32 m0, s39, 4096
s_nop 0
buffer_load_dwordx4 v17, s[12:15], s32 offen sc1 lds
s_add_u32 m0, s39, 8192
s_nop 0
buffer_load_dwordx4 v18, s[12:15], s32 offen sc1 lds
s_add_u32 m0, s39, 12288
s_nop 0
buffer_load_dwordx4 v19, s[12:15], s35 offen sc1 lds
s_add_u32 s32, s32, 4096
s_add_u32 s35, s35, 2048
s_waitcnt vmcnt(20)
s_barrier
s_add_u32 s38, s36, 32768
s_add_u32 m0, s38, 0
s_nop 0
buffer_load_dwordx4 v4, s[8:11], s31 offen lds
s_add_u32 m0, s38, 1024
s_nop 0
buffer_load_dwordx4 v5, s[8:11], s31 offen lds
s_add_u32 m0, s38, 2048
s_nop 0
buffer_load_dwordx4 v6, s[8:11], s31 offen lds
s_add_u32 m0, s38, 3072
s_nop 0
buffer_load_dwordx4 v7, s[8:11], s31 offen lds
s_add_u32 s31, s31, 128
s_add_u32 s39, s37, 32768
s_add_u32 m0, s39, 0
s_nop 0
buffer_load_dwordx4 v16, s[12:15], s32 offen sc1 lds
s_add_u32 m0, s39, 4096
s_nop 0
buffer_load_dwordx4 v17, s[12:15], s32 offen sc1 lds
s_add_u32 m0, s39, 8192
s_nop 0
buffer_load_dwordx4 v18, s[12:15], s32 offen sc1 lds
s_add_u32 m0, s39, 12288
s_nop 0
buffer_load_dwordx4 v19, s[12:15], s35 offen sc1 lds
s_add_u32 s32, s32, 4096
s_add_u32 s35, s35, 2048
s_mov_b32 s33, 25
s_mov_b32 s34, 65536
Lp5_ll0:
s_waitcnt vmcnt(24)
s_barrier
s_add_u32 s38, s36, s34
s_add_u32 m0, s38, 0
s_nop 0
buffer_load_dwordx4 v4, s[8:11], s31 offen lds
s_add_u32 m0, s38, 1024
s_nop 0
buffer_load_dwordx4 v5, s[8:11], s31 offen lds
s_add_u32 m0, s38, 2048
s_nop 0
buffer_load_dwordx4 v6, s[8:11], s31 offen lds
s_add_u32 m0, s38, 3072
s_nop 0
buffer_load_dwordx4 v7, s[8:11], s31 offen lds
s_add_u32 s31, s31, 128
s_add_u32 s39, s37, s34
s_add_u32 m0, s39, 0
s_nop 0
buffer_load_dwordx4 v16, s[12:15], s32 offen sc1 lds
s_add_u32 m0, s39, 4096
s_nop 0
buffer_load_dwordx4 v17, s[12:15], s32 offen sc1 lds
s_add_u32 m0, s39, 8192
s_nop 0
buffer_load_dwordx4 v18, s[12:15], s32 offen sc1 lds
s_add_u32 m0, s39, 12288
s_nop 0
buffer_load_dwordx4 v19, s[12:15], s35 offen sc1 lds
s_add_u32 s32, s32, 4096
s_add_u32 s35, s35, 2048
s_add_u32 s34, s34, 32768
s_cmp_eq_u32 s34, 163840
s_cselect_b32 s34, 0, s34
s_sub_u32 s33, s33, 1
s_cmp_lg_u32 s33, 0
s_cbranch_scc1 Lp5_ll0
v_lshlrev_b32 v25, 7, v1
s_lshl_b32 s88, s2, 2
s_add_u32 s88, s88, s30
s_mov_b32 s84, s54
s_mov_b32 s85, s55
s_mov_b32 s86, 3670016
s_mov_b32 s87, 0x00020000
s_mul_i32 s89, s88, 3584
v_cmp_gt_u32 vcc, 3584, v25
s_nop 3
s_mov_b64 exec, vcc
buffer_load_dword v0, v25, s[84:87], s89 offen
s_add_u32 s89, s89, 3584
s_mov_b64 exec, -1
s_waitcnt vmcnt(25)
s_barrier
s_waitcnt vmcnt(17)
s_barrier
s_waitcnt vmcnt(9)
s_barrier
s_waitcnt vmcnt(1)
s_barrier
s_barrier
s_branch Lp5_vd
Lp5_v1:
s_barrier
s_add_u32 s38, s36, 0
s_add_u32 m0, s38, 0
s_nop 0
buffer_load_dwordx4 v4, s[8:11], s31 offen lds
s_add_u32 m0, s38, 1024
s_nop 0
buffer_load_dwordx4 v5, s[8:11], s31 offen lds
s_add_u32 m0, s38, 2048
s_nop 0
buffer_load_dwordx4 v6, s[8:11], s31 offen lds
s_add_u32 m0, s38, 3072
s_nop 0
buffer_load_dwordx4 v7, s[8:11], s31 offen lds
s_add_u32 s31, s31, 128
s_add_u32 s38, s36, 32768
s_add_u32 m0, s38, 0
s_nop 0
buffer_load_dwordx4 v4, s[8:11], s31 offen lds
s_add_u32 m0, s38, 1024
s_nop 0
buffer_load_dwordx4 v5, s[8:11], s31 offen lds
s_add_u32 m0, s38, 2048
s_nop 0
buffer_load_dwordx4 v6, s[8:11], s31 offen lds
s_add_u32 m0, s38, 3072
s_nop 0
buffer_load_dwordx4 v7, s[8:11], s31 offen lds
s_add_u32 s31, s31, 128
s_add_u32 s38, s36, 65536
s_add_u32 m0, s38, 0
s_nop 0
buffer_load_dwordx4 v4, s[8:11], s31 offen lds
s_add_u32 m0, s38, 1024
s_nop 0
buffer_load_dwordx4 v5, s[8:11], s31 offen lds
s_add_u32 m0, s38, 2048
s_nop 0
buffer_load_dwordx4 v6, s[8:11], s31 offen lds
s_add_u32 m0, s38, 3072
s_nop 0
buffer_load_dwordx4 v7, s[8:11], s31 offen lds
s_add_u32 s31, s31, 128
s_add_u32 s38, s36, 98304
s_add_u32 m0, s38, 0
s_nop 0
buffer_load_dwordx4 v4, s[8:11], s31 offen lds
s_add_u32 m0, s38, 1024
s_nop 0
buffer_load_dwordx4 v5, s[8:11], s31 offen lds
s_add_u32 m0, s38, 2048
s_nop 0
buffer_load_dwordx4 v6, s[8:11], s31 offen lds
s_add_u32 m0, s38, 3072
s_nop 0
buffer_load_dwordx4 v7, s[8:11], s31 offen lds
s_add_u32 s31, s31, 128
s_cmp_lg_u32 s30, 0
s_cbranch_scc1 Lp5_p1_ok
v_lshrrev_b32 v20, 2, v1
v_lshlrev_b32 v20, 9, v20
v_and_b32 v21, 3, v1
v_lshl_add_u32 v20, v21, 2, v20
s_lshl_b32 s3, s29, 5
s_add_u32 s3, s3, 32768
s_xor_b32 s4, s3, 32
Lp5_p1:
buffer_load_dword v22, v20, s[96:99], s3 offen sc1
s_waitcnt vmcnt(0)
v_xor_b32 v22, s100, v22
v_cmp_ne_u32 vcc, 0, v22
s_nop 4
s_cbranch_vccz Lp5_p1_ok
s_sleep 4
s_branch Lp5_p1
Lp5_p1_ok:
s_barrier
s_add_u32 s39, s37, 0
s_add_u32 m0, s39, 0
s_nop 0
buffer_load_dwordx4 v16, s[12:15], s32 offen sc1 lds
s_add_u32 m0, s39, 4096
s_nop 0
buffer_load_dwordx4 v17, s[12:15], s32 offen sc1 lds
s_add_u32 m0, s39, 8192
s_nop 0
buffer_load_dwordx4 v18, s[12:15], s32 offen sc1 lds
s_add_u32 s32, s32, 4096
s_add_u32 s35, s35, 2048
s_add_u32 s39, s37, 32768
s_add_u32 m0, s39, 0
s_nop 0
buffer_load_dwordx4 v16, s[12:15], s32 offen sc1 lds
s_add_u32 m0, s39, 4096
s_nop 0
buffer_load_dwordx4 v17, s[12:15], s32 offen sc1 lds
s_add_u32 m0, s39, 8192
s_nop 0
buffer_load_dwordx4 v18, s[12:15], s32 offen sc1 lds
s_add_u32 s32, s32, 4096
s_add_u32 s35, s35, 2048
s_add_u32 s39, s37, 65536
s_add_u32 m0, s39, 0
s_nop 0
buffer_load_dwordx4 v16, s[12:15], s32 offen sc1 lds
s_add_u32 m0, s39, 4096
s_nop 0
buffer_load_dwordx4 v17, s[12:15], s32 offen sc1 lds
s_add_u32 m0, s39, 8192
s_nop 0
buffer_load_dwordx4 v18, s[12:15], s32 offen sc1 lds
s_add_u32 s32, s32, 4096
s_add_u32 s35, s35, 2048
s_add_u32 s39, s37, 98304
s_add_u32 m0, s39, 0
s_nop 0
buffer_load_dwordx4 v16, s[12:15], s32 offen sc1 lds
s_add_u32 m0, s39, 4096
s_nop 0
buffer_load_dwordx4 v17, s[12:15], s32 offen sc1 lds
s_add_u32 m0, s39, 8192
s_nop 0
buffer_load_dwordx4 v18, s[12:15], s32 offen sc1 lds
s_add_u32 s32, s32, 4096
s_add_u32 s35, s35, 2048
s_waitcnt vmcnt(9)
s_barrier
s_add_u32 s38, s36, 131072
s_add_u32 m0, s38, 0
s_nop 0
buffer_load_dwordx4 v4, s[8:11], s31 offen lds
s_add_u32 m0, s38, 1024
s_nop 0
buffer_load_dwordx4 v5, s[8:11], s31 offen lds
s_add_u32 m0, s38, 2048
s_nop 0
buffer_load_dwordx4 v6, s[8:11], s31 offen lds
s_add_u32 m0, s38, 3072
s_nop 0
buffer_load_dwordx4 v7, s[8:11], s31 offen lds
s_add_u32 s31, s31, 128
s_add_u32 s39, s37, 131072
s_add_u32 m0, s39, 0
s_nop 0
buffer_load_dwordx4 v16, s[12:15], s32 offen sc1 lds
s_add_u32 m0, s39, 4096
s_nop 0
buffer_load_dwordx4 v17, s[12:15], s32 offen sc1 lds
s_add_u32 m0, s39, 8192
s_nop 0
buffer_load_dwordx4 v18, s[12:15], s32 offen sc1 lds
s_add_u32 s32, s32, 4096
s_add_u32 s35, s35, 2048
s_waitcnt vmcnt(13)
s_barrier
s_add_u32 s38, s36, 0
s_add_u32 m0, s38, 0
s_nop 0
buffer_load_dwordx4 v4, s[8:11], s31 offen lds
s_add_u32 m0, s38, 1024
s_nop 0
buffer_load_dwordx4 v5, s[8:11], s31 offen lds
s_add_u32 m0, s38, 2048
s_nop 0
buffer_load_dwordx4 v6, s[8:11], s31 offen lds
s_add_u32 m0, s38, 3072
s_nop 0
buffer_load_dwordx4 v7, s[8:11], s31 offen lds
s_add_u32 s31, s31, 128
s_add_u32 s39, s37, 0
s_add_u32 m0, s39, 0
s_nop 0
buffer_load_dwordx4 v16, s[12:15], s32 offen sc1 lds
s_add_u32 m0, s39, 4096
s_nop 0
buffer_load_dwordx4 v17, s[12:15], s32 offen sc1 lds
s_add_u32 m0, s39, 8192
s_nop 0
buffer_load_dwordx4 v18, s[12:15], s32 offen sc1 lds
s_add_u32 s32, s32, 4096
s_add_u32 s35, s35, 2048
s_waitcnt vmcnt(17)
s_barrier
s_add_u32 s38, s36, 32768
s_add_u32 m0, s38, 0
s_nop 0
buffer_load_dwordx4 v4, s[8:11], s31 offen lds
s_add_u32 m0, s38, 1024
s_nop 0
buffer_load_dwordx4 v5, s[8:11], s31 offen lds
s_add_u32 m0, s38, 2048
s_nop 0
buffer_load_dwordx4 v6, s[8:11], s31 offen lds
s_add_u32 m0, s38, 3072
s_nop 0
buffer_load_dwordx4 v7, s[8:11], s31 offen lds
s_add_u32 s31, s31, 128
s_add_u32 s39, s37, 32768
s_add_u32 m0, s39, 0
s_nop 0
buffer_load_dwordx4 v16, s[12:15], s32 offen sc1 lds
s_add_u32 m0, s39, 4096
s_nop 0
buffer_load_dwordx4 v17, s[12:15], s32 offen sc1 lds
s_add_u32 m0, s39, 8192
s_nop 0
buffer_load_dwordx4 v18, s[12:15], s32 offen sc1 lds
s_add_u32 s32, s32, 4096
s_add_u32 s35, s35, 2048
s_mov_b32 s33, 25
s_mov_b32 s34, 65536
Lp5_ll1:
s_waitcnt vmcnt(21)
s_barrier
s_add_u32 s38, s36, s34
s_add_u32 m0, s38, 0
s_nop 0
buffer_load_dwordx4 v4, s[8:11], s31 offen lds
s_add_u32 m0, s38, 1024
s_nop 0
buffer_load_dwordx4 v5, s[8:11], s31 offen lds
s_add_u32 m0, s38, 2048
s_nop 0
buffer_load_dwordx4 v6, s[8:11], s31 offen lds
s_add_u32 m0, s38, 3072
s_nop 0
buffer_load_dwordx4 v7, s[8:11], s31 offen lds
s_add_u32 s31, s31, 128
s_add_u32 s39, s37, s34
s_add_u32 m0, s39, 0
s_nop 0
buffer_load_dwordx4 v16, s[12:15], s32 offen sc1 lds
s_add_u32 m0, s39, 4096
s_nop 0
buffer_load_dwordx4 v17, s[12:15], s32 offen sc1 lds
s_add_u32 m0, s39, 8192
s_nop 0
buffer_load_dwordx4 v18, s[12:15], s32 offen sc1 lds
s_add_u32 s32, s32, 4096
s_add_u32 s35, s35, 2048
s_add_u32 s34, s34, 32768
s_cmp_eq_u32 s34, 163840
s_cselect_b32 s34, 0, s34
s_sub_u32 s33, s33, 1
s_cmp_lg_u32 s33, 0
s_cbranch_scc1 Lp5_ll1
v_lshlrev_b32 v25, 7, v1
s_lshl_b32 s88, s2, 2
s_add_u32 s88, s88, s30
s_mov_b32 s84, s54
s_mov_b32 s85, s55
s_mov_b32 s86, 3670016
s_mov_b32 s87, 0x00020000
s_mul_i32 s89, s88, 3584
v_cmp_gt_u32 vcc, 3584, v25
s_nop 3
s_mov_b64 exec, vcc
buffer_load_dword v0, v25, s[84:87], s89 offen
s_add_u32 s89, s89, 3584
s_mov_b64 exec, -1
s_waitcnt vmcnt(22)
s_barrier
s_waitcnt vmcnt(15)
s_barrier
s_waitcnt vmcnt(8)
s_barrier
s_waitcnt vmcnt(1)
s_barrier
s_barrier
Lp5_vd:
s_and_b32 s3, s2, 7
s_lshr_b32 s4, s2, 3
s_and_b32 s28, s3, 3
s_lshl_b32 s28, s28, 2
s_and_b32 s5, s4, 3
s_add_u32 s28, s28, s5
s_lshr_b32 s29, s3, 2
s_lshl_b32 s29, s29, 3
s_lshr_b32 s5, s4, 2
s_add_u32 s29, s29, s5
s_lshl_b32 s5, s30, 5
v_lshrrev_b32 v20, 3, v1
v_add_u32 v20, s5, v20
s_mov_b32 s6, 64
v_mul_lo_u32 v20, v20, s6
v_and_b32 v21, 7, v1
v_xor_b32 v21, v21, v3
v_lshrrev_b32 v22, 2, v21
v_lshlrev_b32 v22, 17, v22
v_and_b32 v21, 3, v21
v_lshl_add_u32 v21, v21, 4, v22
v_xor_b32 v22, 0, v21
v_add_u32 v22, v20, v22
v_add_u32 v4, 0, v22
v_xor_b32 v22, 131072, v21
v_add_u32 v22, v20, v22
v_add_u32 v5, 512, v22
v_xor_b32 v22, 0, v21
v_add_u32 v22, v20, v22
v_add_u32 v6, 1024, v22
v_xor_b32 v22, 131072, v21
v_add_u32 v22, v20, v22
v_add_u32 v7, 1536, v22
s_lshl_b32 s5, s28, 13
v_add_u32 v20, s5, v20
v_lshrrev_b32 v20, 1, v20
v_and_b32 v23, 32, v21
v_lshlrev_b32 v23, 11, v23
v_and_b32 v24, 0x20010, v21
v_or_b32 v23, v23, v24
v_add_u32 v4, s5, v4
v_xor_b32 v22, 0, v23
v_cmp_gt_u32 vcc, 0x20000, v22
v_add_u32 v22, v20, v22
v_add_u32 v22, 0, v22
v_cndmask_b32 v8, v4, v22, vcc
v_cndmask_b32 v12, v22, v4, vcc
v_add_u32 v5, s5, v5
v_xor_b32 v22, 131072, v23
v_cmp_gt_u32 vcc, 0x20000, v22
v_add_u32 v22, v20, v22
v_add_u32 v22, 256, v22
v_cndmask_b32 v9, v5, v22, vcc
v_cndmask_b32 v13, v22, v5, vcc
v_add_u32 v6, s5, v6
v_xor_b32 v22, 0, v23
v_cmp_gt_u32 vcc, 0x20000, v22
v_add_u32 v22, v20, v22
v_add_u32 v22, 512, v22
v_cndmask_b32 v10, v6, v22, vcc
v_cndmask_b32 v14, v22, v6, vcc
v_add_u32 v7, s5, v7
v_xor_b32 v22, 131072, v23
v_cmp_gt_u32 vcc, 0x20000, v22
v_add_u32 v22, v20, v22
v_add_u32 v22, 768, v22
v_cndmask_b32 v11, v7, v22, vcc
v_cndmask_b32 v15, v22, v7, vcc
s_and_b32 s7, s29, 1
s_mul_i32 s35, s7, 14
s_lshl_b32 s7, s7, 1
s_lshl_b32 s5, s30, 6
s_mov_b32 s6, 2048
v_add_u32 v20, s5, v1
v_add_u32 v20, 0, v20
v_mul_u32_u24 v21, 131072, v20
v_lshrrev_b32 v21, 20, v21
v_mul_u32_u24 v22, 8, v21
v_sub_u32 v22, v20, v22
v_bfe_u32 v23, v21, 1, 2
v_lshlrev_b32 v23, 1, v23
v_xor_b32 v22, v22, v23
v_and_b32 v23, 0x33, v21
v_bfe_u32 v24, v21, 2, 1
v_lshl_or_b32 v23, v24, 3, v23
v_bfe_u32 v24, v21, 3, 1
v_lshl_or_b32 v23, v24, 2, v23
v_mul_lo_u32 v23, v23, s6
v_lshl_add_u32 v16, v22, 4, v23
v_add_u32 v20, s5, v1
v_add_u32 v20, 256, v20
v_mul_u32_u24 v21, 131072, v20
v_lshrrev_b32 v21, 20, v21
v_mul_u32_u24 v22, 8, v21
v_sub_u32 v22, v20, v22
v_bfe_u32 v23, v21, 1, 2
v_lshlrev_b32 v23, 1, v23
v_xor_b32 v22, v22, v23
v_and_b32 v23, 0x33, v21
v_bfe_u32 v24, v21, 2, 1
v_lshl_or_b32 v23, v24, 3, v23
v_bfe_u32 v24, v21, 3, 1
v_lshl_or_b32 v23, v24, 2, v23
v_mul_lo_u32 v23, v23, s6
v_lshl_add_u32 v17, v22, 4, v23
s_add_u32 s8, s60, 41943040
s_addc_u32 s9, s61, 0
s_mov_b32 s10, 7340032
s_mov_b32 s11, 0x00020000
s_mov_b32 s12, s54
s_mov_b32 s13, s55
s_mov_b32 s14, 3670016
s_mov_b32 s15, 0x00020000
s_mul_i32 s31, s28, 0
s_lshr_b32 s32, s29, 0
s_mul_i32 s32, s32, 128
s_lshl_b32 s36, s30, 12
s_lshl_b32 s37, s30, 10
s_add_u32 s37, s37, 16384
s_mov_b32 s35, s32
s_barrier
s_add_u32 s39, s37, 49152
s_add_u32 m0, s39, 0
s_nop 0
buffer_load_dwordx4 v16, s[12:15], s32 offen lds
s_add_u32 m0, s39, 4096
s_nop 0
buffer_load_dwordx4 v17, s[12:15], s32 offen lds
s_add_u32 s32, s32, 131072
s_add_u32 s39, s37, 57344
s_add_u32 m0, s39, 0
s_nop 0
buffer_load_dwordx4 v16, s[12:15], s32 offen lds
s_add_u32 m0, s39, 4096
s_nop 0
buffer_load_dwordx4 v17, s[12:15], s32 offen lds
s_add_u32 s32, s32, 131072
s_add_u32 s39, s37, 65536
s_add_u32 m0, s39, 0
s_nop 0
buffer_load_dwordx4 v16, s[12:15], s32 offen lds
s_add_u32 m0, s39, 4096
s_nop 0
buffer_load_dwordx4 v17, s[12:15], s32 offen lds
s_add_u32 s32, s32, 131072
s_add_u32 s39, s37, 73728
s_add_u32 m0, s39, 0
s_nop 0
buffer_load_dwordx4 v16, s[12:15], s32 offen lds
s_add_u32 m0, s39, 4096
s_nop 0
buffer_load_dwordx4 v17, s[12:15], s32 offen lds
s_add_u32 s32, s32, 131072
s_add_u32 s39, s37, 81920
s_add_u32 m0, s39, 0
s_nop 0
buffer_load_dwordx4 v16, s[12:15], s32 offen lds
s_add_u32 m0, s39, 4096
s_nop 0
buffer_load_dwordx4 v17, s[12:15], s32 offen lds
s_add_u32 s32, s32, 131072
s_add_u32 s39, s37, 90112
s_add_u32 m0, s39, 0
s_nop 0
buffer_load_dwordx4 v16, s[12:15], s32 offen lds
s_add_u32 m0, s39, 4096
s_nop 0
buffer_load_dwordx4 v17, s[12:15], s32 offen lds
s_add_u32 s32, s32, 131072
s_add_u32 s39, s37, 98304
s_add_u32 m0, s39, 0
s_nop 0
buffer_load_dwordx4 v16, s[12:15], s32 offen lds
s_add_u32 m0, s39, 4096
s_nop 0
buffer_load_dwordx4 v17, s[12:15], s32 offen lds
s_add_u32 s32, s32, 131072
s_add_u32 s39, s37, 106496
s_add_u32 m0, s39, 0
s_nop 0
buffer_load_dwordx4 v16, s[12:15], s32 offen lds
s_add_u32 m0, s39, 4096
s_nop 0
buffer_load_dwordx4 v17, s[12:15], s32 offen lds
s_add_u32 s32, s32, 131072
s_add_u32 s39, s37, 114688
s_add_u32 m0, s39, 0
s_nop 0
buffer_load_dwordx4 v16, s[12:15], s32 offen lds
s_add_u32 m0, s39, 4096
s_nop 0
buffer_load_dwordx4 v17, s[12:15], s32 offen lds
s_add_u32 s32, s32, 131072
s_add_u32 s39, s37, 122880
s_add_u32 m0, s39, 0
s_nop 0
buffer_load_dwordx4 v16, s[12:15], s32 offen lds
s_add_u32 m0, s39, 4096
s_nop 0
buffer_load_dwordx4 v17, s[12:15], s32 offen lds
s_add_u32 s32, s32, 131072
s_add_u32 s39, s37, 131072
s_add_u32 m0, s39, 0
s_nop 0
buffer_load_dwordx4 v16, s[12:15], s32 offen lds
s_add_u32 m0, s39, 4096
s_nop 0
buffer_load_dwordx4 v17, s[12:15], s32 offen lds
s_add_u32 s32, s32, 131072
s_cmp_lg_u32 s30, 0
s_cbranch_scc1 Lp6_p0_ok
v_lshrrev_b32 v20, 2, v1
v_lshlrev_b32 v20, 5, v20
v_and_b32 v21, 3, v1
v_lshl_add_u32 v20, v21, 2, v20
s_lshl_b32 s3, s28, 9
s_add_u32 s3, s3, 40960
Lp6_p0:
buffer_load_dword v22, v20, s[96:99], s3 offen sc1
s_waitcnt vmcnt(0)
v_xor_b32 v22, s100, v22
v_cmp_ne_u32 vcc, 0, v22
s_nop 4
s_cbranch_vccz Lp6_p0_ok
s_sleep 4
s_branch Lp6_p0
Lp6_p0_ok:
s_barrier
s_add_u32 s38, s36, 0
s_add_u32 m0, s38, 0
s_nop 0
buffer_load_dwordx4 v4, s[8:11], s31 offen sc1 lds
s_add_u32 m0, s38, 1024
s_nop 0
buffer_load_dwordx4 v5, s[8:11], s31 offen sc1 lds
s_add_u32 m0, s38, 2048
s_nop 0
buffer_load_dwordx4 v6, s[8:11], s31 offen sc1 lds
s_add_u32 m0, s38, 3072
s_nop 0
buffer_load_dwordx4 v7, s[8:11], s31 offen sc1 lds
s_add_u32 s31, s31, 262144
s_add_u32 s38, s36, 16384
s_add_u32 m0, s38, 0
s_nop 0
buffer_load_dwordx4 v12, s[8:11], s31 offen sc1 lds
s_add_u32 m0, s38, 1024
s_nop 0
buffer_load_dwordx4 v13, s[8:11], s31 offen sc1 lds
s_add_u32 m0, s38, 2048
s_nop 0
buffer_load_dwordx4 v14, s[8:11], s31 offen sc1 lds
s_add_u32 m0, s38, 3072
s_nop 0
buffer_load_dwordx4 v15, s[8:11], s31 offen sc1 lds
s_add_u32 s31, s31, 262144
s_add_u32 s38, s36, 32768
s_add_u32 m0, s38, 0
s_nop 0
buffer_load_dwordx4 v4, s[8:11], s31 offen sc1 lds
s_add_u32 m0, s38, 1024
s_nop 0
buffer_load_dwordx4 v5, s[8:11], s31 offen sc1 lds
s_add_u32 m0, s38, 2048
s_nop 0
buffer_load_dwordx4 v6, s[8:11], s31 offen sc1 lds
s_add_u32 m0, s38, 3072
s_nop 0
buffer_load_dwordx4 v7, s[8:11], s31 offen sc1 lds
s_add_u32 s31, s31, 262144
s_waitcnt vmcnt(8)
s_barrier
s_add_u32 s38, s36, 49152
s_add_u32 m0, s38, 0
s_nop 0
buffer_load_dwordx4 v4, s[8:11], s31 offen sc1 lds
s_add_u32 m0, s38, 1024
s_nop 0
buffer_load_dwordx4 v5, s[8:11], s31 offen sc1 lds
s_add_u32 m0, s38, 2048
s_nop 0
buffer_load_dwordx4 v6, s[8:11], s31 offen sc1 lds
s_add_u32 m0, s38, 3072
s_nop 0
buffer_load_dwordx4 v7, s[8:11], s31 offen sc1 lds
s_add_u32 s31, s31, 262144
s_add_u32 s39, s37, 139264
s_add_u32 m0, s39, 0
s_nop 0
buffer_load_dwordx4 v16, s[12:15], s32 offen lds
s_add_u32 m0, s39, 4096
s_nop 0
buffer_load_dwordx4 v17, s[12:15], s32 offen lds
s_add_u32 s32, s32, 131072
s_waitcnt vmcnt(10)
s_barrier
s_add_u32 s38, s36, 0
s_add_u32 m0, s38, 0
s_nop 0
buffer_load_dwordx4 v4, s[8:11], s31 offen sc1 lds
s_add_u32 m0, s38, 1024
s_nop 0
buffer_load_dwordx4 v5, s[8:11], s31 offen sc1 lds
s_add_u32 m0, s38, 2048
s_nop 0
buffer_load_dwordx4 v6, s[8:11], s31 offen sc1 lds
s_add_u32 m0, s38, 3072
s_nop 0
buffer_load_dwordx4 v7, s[8:11], s31 offen sc1 lds
s_add_u32 s31, s31, 262144
s_add_u32 s39, s37, 49152
s_add_u32 m0, s39, 0
s_nop 0
buffer_load_dwordx4 v16, s[12:15], s32 offen lds
s_add_u32 m0, s39, 4096
s_nop 0
buffer_load_dwordx4 v17, s[12:15], s32 offen lds
s_add_u32 s32, s32, 131072
s_waitcnt vmcnt(12)
s_barrier
s_add_u32 s38, s36, 16384
s_add_u32 m0, s38, 0
s_nop 0
buffer_load_dwordx4 v8, s[8:11], s31 offen sc1 lds
s_add_u32 m0, s38, 1024
s_nop 0
buffer_load_dwordx4 v9, s[8:11], s31 offen sc1 lds
s_add_u32 m0, s38, 2048
s_nop 0
buffer_load_dwordx4 v10, s[8:11], s31 offen sc1 lds
s_add_u32 m0, s38, 3072
s_nop 0
buffer_load_dwordx4 v11, s[8:11], s31 offen sc1 lds
s_add_u32 s31, s31, 262144
s_add_u32 s39, s37, 57344
s_add_u32 m0, s39, 0
s_nop 0
buffer_load_dwordx4 v16, s[12:15], s32 offen lds
s_add_u32 m0, s39, 4096
s_nop 0
buffer_load_dwordx4 v17, s[12:15], s32 offen lds
s_add_u32 s32, s32, 131072
s_waitcnt vmcnt(14)
s_barrier
s_add_u32 s38, s36, 32768
s_add_u32 m0, s38, 0
s_nop 0
buffer_load_dwordx4 v4, s[8:11], s31 offen sc1 lds
s_add_u32 m0, s38, 1024
s_nop 0
buffer_load_dwordx4 v5, s[8:11], s31 offen sc1 lds
s_add_u32 m0, s38, 2048
s_nop 0
buffer_load_dwordx4 v6, s[8:11], s31 offen sc1 lds
s_add_u32 m0, s38, 3072
s_nop 0
buffer_load_dwordx4 v7, s[8:11], s31 offen sc1 lds
s_add_u32 s31, s31, 262144
s_add_u32 s39, s37, 65536
s_add_u32 m0, s39, 0
s_nop 0
buffer_load_dwordx4 v16, s[12:15], s32 offen lds
s_add_u32 m0, s39, 4096
s_nop 0
buffer_load_dwordx4 v17, s[12:15], s32 offen lds
s_add_u32 s32, s32, 131072
s_waitcnt vmcnt(14)
s_barrier
s_add_u32 s38, s36, 49152
s_add_u32 m0, s38, 0
s_nop 0
buffer_load_dwordx4 v4, s[8:11], s31 offen sc1 lds
s_add_u32 m0, s38, 1024
s_nop 0
buffer_load_dwordx4 v5, s[8:11], s31 offen sc1 lds
s_add_u32 m0, s38, 2048
s_nop 0
buffer_load_dwordx4 v6, s[8:11], s31 offen sc1 lds
s_add_u32 m0, s38, 3072
s_nop 0
buffer_load_dwordx4 v7, s[8:11], s31 offen sc1 lds
s_add_u32 s31, s31, 262144
s_add_u32 s39, s37, 73728
s_add_u32 m0, s39, 0
s_nop 0
buffer_load_dwordx4 v16, s[12:15], s32 offen lds
s_add_u32 m0, s39, 4096
s_nop 0
buffer_load_dwordx4 v17, s[12:15], s32 offen lds
s_add_u32 s32, s32, 131072
s_waitcnt vmcnt(14)
s_barrier
s_add_u32 s38, s36, 0
s_add_u32 m0, s38, 0
s_nop 0
buffer_load_dwordx4 v12, s[8:11], s31 offen sc1 lds
s_add_u32 m0, s38, 1024
s_nop 0
buffer_load_dwordx4 v13, s[8:11], s31 offen sc1 lds
s_add_u32 m0, s38, 2048
s_nop 0
buffer_load_dwordx4 v14, s[8:11], s31 offen sc1 lds
s_add_u32 m0, s38, 3072
s_nop 0
buffer_load_dwordx4 v15, s[8:11], s31 offen sc1 lds
s_add_u32 s31, s31, 262144
s_add_u32 s39, s37, 81920
s_add_u32 m0, s39, 0
s_nop 0
buffer_load_dwordx4 v16, s[12:15], s32 offen lds
s_add_u32 m0, s39, 4096
s_nop 0
buffer_load_dwordx4 v17, s[12:15], s32 offen lds
s_add_u32 s32, s32, 131072
s_waitcnt vmcnt(14)
s_barrier
s_add_u32 s38, s36, 16384
s_add_u32 m0, s38, 0
s_nop 0
buffer_load_dwordx4 v4, s[8:11], s31 offen sc1 lds
s_add_u32 m0, s38, 1024
s_nop 0
buffer_load_dwordx4 v5, s[8:11], s31 offen sc1 lds
s_add_u32 m0, s38, 2048
s_nop 0
buffer_load_dwordx4 v6, s[8:11], s31 offen sc1 lds
s_add_u32 m0, s38, 3072
s_nop 0
buffer_load_dwordx4 v7, s[8:11], s31 offen sc1 lds
s_add_u32 s31, s31, 262144
s_add_u32 s39, s37, 90112
s_add_u32 m0, s39, 0
s_nop 0
buffer_load_dwordx4 v16, s[12:15], s32 offen lds
s_add_u32 m0, s39, 4096
s_nop 0
buffer_load_dwordx4 v17, s[12:15], s32 offen lds
s_add_u32 s32, s32, 131072
s_waitcnt vmcnt(14)
s_barrier
s_add_u32 s38, s36, 32768
s_add_u32 m0, s38, 0
s_nop 0
buffer_load_dwordx4 v4, s[8:11], s31 offen sc1 lds
s_add_u32 m0, s38, 1024
s_nop 0
buffer_load_dwordx4 v5, s[8:11], s31 offen sc1 lds
s_add_u32 m0, s38, 2048
s_nop 0
buffer_load_dwordx4 v6, s[8:11], s31 offen sc1 lds
s_add_u32 m0, s38, 3072
s_nop 0
buffer_load_dwordx4 v7, s[8:11], s31 offen sc1 lds
s_add_u32 s31, s31, 262144
s_add_u32 s39, s37, 98304
s_add_u32 m0, s39, 0
s_nop 0
buffer_load_dwordx4 v16, s[12:15], s32 offen lds
s_add_u32 m0, s39, 4096
s_nop 0
buffer_load_dwordx4 v17, s[12:15], s32 offen lds
s_add_u32 s32, s32, 131072
s_waitcnt vmcnt(14)
s_barrier
s_add_u32 s38, s36, 49152
s_add_u32 m0, s38, 0
s_nop 0
buffer_load_dwordx4 v4, s[8:11], s31 offen sc1 lds
s_add_u32 m0, s38, 1024
s_nop 0
buffer_load_dwordx4 v5, s[8:11], s31 offen sc1 lds
s_add_u32 m0, s38, 2048
s_nop 0
buffer_load_dwordx4 v6, s[8:11], s31 offen sc1 lds
s_add_u32 m0, s38, 3072
s_nop 0
buffer_load_dwordx4 v7, s[8:11], s31 offen sc1 lds
s_add_u32 s31, s31, 262144
s_add_u32 s39, s37, 106496
s_add_u32 m0, s39, 0
s_nop 0
buffer_load_dwordx4 v16, s[12:15], s32 offen lds
s_add_u32 m0, s39, 4096
s_nop 0
buffer_load_dwordx4 v17, s[12:15], s32 offen lds
s_add_u32 s32, s32, 131072
s_waitcnt vmcnt(14)
s_barrier
s_add_u32 s38, s36, 0
s_add_u32 m0, s38, 0
s_nop 0
buffer_load_dwordx4 v8, s[8:11], s31 offen sc1 lds
s_add_u32 m0, s38, 1024
s_nop 0
buffer_load_dwordx4 v9, s[8:11], s31 offen sc1 lds
s_add_u32 m0, s38, 2048
s_nop 0
buffer_load_dwordx4 v10, s[8:11], s31 offen sc1 lds
s_add_u32 m0, s38, 3072
s_nop 0
buffer_load_dwordx4 v11, s[8:11], s31 offen sc1 lds
s_add_u32 s31, s31, 262144
s_add_u32 s39, s37, 114688
s_add_u32 m0, s39, 0
s_nop 0
buffer_load_dwordx4 v16, s[12:15], s32 offen lds
s_add_u32 m0, s39, 4096
s_nop 0
buffer_load_dwordx4 v17, s[12:15], s32 offen lds
s_add_u32 s32, s32, 131072
s_waitcnt vmcnt(14)
s_barrier
s_add_u32 s38, s36, 16384
s_add_u32 m0, s38, 0
s_nop 0
buffer_load_dwordx4 v4, s[8:11], s31 offen sc1 lds
s_add_u32 m0, s38, 1024
s_nop 0
buffer_load_dwordx4 v5, s[8:11], s31 offen sc1 lds
s_add_u32 m0, s38, 2048
s_nop 0
buffer_load_dwordx4 v6, s[8:11], s31 offen sc1 lds
s_add_u32 m0, s38, 3072
s_nop 0
buffer_load_dwordx4 v7, s[8:11], s31 offen sc1 lds
s_add_u32 s31, s31, 262144
s_add_u32 s39, s37, 122880
s_add_u32 m0, s39, 0
s_nop 0
buffer_load_dwordx4 v16, s[12:15], s32 offen lds
s_add_u32 m0, s39, 4096
s_nop 0
buffer_load_dwordx4 v17, s[12:15], s32 offen lds
s_add_u32 s32, s32, 131072
s_waitcnt vmcnt(14)
s_barrier
s_add_u32 s38, s36, 32768
s_add_u32 m0, s38, 0
s_nop 0
buffer_load_dwordx4 v4, s[8:11], s31 offen sc1 lds
s_add_u32 m0, s38, 1024
s_nop 0
buffer_load_dwordx4 v5, s[8:11], s31 offen sc1 lds
s_add_u32 m0, s38, 2048
s_nop 0
buffer_load_dwordx4 v6, s[8:11], s31 offen sc1 lds
s_add_u32 m0, s38, 3072
s_nop 0
buffer_load_dwordx4 v7, s[8:11], s31 offen sc1 lds
s_add_u32 s31, s31, 262144
s_add_u32 s39, s37, 131072
s_add_u32 m0, s39, 0
s_nop 0
buffer_load_dwordx4 v16, s[12:15], s32 offen lds
s_add_u32 m0, s39, 4096
s_nop 0
buffer_load_dwordx4 v17, s[12:15], s32 offen lds
s_add_u32 s32, s32, 131072
s_waitcnt vmcnt(14)
s_barrier
s_add_u32 s38, s36, 49152
s_add_u32 m0, s38, 0
s_nop 0
buffer_load_dwordx4 v12, s[8:11], s31 offen sc1 lds
s_add_u32 m0, s38, 1024
s_nop 0
buffer_load_dwordx4 v13, s[8:11], s31 offen sc1 lds
s_add_u32 m0, s38, 2048
s_nop 0
buffer_load_dwordx4 v14, s[8:11], s31 offen sc1 lds
s_add_u32 m0, s38, 3072
s_nop 0
buffer_load_dwordx4 v15, s[8:11], s31 offen sc1 lds
s_add_u32 s31, s31, 262144
s_add_u32 s39, s37, 139264
s_add_u32 m0, s39, 0
s_nop 0
buffer_load_dwordx4 v16, s[12:15], s32 offen lds
s_add_u32 m0, s39, 4096
s_nop 0
buffer_load_dwordx4 v17, s[12:15], s32 offen lds
s_add_u32 s32, s32, 131072
s_waitcnt vmcnt(14)
s_barrier
s_add_u32 s38, s36, 0
s_add_u32 m0, s38, 0
s_nop 0
buffer_load_dwordx4 v4, s[8:11], s31 offen sc1 lds
s_add_u32 m0, s38, 1024
s_nop 0
buffer_load_dwordx4 v5, s[8:11], s31 offen sc1 lds
s_add_u32 m0, s38, 2048
s_nop 0
buffer_load_dwordx4 v6, s[8:11], s31 offen sc1 lds
s_add_u32 m0, s38, 3072
s_nop 0
buffer_load_dwordx4 v7, s[8:11], s31 offen sc1 lds
s_add_u32 s31, s31, 262144
s_add_u32 s39, s37, 49152
s_add_u32 m0, s39, 0
s_nop 0
buffer_load_dwordx4 v16, s[12:15], s32 offen lds
s_add_u32 m0, s39, 4096
s_nop 0
buffer_load_dwordx4 v17, s[12:15], s32 offen lds
s_add_u32 s32, s32, 131072
s_waitcnt vmcnt(14)
s_barrier
s_add_u32 s38, s36, 16384
s_add_u32 m0, s38, 0
s_nop 0
buffer_load_dwordx4 v4, s[8:11], s31 offen sc1 lds
s_add_u32 m0, s38, 1024
s_nop 0
buffer_load_dwordx4 v5, s[8:11], s31 offen sc1 lds
s_add_u32 m0, s38, 2048
s_nop 0
buffer_load_dwordx4 v6, s[8:11], s31 offen sc1 lds
s_add_u32 m0, s38, 3072
s_nop 0
buffer_load_dwordx4 v7, s[8:11], s31 offen sc1 lds
s_add_u32 s31, s31, 262144
s_add_u32 s39, s37, 57344
s_add_u32 m0, s39, 0
s_nop 0
buffer_load_dwordx4 v16, s[12:15], s32 offen lds
s_add_u32 m0, s39, 4096
s_nop 0
buffer_load_dwordx4 v17, s[12:15], s32 offen lds
s_add_u32 s32, s32, 131072
s_waitcnt vmcnt(14)
s_barrier
s_add_u32 s38, s36, 32768
s_add_u32 m0, s38, 0
s_nop 0
buffer_load_dwordx4 v4, s[8:11], s31 offen sc1 lds
s_add_u32 m0, s38, 1024
s_nop 0
buffer_load_dwordx4 v5, s[8:11], s31 offen sc1 lds
s_add_u32 m0, s38, 2048
s_nop 0
buffer_load_dwordx4 v6, s[8:11], s31 offen sc1 lds
s_add_u32 m0, s38, 3072
s_nop 0
buffer_load_dwordx4 v7, s[8:11], s31 offen sc1 lds
s_add_u32 s31, s31, 262144
s_add_u32 s39, s37, 65536
s_add_u32 m0, s39, 0
s_nop 0
buffer_load_dwordx4 v16, s[12:15], s32 offen lds
s_add_u32 m0, s39, 4096
s_nop 0
buffer_load_dwordx4 v17, s[12:15], s32 offen lds
s_add_u32 s32, s32, 131072
s_waitcnt vmcnt(14)
s_barrier
s_add_u32 s38, s36, 49152
s_add_u32 m0, s38, 0
s_nop 0
buffer_load_dwordx4 v8, s[8:11], s31 offen sc1 lds
s_add_u32 m0, s38, 1024
s_nop 0
buffer_load_dwordx4 v9, s[8:11], s31 offen sc1 lds
s_add_u32 m0, s38, 2048
s_nop 0
buffer_load_dwordx4 v10, s[8:11], s31 offen sc1 lds
s_add_u32 m0, s38, 3072
s_nop 0
buffer_load_dwordx4 v11, s[8:11], s31 offen sc1 lds
s_add_u32 s31, s31, 262144
s_add_u32 s39, s37, 73728
s_add_u32 m0, s39, 0
s_nop 0
buffer_load_dwordx4 v16, s[12:15], s32 offen lds
s_add_u32 m0, s39, 4096
s_nop 0
buffer_load_dwordx4 v17, s[12:15], s32 offen lds
s_add_u32 s32, s32, 131072
s_waitcnt vmcnt(14)
s_barrier
s_add_u32 s38, s36, 0
s_add_u32 m0, s38, 0
s_nop 0
buffer_load_dwordx4 v4, s[8:11], s31 offen sc1 lds
s_add_u32 m0, s38, 1024
s_nop 0
buffer_load_dwordx4 v5, s[8:11], s31 offen sc1 lds
s_add_u32 m0, s38, 2048
s_nop 0
buffer_load_dwordx4 v6, s[8:11], s31 offen sc1 lds
s_add_u32 m0, s38, 3072
s_nop 0
buffer_load_dwordx4 v7, s[8:11], s31 offen sc1 lds
s_add_u32 s31, s31, 262144
s_waitcnt vmcnt(12)
s_barrier
s_add_u32 s38, s36, 16384
s_add_u32 m0, s38, 0
s_nop 0
buffer_load_dwordx4 v4, s[8:11], s31 offen sc1 lds
s_add_u32 m0, s38, 1024
s_nop 0
buffer_load_dwordx4 v5, s[8:11], s31 offen sc1 lds
s_add_u32 m0, s38, 2048
s_nop 0
buffer_load_dwordx4 v6, s[8:11], s31 offen sc1 lds
s_add_u32 m0, s38, 3072
s_nop 0
buffer_load_dwordx4 v7, s[8:11], s31 offen sc1 lds
s_add_u32 s31, s31, 262144
s_waitcnt vmcnt(10)
s_barrier
s_add_u32 s38, s36, 32768
s_add_u32 m0, s38, 0
s_nop 0
buffer_load_dwordx4 v12, s[8:11], s31 offen sc1 lds
s_add_u32 m0, s38, 1024
s_nop 0
buffer_load_dwordx4 v13, s[8:11], s31 offen sc1 lds
s_add_u32 m0, s38, 2048
s_nop 0
buffer_load_dwordx4 v14, s[8:11], s31 offen sc1 lds
s_add_u32 m0, s38, 3072
s_nop 0
buffer_load_dwordx4 v15, s[8:11], s31 offen sc1 lds
s_add_u32 s31, s31, 262144
s_waitcnt vmcnt(8)
s_barrier
s_add_u32 s38, s36, 49152
s_add_u32 m0, s38, 0
s_nop 0
buffer_load_dwordx4 v4, s[8:11], s31 offen sc1 lds
s_add_u32 m0, s38, 1024
s_nop 0
buffer_load_dwordx4 v5, s[8:11], s31 offen sc1 lds
s_add_u32 m0, s38, 2048
s_nop 0
buffer_load_dwordx4 v6, s[8:11], s31 offen sc1 lds
s_add_u32 m0, s38, 3072
s_nop 0
buffer_load_dwordx4 v7, s[8:11], s31 offen sc1 lds
s_add_u32 s31, s31, 262144
s_waitcnt vmcnt(8)
s_barrier
s_add_u32 s38, s36, 0
s_add_u32 m0, s38, 0
s_nop 0
buffer_load_dwordx4 v4, s[8:11], s31 offen sc1 lds
s_add_u32 m0, s38, 1024
s_nop 0
buffer_load_dwordx4 v5, s[8:11], s31 offen sc1 lds
s_add_u32 m0, s38, 2048
s_nop 0
buffer_load_dwordx4 v6, s[8:11], s31 offen sc1 lds
s_add_u32 m0, s38, 3072
s_nop 0
buffer_load_dwordx4 v7, s[8:11], s31 offen sc1 lds
s_add_u32 s31, s31, 262144
s_waitcnt vmcnt(8)
s_barrier
s_add_u32 s38, s36, 16384
s_add_u32 m0, s38, 0
s_nop 0
buffer_load_dwordx4 v4, s[8:11], s31 offen sc1 lds
s_add_u32 m0, s38, 1024
s_nop 0
buffer_load_dwordx4 v5, s[8:11], s31 offen sc1 lds
s_add_u32 m0, s38, 2048
s_nop 0
buffer_load_dwordx4 v6, s[8:11], s31 offen sc1 lds
s_add_u32 m0, s38, 3072
s_nop 0
buffer_load_dwordx4 v7, s[8:11], s31 offen sc1 lds
s_add_u32 s31, s31, 262144
s_waitcnt vmcnt(8)
s_barrier
s_add_u32 s38, s36, 32768
s_add_u32 m0, s38, 0
s_nop 0
buffer_load_dwordx4 v8, s[8:11], s31 offen sc1 lds
s_add_u32 m0, s38, 1024
s_nop 0
buffer_load_dwordx4 v9, s[8:11], s31 offen sc1 lds
s_add_u32 m0, s38, 2048
s_nop 0
buffer_load_dwordx4 v10, s[8:11], s31 offen sc1 lds
s_add_u32 m0, s38, 3072
s_nop 0
buffer_load_dwordx4 v11, s[8:11], s31 offen sc1 lds
s_add_u32 s31, s31, 262144
s_waitcnt vmcnt(8)
s_barrier
s_add_u32 s38, s36, 49152
s_add_u32 m0, s38, 0
s_nop 0
buffer_load_dwordx4 v4, s[8:11], s31 offen sc1 lds
s_add_u32 m0, s38, 1024
s_nop 0
buffer_load_dwordx4 v5, s[8:11], s31 offen sc1 lds
s_add_u32 m0, s38, 2048
s_nop 0
buffer_load_dwordx4 v6, s[8:11], s31 offen sc1 lds
s_add_u32 m0, s38, 3072
s_nop 0
buffer_load_dwordx4 v7, s[8:11], s31 offen sc1 lds
s_add_u32 s31, s31, 262144
s_waitcnt vmcnt(8)
s_barrier
s_waitcnt vmcnt(4)
s_barrier
s_waitcnt vmcnt(0)
s_barrier
s_barrier
Lsequential_preLN__sliding_block__mixer_gmlp__prompt_kernel_end:
s_endpgm
Lcode_end:
.section .rodata,"a"
.p2align 6
.amdhsa_kernel sequential_preLN__sliding_block__mixer_gmlp__prompt_kernel
  .amdhsa_next_free_vgpr 256
  .amdhsa_next_free_sgpr 102
  .amdhsa_accum_offset 256
  .amdhsa_group_segment_fixed_size 0
  .amdhsa_kernarg_size 88
  .amdhsa_user_sgpr_count 2
  .amdhsa_user_sgpr_kernarg_segment_ptr 1
  .amdhsa_system_sgpr_workgroup_id_x 1
.end_amdhsa_kernel
```
